```python
import torch

def _softmax(x, axis=-1):
    return torch.softmax(x, dim=axis)

def _gelu(x):
    return torch.nn.functional.gelu(x, approximate='tanh')

def _silu(x):
    return torch.nn.functional.silu(x)

def _sigmoid(x):
    return torch.sigmoid(x)

def _layernorm(x, axis=-1, eps=1e-05):
    m = x.mean(dim=axis, keepdim=True)
    v = x.var(dim=axis, keepdim=True, unbiased=False)
    return (x - m) / torch.sqrt(v + eps)

def _scatter_add(tgt, idx, src, axis=0):
    return tgt.clone().index_add_(axis, idx, src)

def _segment_sum(src, seg, n):
    out = torch.zeros((n,) + src.shape[1:], dtype=src.dtype)
    return out.index_add_(0, seg, src)

def _pad(x, pw):
    flat = tuple((v for pair in reversed(pw) for v in pair))
    return torch.nn.functional.pad(x, flat)
kernel_name = 'parallel_sum__memory_aug_recurrent_mem_tr__mixer_channel_mlp__prompt'

def setup_inputs():

    _w = lambda a: (lambda t: t.to(torch.bfloat16) if t.is_floating_point() else t)(torch.as_tensor(a))

    def _A_setup():
        B, S, Dm = (1, 2048, 576)
        H, Dh = (32, 128)
        M, seg = (8, 32)
        seg = min(seg, S)
        S = S // seg * seg
        return {'x': _w((lambda *s: torch.randn(*s, dtype=torch.bfloat16) * 0.05)(B, S, Dm)), 'mem0': _w((lambda *s: torch.randn(*s, dtype=torch.bfloat16) * 0.2)(B, M, Dm)), 'Wq': _w((lambda *s: torch.randn(*s, dtype=torch.bfloat16) * 1.6)(Dm, H, Dh) * Dm ** (-0.5)), 'Wk': _w((lambda *s: torch.randn(*s, dtype=torch.bfloat16) * 1.6)(Dm, H, Dh) * Dm ** (-0.5)), 'Wv': _w((lambda *s: torch.randn(*s, dtype=torch.bfloat16) * 0.2)(Dm, H, Dh) * Dm ** (-0.5)), 'Wo': _w((lambda *s: torch.randn(*s, dtype=torch.bfloat16) * 0.2)(H, Dh, Dm) * (H * Dh) ** (-0.5)), 'seg_len': seg}
    _A_in = _A_setup()

    def _B_setup():
        B, S, D, F = (1, 2048, 576, 4608)
        return {'x': _w((lambda *s: torch.randn(*s, dtype=torch.bfloat16) * 0.05)(B, S, D)), 'w1': _w((lambda *s: torch.randn(*s, dtype=torch.bfloat16) * 0.8)(D, F) * D ** (-0.5)), 'b1': _w((lambda *s: torch.randn(*s, dtype=torch.bfloat16) * 0.4)(F)), 'w2': _w((lambda *s: torch.randn(*s, dtype=torch.bfloat16) * 0.05)(F, D) * F ** (-0.5)), 'b2': _w((lambda *s: torch.randn(*s, dtype=torch.bfloat16) * 0.05)(D))}
    _B_in = _B_setup()
    return {'A_x': _A_in['x'], 'A_mem0': _A_in['mem0'], 'A_Wq': _A_in['Wq'], 'A_Wk': _A_in['Wk'], 'A_Wv': _A_in['Wv'], 'A_Wo': _A_in['Wo'], 'A_seg_len': _A_in['seg_len'], 'B_x': _B_in['x'], 'B_w1': _B_in['w1'], 'B_b1': _B_in['b1'], 'B_w2': _B_in['w2'], 'B_b2': _B_in['b2']}

def reference(A_x, A_mem0, A_Wq, A_Wk, A_Wv, A_Wo, A_seg_len, B_x, B_w1, B_b1, B_w2, B_b2):

    def _A_ref(x, mem0, Wq, Wk, Wv, Wo, seg_len):
        B, S, Dm = x.shape
        H, Dh = (Wq.shape[1], Wq.shape[2])
        M = mem0.shape[1]
        scale = Dh ** (-0.5)
        n_seg = S // seg_len
        L = M + seg_len
        idx = torch.arange(L)
        mask = (idx[:, None] < M) | (idx[:, None] >= idx[None, :])
        mem = mem0
        outs = []
        for s in range(n_seg):
            xs = x[:, s * seg_len:(s + 1) * seg_len, :].clone()
            h = torch.concatenate([mem, xs], axis=1)
            q = torch.einsum('btd,dhe->bhte', h, Wq)
            k = torch.einsum('btd,dhe->bhte', h, Wk)
            v = torch.einsum('btd,dhe->bhte', h, Wv)
            scores = torch.einsum('bhqe,bhke->bhqk', q, k) * scale
            scores = torch.where(mask[None, None], scores, -1000000000.0)
            p = _softmax(scores, axis=-1)
            o = torch.einsum('bhqk,bhke->bhqe', p, v)
            o = torch.einsum('bhte,hed->btd', o, Wo)
            mem = o[:, :M, :].clone()
            outs.append(o[:, M:, :])
        return torch.concatenate(outs, axis=1)

    def _B_ref(x, w1, b1, w2, b2):
        y = _layernorm(x, axis=-1)
        h = _gelu(torch.einsum('bsd,df->bsf', y, w1) + b1)
        return torch.einsum('bsf,fd->bsd', h, w2) + b2
    x = A_x
    xn = _layernorm(x, axis=-1)
    return x + _A_ref(xn, A_mem0, A_Wq, A_Wk, A_Wv, A_Wo, A_seg_len) + _B_ref(xn, B_w1, B_b1, B_w2, B_b2)
```

```asm
; @launch grid=(256,1,1) block=(256,1,1) lds=163840
.amdgcn_target "amdgcn-amd-amdhsa--gfx950"
.text
.globl parallel_sum__memory_aug_recurrent_mem_tr__mixer_channel_mlp__prompt_kernel
.p2align 8
.type parallel_sum__memory_aug_recurrent_mem_tr__mixer_channel_mlp__prompt_kernel,@function
parallel_sum__memory_aug_recurrent_mem_tr__mixer_channel_mlp__prompt_kernel:
    s_cmp_ge_u32 s2, 256
    s_cbranch_scc1 L_end
    s_mov_b32 s3, 30000
    s_load_dwordx2 s[42:43], s[0:1], 104
    s_load_dwordx2 s[8:9], s[0:1], 112
    s_getreg_b32 s4, hwreg(HW_REG_XCC_ID, 0, 4)
    v_lshrrev_b32 v1, 6, v0
    v_and_b32 v0, 63, v0
    s_nop 0
    v_readfirstlane_b32 s17, v1
    s_and_b32 s4, s4, 7
    s_waitcnt lgkmcnt(0)
    s_mov_b32 s10, 0x10000000
    s_mov_b32 s11, 0x20000
    s_cmp_eq_u32 s17, 0
    s_cbranch_scc0 L_bs1
    s_lshl_b32 s12, s4, 2
    s_add_u32 s12, s12, 128
    s_cmp_eq_u32 s4, 0
    s_cselect_b32 s12, 0, s12
    v_mov_b32 v2, s12
    v_mov_b32 v3, 1
    s_mov_b64 exec, 1
    global_atomic_add v4, v2, v3, s[42:43] sc0
    s_waitcnt vmcnt(0)
    v_mov_b32 v2, 0
    ds_write_b32 v2, v4
    s_waitcnt lgkmcnt(0)
    s_mov_b64 exec, -1
L_bs1:
    s_cmp_eq_u32 s2, 0
    s_cbranch_scc0 L_bs2
    s_lshl_b32 s12, s17, 6
    v_add_u32 v2, s12, v0
    v_lshlrev_b32 v2, 4, v2
    v_mov_b64 v[4:5], 0
    v_mov_b64 v[6:7], 0
    s_mov_b32 s12, 0x200000
    buffer_store_dwordx4 v[4:7], v2, s[8:11], s12 offen sc1
    s_mov_b32 s12, 0x201000
    buffer_store_dwordx4 v[4:7], v2, s[8:11], s12 offen sc1
    s_mov_b32 s12, 0x202000
    buffer_store_dwordx4 v[4:7], v2, s[8:11], s12 offen sc1
    s_mov_b32 s12, 0x203000
    buffer_store_dwordx4 v[4:7], v2, s[8:11], s12 offen sc1
    s_mov_b32 s12, 0x204000
    buffer_store_dwordx4 v[4:7], v2, s[8:11], s12 offen sc1
    s_mov_b32 s12, 0x205000
    buffer_store_dwordx4 v[4:7], v2, s[8:11], s12 offen sc1
    s_waitcnt vmcnt(0)
    s_barrier
    s_cmp_eq_u32 s17, 0
    s_cbranch_scc0 L_bs2
    v_mov_b32 v2, 192
    v_mov_b32 v3, 1
    s_mov_b64 exec, 1
    global_store_dword v2, v3, s[42:43] sc1
    s_mov_b64 exec, -1
L_bs2:
    s_barrier
    v_mov_b32 v2, 0
    ds_read_b32 v4, v2
    s_waitcnt lgkmcnt(0)
    v_readfirstlane_b32 s5, v4
    s_barrier
    s_cmp_lt_u32 s5, 32
    s_cbranch_scc1 L_role
    s_mov_b32 s13, s3
L_ov_poll:
    v_and_b32 v5, 7, v0
    v_lshlrev_b32 v5, 2, v5
    v_add_u32 v5, 128, v5
    v_and_b32 v4, 7, v0
    v_cmp_eq_u32 vcc, 0, v4
    s_nop 1
    v_cndmask_b32 v5, v5, 0, vcc
    global_load_dword v4, v5, s[42:43] sc1
    s_waitcnt vmcnt(0)
    v_readlane_b32 s20, v4, 0
    v_readlane_b32 s21, v4, 1
    v_readlane_b32 s22, v4, 2
    v_readlane_b32 s23, v4, 3
    v_readlane_b32 s24, v4, 4
    v_readlane_b32 s25, v4, 5
    v_readlane_b32 s26, v4, 6
    v_readlane_b32 s27, v4, 7
    s_mov_b32 s12, 0
    s_add_u32 s12, s12, s20
    s_add_u32 s12, s12, s21
    s_add_u32 s12, s12, s22
    s_add_u32 s12, s12, s23
    s_add_u32 s12, s12, s24
    s_add_u32 s12, s12, s25
    s_add_u32 s12, s12, s26
    s_add_u32 s12, s12, s27
    s_cmp_ge_u32 s12, 256
    s_cbranch_scc1 L_ov_ok
    s_sleep 8
    s_sub_u32 s13, s13, 1
    s_cmp_lg_u32 s13, 0
    s_cbranch_scc1 L_ov_poll
L_ov_ok:
    s_sub_u32 s12, s5, 32
    s_sub_i32 s14, s20, 32
    s_max_i32 s14, s14, 0
    s_cmp_gt_u32 s4, 0
    s_cselect_b32 s14, s14, 0
    s_add_u32 s12, s12, s14
    s_sub_i32 s14, s21, 32
    s_max_i32 s14, s14, 0
    s_cmp_gt_u32 s4, 1
    s_cselect_b32 s14, s14, 0
    s_add_u32 s12, s12, s14
    s_sub_i32 s14, s22, 32
    s_max_i32 s14, s14, 0
    s_cmp_gt_u32 s4, 2
    s_cselect_b32 s14, s14, 0
    s_add_u32 s12, s12, s14
    s_sub_i32 s14, s23, 32
    s_max_i32 s14, s14, 0
    s_cmp_gt_u32 s4, 3
    s_cselect_b32 s14, s14, 0
    s_add_u32 s12, s12, s14
    s_sub_i32 s14, s24, 32
    s_max_i32 s14, s14, 0
    s_cmp_gt_u32 s4, 4
    s_cselect_b32 s14, s14, 0
    s_add_u32 s12, s12, s14
    s_sub_i32 s14, s25, 32
    s_max_i32 s14, s14, 0
    s_cmp_gt_u32 s4, 5
    s_cselect_b32 s14, s14, 0
    s_add_u32 s12, s12, s14
    s_sub_i32 s14, s26, 32
    s_max_i32 s14, s14, 0
    s_cmp_gt_u32 s4, 6
    s_cselect_b32 s14, s14, 0
    s_add_u32 s12, s12, s14
    s_sub_i32 s14, s27, 32
    s_max_i32 s14, s14, 0
    s_cmp_gt_u32 s4, 7
    s_cselect_b32 s14, s14, 0
    s_add_u32 s12, s12, s14
    s_mov_b32 s15, 0
    s_sub_i32 s14, 32, s20
    s_max_i32 s14, s14, 0
    s_cmp_eq_u32 s15, 0
    s_cselect_b32 s16, 1, 0
    s_cmp_lt_u32 s12, s14
    s_cselect_b32 s16, s16, 0
    s_cmp_eq_u32 s16, 1
    s_cbranch_scc0 L_ov_n0
    s_mov_b32 s4, 0
    s_add_u32 s5, s20, s12
    s_mov_b32 s15, 1
L_ov_n0:
    s_cmp_eq_u32 s15, 0
    s_cselect_b32 s14, s14, 0
    s_sub_u32 s12, s12, s14
    s_sub_i32 s14, 32, s21
    s_max_i32 s14, s14, 0
    s_cmp_eq_u32 s15, 0
    s_cselect_b32 s16, 1, 0
    s_cmp_lt_u32 s12, s14
    s_cselect_b32 s16, s16, 0
    s_cmp_eq_u32 s16, 1
    s_cbranch_scc0 L_ov_n1
    s_mov_b32 s4, 1
    s_add_u32 s5, s21, s12
    s_mov_b32 s15, 1
L_ov_n1:
    s_cmp_eq_u32 s15, 0
    s_cselect_b32 s14, s14, 0
    s_sub_u32 s12, s12, s14
    s_sub_i32 s14, 32, s22
    s_max_i32 s14, s14, 0
    s_cmp_eq_u32 s15, 0
    s_cselect_b32 s16, 1, 0
    s_cmp_lt_u32 s12, s14
    s_cselect_b32 s16, s16, 0
    s_cmp_eq_u32 s16, 1
    s_cbranch_scc0 L_ov_n2
    s_mov_b32 s4, 2
    s_add_u32 s5, s22, s12
    s_mov_b32 s15, 1
L_ov_n2:
    s_cmp_eq_u32 s15, 0
    s_cselect_b32 s14, s14, 0
    s_sub_u32 s12, s12, s14
    s_sub_i32 s14, 32, s23
    s_max_i32 s14, s14, 0
    s_cmp_eq_u32 s15, 0
    s_cselect_b32 s16, 1, 0
    s_cmp_lt_u32 s12, s14
    s_cselect_b32 s16, s16, 0
    s_cmp_eq_u32 s16, 1
    s_cbranch_scc0 L_ov_n3
    s_mov_b32 s4, 3
    s_add_u32 s5, s23, s12
    s_mov_b32 s15, 1
L_ov_n3:
    s_cmp_eq_u32 s15, 0
    s_cselect_b32 s14, s14, 0
    s_sub_u32 s12, s12, s14
    s_sub_i32 s14, 32, s24
    s_max_i32 s14, s14, 0
    s_cmp_eq_u32 s15, 0
    s_cselect_b32 s16, 1, 0
    s_cmp_lt_u32 s12, s14
    s_cselect_b32 s16, s16, 0
    s_cmp_eq_u32 s16, 1
    s_cbranch_scc0 L_ov_n4
    s_mov_b32 s4, 4
    s_add_u32 s5, s24, s12
    s_mov_b32 s15, 1
L_ov_n4:
    s_cmp_eq_u32 s15, 0
    s_cselect_b32 s14, s14, 0
    s_sub_u32 s12, s12, s14
    s_sub_i32 s14, 32, s25
    s_max_i32 s14, s14, 0
    s_cmp_eq_u32 s15, 0
    s_cselect_b32 s16, 1, 0
    s_cmp_lt_u32 s12, s14
    s_cselect_b32 s16, s16, 0
    s_cmp_eq_u32 s16, 1
    s_cbranch_scc0 L_ov_n5
    s_mov_b32 s4, 5
    s_add_u32 s5, s25, s12
    s_mov_b32 s15, 1
L_ov_n5:
    s_cmp_eq_u32 s15, 0
    s_cselect_b32 s14, s14, 0
    s_sub_u32 s12, s12, s14
    s_sub_i32 s14, 32, s26
    s_max_i32 s14, s14, 0
    s_cmp_eq_u32 s15, 0
    s_cselect_b32 s16, 1, 0
    s_cmp_lt_u32 s12, s14
    s_cselect_b32 s16, s16, 0
    s_cmp_eq_u32 s16, 1
    s_cbranch_scc0 L_ov_n6
    s_mov_b32 s4, 6
    s_add_u32 s5, s26, s12
    s_mov_b32 s15, 1
L_ov_n6:
    s_cmp_eq_u32 s15, 0
    s_cselect_b32 s14, s14, 0
    s_sub_u32 s12, s12, s14
    s_sub_i32 s14, 32, s27
    s_max_i32 s14, s14, 0
    s_cmp_eq_u32 s15, 0
    s_cselect_b32 s16, 1, 0
    s_cmp_lt_u32 s12, s14
    s_cselect_b32 s16, s16, 0
    s_cmp_eq_u32 s16, 1
    s_cbranch_scc0 L_ov_n7
    s_mov_b32 s4, 7
    s_add_u32 s5, s27, s12
    s_mov_b32 s15, 1
L_ov_n7:
    s_cmp_eq_u32 s15, 0
    s_cselect_b32 s14, s14, 0
    s_sub_u32 s12, s12, s14
L_role:
    s_cmp_eq_u32 s4, 0
    s_cbranch_scc0 L_wk
    s_mov_b32 s16, s5
    s_branch L_chain
L_wk:
    s_sub_u32 s7, s4, 1
    s_lshl_b32 s7, s7, 5
    s_add_u32 s7, s7, s5
    s_branch L_worker
L_worker:
    s_load_dwordx2 s[48:49], s[0:1], 24
    s_load_dwordx2 s[50:51], s[0:1], 32
    s_load_dwordx2 s[52:53], s[0:1], 16
    s_load_dwordx2 s[54:55], s[0:1], 64
    s_load_dwordx2 s[56:57], s[0:1], 72
    s_load_dwordx2 s[58:59], s[0:1], 80
    s_load_dwordx2 s[64:65], s[0:1], 0
    s_load_dwordx2 s[66:67], s[0:1], 88
    s_load_dwordx2 s[68:69], s[0:1], 96
    s_load_dwordx2 s[70:71], s[0:1], 40
    s_waitcnt lgkmcnt(0)
    s_mov_b32 s40, 0xc0135761
    s_mov_b32 s41, 0xbdd2d3e7
    s_sub_u32 s46, s7, 64
    s_cmp_lt_u32 s46, 128
    s_cbranch_scc0 L_noln
    s_mov_b32 s32, s64
    s_mov_b32 s33, s65
    s_mov_b32 s34, 0x240000
    s_mov_b32 s35, 0x20000
    s_lshl_b32 s47, s46, 4
    s_lshl_b32 s45, s17, 2
    s_add_u32 s47, s47, s45
    v_lshrrev_b32 v2, 4, v0
    v_and_b32 v3, 15, v0
    v_add_u32 v2, s47, v2
    s_movk_i32 s19, 1152
    v_mul_lo_u32 v4, v2, s19
    v_lshl_add_u32 v4, v3, 3, v4
    buffer_load_dwordx2 v[20:21], v4, s[32:35], 0 offen offset:0
    buffer_load_dwordx2 v[22:23], v4, s[32:35], 0 offen offset:128
    buffer_load_dwordx2 v[24:25], v4, s[32:35], 0 offen offset:256
    buffer_load_dwordx2 v[26:27], v4, s[32:35], 0 offen offset:384
    buffer_load_dwordx2 v[28:29], v4, s[32:35], 0 offen offset:512
    buffer_load_dwordx2 v[30:31], v4, s[32:35], 0 offen offset:640
    buffer_load_dwordx2 v[32:33], v4, s[32:35], 0 offen offset:768
    buffer_load_dwordx2 v[34:35], v4, s[32:35], 0 offen offset:896
    buffer_load_dwordx2 v[36:37], v4, s[32:35], 0 offen offset:1024
    v_lshrrev_b32 v18, 2, v3
    v_lshlrev_b32 v18, 10, v18
    v_and_b32 v10, 1, v3
    v_lshl_add_u32 v18, v10, 9, v18
    v_and_b32 v11, 31, v2
    v_lshl_add_u32 v18, v11, 4, v18
    v_bfe_u32 v10, v3, 1, 1
    v_cmp_eq_u32 s[84:85], 0, v10
    v_mov_b32 v19, 0x40000000
    s_nop 0
    v_cndmask_b32 v19, v19, v18, s[84:85]
    v_lshl_add_u32 v18, v10, 12, v18
    s_lshr_b32 s29, s47, 5
    s_mul_i32 s29, s29, 36864
    s_mov_b32 s20, 0x3ae38e39
    s_mov_b32 s21, 0x3727c5ac
    s_waitcnt vmcnt(8)
    v_lshlrev_b32 v40, 16, v20
    v_and_b32 v41, 0xffff0000, v20
    v_lshlrev_b32 v42, 16, v21
    v_and_b32 v43, 0xffff0000, v21
    s_waitcnt vmcnt(7)
    v_lshlrev_b32 v44, 16, v22
    v_and_b32 v45, 0xffff0000, v22
    v_lshlrev_b32 v46, 16, v23
    v_and_b32 v47, 0xffff0000, v23
    s_waitcnt vmcnt(6)
    v_lshlrev_b32 v48, 16, v24
    v_and_b32 v49, 0xffff0000, v24
    v_lshlrev_b32 v50, 16, v25
    v_and_b32 v51, 0xffff0000, v25
    s_waitcnt vmcnt(5)
    v_lshlrev_b32 v52, 16, v26
    v_and_b32 v53, 0xffff0000, v26
    v_lshlrev_b32 v54, 16, v27
    v_and_b32 v55, 0xffff0000, v27
    s_waitcnt vmcnt(4)
    v_lshlrev_b32 v56, 16, v28
    v_and_b32 v57, 0xffff0000, v28
    v_lshlrev_b32 v58, 16, v29
    v_and_b32 v59, 0xffff0000, v29
    s_waitcnt vmcnt(3)
    v_lshlrev_b32 v60, 16, v30
    v_and_b32 v61, 0xffff0000, v30
    v_lshlrev_b32 v62, 16, v31
    v_and_b32 v63, 0xffff0000, v31
    s_waitcnt vmcnt(2)
    v_lshlrev_b32 v64, 16, v32
    v_and_b32 v65, 0xffff0000, v32
    v_lshlrev_b32 v66, 16, v33
    v_and_b32 v67, 0xffff0000, v33
    s_waitcnt vmcnt(1)
    v_lshlrev_b32 v68, 16, v34
    v_and_b32 v69, 0xffff0000, v34
    v_lshlrev_b32 v70, 16, v35
    v_and_b32 v71, 0xffff0000, v35
    s_waitcnt vmcnt(0)
    v_lshlrev_b32 v72, 16, v36
    v_and_b32 v73, 0xffff0000, v36
    v_lshlrev_b32 v74, 16, v37
    v_and_b32 v75, 0xffff0000, v37
    v_pk_add_f32 v[6:7], v[40:41], v[42:43]
    v_pk_add_f32 v[6:7], v[6:7], v[44:45]
    v_pk_add_f32 v[6:7], v[6:7], v[46:47]
    v_pk_add_f32 v[6:7], v[6:7], v[48:49]
    v_pk_add_f32 v[6:7], v[6:7], v[50:51]
    v_pk_add_f32 v[6:7], v[6:7], v[52:53]
    v_pk_add_f32 v[6:7], v[6:7], v[54:55]
    v_pk_add_f32 v[6:7], v[6:7], v[56:57]
    v_pk_add_f32 v[6:7], v[6:7], v[58:59]
    v_pk_add_f32 v[6:7], v[6:7], v[60:61]
    v_pk_add_f32 v[6:7], v[6:7], v[62:63]
    v_pk_add_f32 v[6:7], v[6:7], v[64:65]
    v_pk_add_f32 v[6:7], v[6:7], v[66:67]
    v_pk_add_f32 v[6:7], v[6:7], v[68:69]
    v_pk_add_f32 v[6:7], v[6:7], v[70:71]
    v_pk_add_f32 v[6:7], v[6:7], v[72:73]
    v_pk_add_f32 v[6:7], v[6:7], v[74:75]
    v_add_f32 v5, v6, v7
    s_nop 1
    v_add_f32_dpp v5, v5, v5 row_ror:8 row_mask:0xf bank_mask:0xf
    s_nop 1
    v_add_f32_dpp v5, v5, v5 row_ror:4 row_mask:0xf bank_mask:0xf
    s_nop 1
    v_add_f32_dpp v5, v5, v5 row_ror:2 row_mask:0xf bank_mask:0xf
    s_nop 1
    v_add_f32_dpp v5, v5, v5 row_ror:1 row_mask:0xf bank_mask:0xf
    v_mul_f32 v8, s20, v5
    v_mov_b32 v12, 0
    v_mov_b32 v13, 0
    v_pk_add_f32 v[6:7], v[40:41], v[8:9] op_sel_hi:[1,0] neg_lo:[0,1] neg_hi:[0,1]
    v_fmac_f32 v12, v6, v6
    v_fmac_f32 v13, v7, v7
    v_pk_add_f32 v[6:7], v[42:43], v[8:9] op_sel_hi:[1,0] neg_lo:[0,1] neg_hi:[0,1]
    v_fmac_f32 v12, v6, v6
    v_fmac_f32 v13, v7, v7
    v_pk_add_f32 v[6:7], v[44:45], v[8:9] op_sel_hi:[1,0] neg_lo:[0,1] neg_hi:[0,1]
    v_fmac_f32 v12, v6, v6
    v_fmac_f32 v13, v7, v7
    v_pk_add_f32 v[6:7], v[46:47], v[8:9] op_sel_hi:[1,0] neg_lo:[0,1] neg_hi:[0,1]
    v_fmac_f32 v12, v6, v6
    v_fmac_f32 v13, v7, v7
    v_pk_add_f32 v[6:7], v[48:49], v[8:9] op_sel_hi:[1,0] neg_lo:[0,1] neg_hi:[0,1]
    v_fmac_f32 v12, v6, v6
    v_fmac_f32 v13, v7, v7
    v_pk_add_f32 v[6:7], v[50:51], v[8:9] op_sel_hi:[1,0] neg_lo:[0,1] neg_hi:[0,1]
    v_fmac_f32 v12, v6, v6
    v_fmac_f32 v13, v7, v7
    v_pk_add_f32 v[6:7], v[52:53], v[8:9] op_sel_hi:[1,0] neg_lo:[0,1] neg_hi:[0,1]
    v_fmac_f32 v12, v6, v6
    v_fmac_f32 v13, v7, v7
    v_pk_add_f32 v[6:7], v[54:55], v[8:9] op_sel_hi:[1,0] neg_lo:[0,1] neg_hi:[0,1]
    v_fmac_f32 v12, v6, v6
    v_fmac_f32 v13, v7, v7
    v_pk_add_f32 v[6:7], v[56:57], v[8:9] op_sel_hi:[1,0] neg_lo:[0,1] neg_hi:[0,1]
    v_fmac_f32 v12, v6, v6
    v_fmac_f32 v13, v7, v7
    v_pk_add_f32 v[6:7], v[58:59], v[8:9] op_sel_hi:[1,0] neg_lo:[0,1] neg_hi:[0,1]
    v_fmac_f32 v12, v6, v6
    v_fmac_f32 v13, v7, v7
    v_pk_add_f32 v[6:7], v[60:61], v[8:9] op_sel_hi:[1,0] neg_lo:[0,1] neg_hi:[0,1]
    v_fmac_f32 v12, v6, v6
    v_fmac_f32 v13, v7, v7
    v_pk_add_f32 v[6:7], v[62:63], v[8:9] op_sel_hi:[1,0] neg_lo:[0,1] neg_hi:[0,1]
    v_fmac_f32 v12, v6, v6
    v_fmac_f32 v13, v7, v7
    v_pk_add_f32 v[6:7], v[64:65], v[8:9] op_sel_hi:[1,0] neg_lo:[0,1] neg_hi:[0,1]
    v_fmac_f32 v12, v6, v6
    v_fmac_f32 v13, v7, v7
    v_pk_add_f32 v[6:7], v[66:67], v[8:9] op_sel_hi:[1,0] neg_lo:[0,1] neg_hi:[0,1]
    v_fmac_f32 v12, v6, v6
    v_fmac_f32 v13, v7, v7
    v_pk_add_f32 v[6:7], v[68:69], v[8:9] op_sel_hi:[1,0] neg_lo:[0,1] neg_hi:[0,1]
    v_fmac_f32 v12, v6, v6
    v_fmac_f32 v13, v7, v7
    v_pk_add_f32 v[6:7], v[70:71], v[8:9] op_sel_hi:[1,0] neg_lo:[0,1] neg_hi:[0,1]
    v_fmac_f32 v12, v6, v6
    v_fmac_f32 v13, v7, v7
    v_pk_add_f32 v[6:7], v[72:73], v[8:9] op_sel_hi:[1,0] neg_lo:[0,1] neg_hi:[0,1]
    v_fmac_f32 v12, v6, v6
    v_fmac_f32 v13, v7, v7
    v_pk_add_f32 v[6:7], v[74:75], v[8:9] op_sel_hi:[1,0] neg_lo:[0,1] neg_hi:[0,1]
    v_fmac_f32 v12, v6, v6
    v_fmac_f32 v13, v7, v7
    v_add_f32 v12, v12, v13
    s_nop 1
    v_add_f32_dpp v12, v12, v12 row_ror:8 row_mask:0xf bank_mask:0xf
    s_nop 1
    v_add_f32_dpp v12, v12, v12 row_ror:4 row_mask:0xf bank_mask:0xf
    s_nop 1
    v_add_f32_dpp v12, v12, v12 row_ror:2 row_mask:0xf bank_mask:0xf
    s_nop 1
    v_add_f32_dpp v12, v12, v12 row_ror:1 row_mask:0xf bank_mask:0xf
    v_mul_f32 v12, s20, v12
    v_cvt_pk_bf16_f32 v8, v8, v8
    v_lshlrev_b32 v8, 16, v8
    v_cvt_pk_bf16_f32 v12, v12, v12
    v_lshlrev_b32 v12, 16, v12
    v_add_f32 v12, s21, v12
    v_cvt_pk_bf16_f32 v12, v12, v12
    v_lshlrev_b32 v12, 16, v12
    v_sqrt_f32 v12, v12
    s_nop 0
    v_cvt_pk_bf16_f32 v12, v12, v12
    v_lshlrev_b32 v12, 16, v12
    v_rcp_f32 v14, v12
    v_pk_add_f32 v[40:41], v[40:41], v[8:9] op_sel_hi:[1,0] neg_lo:[0,1] neg_hi:[0,1]
    v_cvt_pk_bf16_f32 v6, v40, v41
    v_lshlrev_b32 v40, 16, v6
    v_and_b32 v41, 0xffff0000, v6
    v_pk_mul_f32 v[40:41], v[40:41], v[14:15] op_sel_hi:[1,0]
    v_cvt_pk_bf16_f32 v20, v40, v41
    v_pk_add_f32 v[42:43], v[42:43], v[8:9] op_sel_hi:[1,0] neg_lo:[0,1] neg_hi:[0,1]
    v_cvt_pk_bf16_f32 v6, v42, v43
    v_lshlrev_b32 v42, 16, v6
    v_and_b32 v43, 0xffff0000, v6
    v_pk_mul_f32 v[42:43], v[42:43], v[14:15] op_sel_hi:[1,0]
    v_cvt_pk_bf16_f32 v21, v42, v43
    v_pk_add_f32 v[44:45], v[44:45], v[8:9] op_sel_hi:[1,0] neg_lo:[0,1] neg_hi:[0,1]
    v_cvt_pk_bf16_f32 v6, v44, v45
    v_lshlrev_b32 v44, 16, v6
    v_and_b32 v45, 0xffff0000, v6
    v_pk_mul_f32 v[44:45], v[44:45], v[14:15] op_sel_hi:[1,0]
    v_cvt_pk_bf16_f32 v22, v44, v45
    v_pk_add_f32 v[46:47], v[46:47], v[8:9] op_sel_hi:[1,0] neg_lo:[0,1] neg_hi:[0,1]
    v_cvt_pk_bf16_f32 v6, v46, v47
    v_lshlrev_b32 v46, 16, v6
    v_and_b32 v47, 0xffff0000, v6
    v_pk_mul_f32 v[46:47], v[46:47], v[14:15] op_sel_hi:[1,0]
    v_cvt_pk_bf16_f32 v23, v46, v47
    v_pk_add_f32 v[48:49], v[48:49], v[8:9] op_sel_hi:[1,0] neg_lo:[0,1] neg_hi:[0,1]
    v_cvt_pk_bf16_f32 v6, v48, v49
    v_lshlrev_b32 v48, 16, v6
    v_and_b32 v49, 0xffff0000, v6
    v_pk_mul_f32 v[48:49], v[48:49], v[14:15] op_sel_hi:[1,0]
    v_cvt_pk_bf16_f32 v24, v48, v49
    v_pk_add_f32 v[50:51], v[50:51], v[8:9] op_sel_hi:[1,0] neg_lo:[0,1] neg_hi:[0,1]
    v_cvt_pk_bf16_f32 v6, v50, v51
    v_lshlrev_b32 v50, 16, v6
    v_and_b32 v51, 0xffff0000, v6
    v_pk_mul_f32 v[50:51], v[50:51], v[14:15] op_sel_hi:[1,0]
    v_cvt_pk_bf16_f32 v25, v50, v51
    v_pk_add_f32 v[52:53], v[52:53], v[8:9] op_sel_hi:[1,0] neg_lo:[0,1] neg_hi:[0,1]
    v_cvt_pk_bf16_f32 v6, v52, v53
    v_lshlrev_b32 v52, 16, v6
    v_and_b32 v53, 0xffff0000, v6
    v_pk_mul_f32 v[52:53], v[52:53], v[14:15] op_sel_hi:[1,0]
    v_cvt_pk_bf16_f32 v26, v52, v53
    v_pk_add_f32 v[54:55], v[54:55], v[8:9] op_sel_hi:[1,0] neg_lo:[0,1] neg_hi:[0,1]
    v_cvt_pk_bf16_f32 v6, v54, v55
    v_lshlrev_b32 v54, 16, v6
    v_and_b32 v55, 0xffff0000, v6
    v_pk_mul_f32 v[54:55], v[54:55], v[14:15] op_sel_hi:[1,0]
    v_cvt_pk_bf16_f32 v27, v54, v55
    v_pk_add_f32 v[56:57], v[56:57], v[8:9] op_sel_hi:[1,0] neg_lo:[0,1] neg_hi:[0,1]
    v_cvt_pk_bf16_f32 v6, v56, v57
    v_lshlrev_b32 v56, 16, v6
    v_and_b32 v57, 0xffff0000, v6
    v_pk_mul_f32 v[56:57], v[56:57], v[14:15] op_sel_hi:[1,0]
    v_cvt_pk_bf16_f32 v28, v56, v57
    v_pk_add_f32 v[58:59], v[58:59], v[8:9] op_sel_hi:[1,0] neg_lo:[0,1] neg_hi:[0,1]
    v_cvt_pk_bf16_f32 v6, v58, v59
    v_lshlrev_b32 v58, 16, v6
    v_and_b32 v59, 0xffff0000, v6
    v_pk_mul_f32 v[58:59], v[58:59], v[14:15] op_sel_hi:[1,0]
    v_cvt_pk_bf16_f32 v29, v58, v59
    v_pk_add_f32 v[60:61], v[60:61], v[8:9] op_sel_hi:[1,0] neg_lo:[0,1] neg_hi:[0,1]
    v_cvt_pk_bf16_f32 v6, v60, v61
    v_lshlrev_b32 v60, 16, v6
    v_and_b32 v61, 0xffff0000, v6
    v_pk_mul_f32 v[60:61], v[60:61], v[14:15] op_sel_hi:[1,0]
    v_cvt_pk_bf16_f32 v30, v60, v61
    v_pk_add_f32 v[62:63], v[62:63], v[8:9] op_sel_hi:[1,0] neg_lo:[0,1] neg_hi:[0,1]
    v_cvt_pk_bf16_f32 v6, v62, v63
    v_lshlrev_b32 v62, 16, v6
    v_and_b32 v63, 0xffff0000, v6
    v_pk_mul_f32 v[62:63], v[62:63], v[14:15] op_sel_hi:[1,0]
    v_cvt_pk_bf16_f32 v31, v62, v63
    v_pk_add_f32 v[64:65], v[64:65], v[8:9] op_sel_hi:[1,0] neg_lo:[0,1] neg_hi:[0,1]
    v_cvt_pk_bf16_f32 v6, v64, v65
    v_lshlrev_b32 v64, 16, v6
    v_and_b32 v65, 0xffff0000, v6
    v_pk_mul_f32 v[64:65], v[64:65], v[14:15] op_sel_hi:[1,0]
    v_cvt_pk_bf16_f32 v32, v64, v65
    v_pk_add_f32 v[66:67], v[66:67], v[8:9] op_sel_hi:[1,0] neg_lo:[0,1] neg_hi:[0,1]
    v_cvt_pk_bf16_f32 v6, v66, v67
    v_lshlrev_b32 v66, 16, v6
    v_and_b32 v67, 0xffff0000, v6
    v_pk_mul_f32 v[66:67], v[66:67], v[14:15] op_sel_hi:[1,0]
    v_cvt_pk_bf16_f32 v33, v66, v67
    v_pk_add_f32 v[68:69], v[68:69], v[8:9] op_sel_hi:[1,0] neg_lo:[0,1] neg_hi:[0,1]
    v_cvt_pk_bf16_f32 v6, v68, v69
    v_lshlrev_b32 v68, 16, v6
    v_and_b32 v69, 0xffff0000, v6
    v_pk_mul_f32 v[68:69], v[68:69], v[14:15] op_sel_hi:[1,0]
    v_cvt_pk_bf16_f32 v34, v68, v69
    v_pk_add_f32 v[70:71], v[70:71], v[8:9] op_sel_hi:[1,0] neg_lo:[0,1] neg_hi:[0,1]
    v_cvt_pk_bf16_f32 v6, v70, v71
    v_lshlrev_b32 v70, 16, v6
    v_and_b32 v71, 0xffff0000, v6
    v_pk_mul_f32 v[70:71], v[70:71], v[14:15] op_sel_hi:[1,0]
    v_cvt_pk_bf16_f32 v35, v70, v71
    v_pk_add_f32 v[72:73], v[72:73], v[8:9] op_sel_hi:[1,0] neg_lo:[0,1] neg_hi:[0,1]
    v_cvt_pk_bf16_f32 v6, v72, v73
    v_lshlrev_b32 v72, 16, v6
    v_and_b32 v73, 0xffff0000, v6
    v_pk_mul_f32 v[72:73], v[72:73], v[14:15] op_sel_hi:[1,0]
    v_cvt_pk_bf16_f32 v36, v72, v73
    v_pk_add_f32 v[74:75], v[74:75], v[8:9] op_sel_hi:[1,0] neg_lo:[0,1] neg_hi:[0,1]
    v_cvt_pk_bf16_f32 v6, v74, v75
    v_lshlrev_b32 v74, 16, v6
    v_and_b32 v75, 0xffff0000, v6
    v_pk_mul_f32 v[74:75], v[74:75], v[14:15] op_sel_hi:[1,0]
    v_cvt_pk_bf16_f32 v37, v74, v75
    v_cndmask_b32 v6, v20, v22, s[84:85]
    v_cndmask_b32 v7, v21, v23, s[84:85]
    s_nop 0
    v_mov_b32_dpp v8, v6 quad_perm:[2,3,0,1] row_mask:0xf bank_mask:0xf
    v_mov_b32_dpp v9, v7 quad_perm:[2,3,0,1] row_mask:0xf bank_mask:0xf
    v_cndmask_b32 v12, v8, v20, s[84:85]
    v_cndmask_b32 v13, v9, v21, s[84:85]
    v_cndmask_b32 v14, v22, v8, s[84:85]
    v_cndmask_b32 v15, v23, v9, s[84:85]
    s_add_u32 s22, s29, 104857600
    buffer_store_dwordx4 v[12:15], v18, s[8:11], s22 offen sc1
    v_cndmask_b32 v6, v24, v26, s[84:85]
    v_cndmask_b32 v7, v25, v27, s[84:85]
    s_nop 0
    v_mov_b32_dpp v8, v6 quad_perm:[2,3,0,1] row_mask:0xf bank_mask:0xf
    v_mov_b32_dpp v9, v7 quad_perm:[2,3,0,1] row_mask:0xf bank_mask:0xf
    v_cndmask_b32 v12, v8, v24, s[84:85]
    v_cndmask_b32 v13, v9, v25, s[84:85]
    v_cndmask_b32 v14, v26, v8, s[84:85]
    v_cndmask_b32 v15, v27, v9, s[84:85]
    s_add_u32 s22, s29, 104865792
    buffer_store_dwordx4 v[12:15], v18, s[8:11], s22 offen sc1
    v_cndmask_b32 v6, v28, v30, s[84:85]
    v_cndmask_b32 v7, v29, v31, s[84:85]
    s_nop 0
    v_mov_b32_dpp v8, v6 quad_perm:[2,3,0,1] row_mask:0xf bank_mask:0xf
    v_mov_b32_dpp v9, v7 quad_perm:[2,3,0,1] row_mask:0xf bank_mask:0xf
    v_cndmask_b32 v12, v8, v28, s[84:85]
    v_cndmask_b32 v13, v9, v29, s[84:85]
    v_cndmask_b32 v14, v30, v8, s[84:85]
    v_cndmask_b32 v15, v31, v9, s[84:85]
    s_add_u32 s22, s29, 104873984
    buffer_store_dwordx4 v[12:15], v18, s[8:11], s22 offen sc1
    v_cndmask_b32 v6, v32, v34, s[84:85]
    v_cndmask_b32 v7, v33, v35, s[84:85]
    s_nop 0
    v_mov_b32_dpp v8, v6 quad_perm:[2,3,0,1] row_mask:0xf bank_mask:0xf
    v_mov_b32_dpp v9, v7 quad_perm:[2,3,0,1] row_mask:0xf bank_mask:0xf
    v_cndmask_b32 v12, v8, v32, s[84:85]
    v_cndmask_b32 v13, v9, v33, s[84:85]
    v_cndmask_b32 v14, v34, v8, s[84:85]
    v_cndmask_b32 v15, v35, v9, s[84:85]
    s_add_u32 s22, s29, 104882176
    buffer_store_dwordx4 v[12:15], v18, s[8:11], s22 offen sc1
    v_cndmask_b32 v6, v36, v36, s[84:85]
    v_cndmask_b32 v7, v37, v37, s[84:85]
    s_nop 0
    v_mov_b32_dpp v8, v6 quad_perm:[2,3,0,1] row_mask:0xf bank_mask:0xf
    v_mov_b32_dpp v9, v7 quad_perm:[2,3,0,1] row_mask:0xf bank_mask:0xf
    v_cndmask_b32 v12, v8, v36, s[84:85]
    v_cndmask_b32 v13, v9, v37, s[84:85]
    v_cndmask_b32 v14, v36, v8, s[84:85]
    v_cndmask_b32 v15, v37, v9, s[84:85]
    s_add_u32 s22, s29, 104890368
    buffer_store_dwordx4 v[12:15], v19, s[8:11], s22 offen sc1
    v_lshlrev_b32 v40, 16, v20
    v_and_b32 v41, 0xffff0000, v20
    v_lshlrev_b32 v42, 16, v21
    v_and_b32 v43, 0xffff0000, v21
    v_lshlrev_b32 v44, 16, v22
    v_and_b32 v45, 0xffff0000, v22
    v_lshlrev_b32 v46, 16, v23
    v_and_b32 v47, 0xffff0000, v23
    v_lshlrev_b32 v48, 16, v24
    v_and_b32 v49, 0xffff0000, v24
    v_lshlrev_b32 v50, 16, v25
    v_and_b32 v51, 0xffff0000, v25
    v_lshlrev_b32 v52, 16, v26
    v_and_b32 v53, 0xffff0000, v26
    v_lshlrev_b32 v54, 16, v27
    v_and_b32 v55, 0xffff0000, v27
    v_lshlrev_b32 v56, 16, v28
    v_and_b32 v57, 0xffff0000, v28
    v_lshlrev_b32 v58, 16, v29
    v_and_b32 v59, 0xffff0000, v29
    v_lshlrev_b32 v60, 16, v30
    v_and_b32 v61, 0xffff0000, v30
    v_lshlrev_b32 v62, 16, v31
    v_and_b32 v63, 0xffff0000, v31
    v_lshlrev_b32 v64, 16, v32
    v_and_b32 v65, 0xffff0000, v32
    v_lshlrev_b32 v66, 16, v33
    v_and_b32 v67, 0xffff0000, v33
    v_lshlrev_b32 v68, 16, v34
    v_and_b32 v69, 0xffff0000, v34
    v_lshlrev_b32 v70, 16, v35
    v_and_b32 v71, 0xffff0000, v35
    v_lshlrev_b32 v72, 16, v36
    v_and_b32 v73, 0xffff0000, v36
    v_lshlrev_b32 v74, 16, v37
    v_and_b32 v75, 0xffff0000, v37
    v_pk_add_f32 v[6:7], v[40:41], v[42:43]
    v_pk_add_f32 v[6:7], v[6:7], v[44:45]
    v_pk_add_f32 v[6:7], v[6:7], v[46:47]
    v_pk_add_f32 v[6:7], v[6:7], v[48:49]
    v_pk_add_f32 v[6:7], v[6:7], v[50:51]
    v_pk_add_f32 v[6:7], v[6:7], v[52:53]
    v_pk_add_f32 v[6:7], v[6:7], v[54:55]
    v_pk_add_f32 v[6:7], v[6:7], v[56:57]
    v_pk_add_f32 v[6:7], v[6:7], v[58:59]
    v_pk_add_f32 v[6:7], v[6:7], v[60:61]
    v_pk_add_f32 v[6:7], v[6:7], v[62:63]
    v_pk_add_f32 v[6:7], v[6:7], v[64:65]
    v_pk_add_f32 v[6:7], v[6:7], v[66:67]
    v_pk_add_f32 v[6:7], v[6:7], v[68:69]
    v_pk_add_f32 v[6:7], v[6:7], v[70:71]
    v_pk_add_f32 v[6:7], v[6:7], v[72:73]
    v_pk_add_f32 v[6:7], v[6:7], v[74:75]
    v_add_f32 v5, v6, v7
    s_nop 1
    v_add_f32_dpp v5, v5, v5 row_ror:8 row_mask:0xf bank_mask:0xf
    s_nop 1
    v_add_f32_dpp v5, v5, v5 row_ror:4 row_mask:0xf bank_mask:0xf
    s_nop 1
    v_add_f32_dpp v5, v5, v5 row_ror:2 row_mask:0xf bank_mask:0xf
    s_nop 1
    v_add_f32_dpp v5, v5, v5 row_ror:1 row_mask:0xf bank_mask:0xf
    v_mul_f32 v8, s20, v5
    v_mov_b32 v12, 0
    v_mov_b32 v13, 0
    v_pk_add_f32 v[6:7], v[40:41], v[8:9] op_sel_hi:[1,0] neg_lo:[0,1] neg_hi:[0,1]
    v_fmac_f32 v12, v6, v6
    v_fmac_f32 v13, v7, v7
    v_pk_add_f32 v[6:7], v[42:43], v[8:9] op_sel_hi:[1,0] neg_lo:[0,1] neg_hi:[0,1]
    v_fmac_f32 v12, v6, v6
    v_fmac_f32 v13, v7, v7
    v_pk_add_f32 v[6:7], v[44:45], v[8:9] op_sel_hi:[1,0] neg_lo:[0,1] neg_hi:[0,1]
    v_fmac_f32 v12, v6, v6
    v_fmac_f32 v13, v7, v7
    v_pk_add_f32 v[6:7], v[46:47], v[8:9] op_sel_hi:[1,0] neg_lo:[0,1] neg_hi:[0,1]
    v_fmac_f32 v12, v6, v6
    v_fmac_f32 v13, v7, v7
    v_pk_add_f32 v[6:7], v[48:49], v[8:9] op_sel_hi:[1,0] neg_lo:[0,1] neg_hi:[0,1]
    v_fmac_f32 v12, v6, v6
    v_fmac_f32 v13, v7, v7
    v_pk_add_f32 v[6:7], v[50:51], v[8:9] op_sel_hi:[1,0] neg_lo:[0,1] neg_hi:[0,1]
    v_fmac_f32 v12, v6, v6
    v_fmac_f32 v13, v7, v7
    v_pk_add_f32 v[6:7], v[52:53], v[8:9] op_sel_hi:[1,0] neg_lo:[0,1] neg_hi:[0,1]
    v_fmac_f32 v12, v6, v6
    v_fmac_f32 v13, v7, v7
    v_pk_add_f32 v[6:7], v[54:55], v[8:9] op_sel_hi:[1,0] neg_lo:[0,1] neg_hi:[0,1]
    v_fmac_f32 v12, v6, v6
    v_fmac_f32 v13, v7, v7
    v_pk_add_f32 v[6:7], v[56:57], v[8:9] op_sel_hi:[1,0] neg_lo:[0,1] neg_hi:[0,1]
    v_fmac_f32 v12, v6, v6
    v_fmac_f32 v13, v7, v7
    v_pk_add_f32 v[6:7], v[58:59], v[8:9] op_sel_hi:[1,0] neg_lo:[0,1] neg_hi:[0,1]
    v_fmac_f32 v12, v6, v6
    v_fmac_f32 v13, v7, v7
    v_pk_add_f32 v[6:7], v[60:61], v[8:9] op_sel_hi:[1,0] neg_lo:[0,1] neg_hi:[0,1]
    v_fmac_f32 v12, v6, v6
    v_fmac_f32 v13, v7, v7
    v_pk_add_f32 v[6:7], v[62:63], v[8:9] op_sel_hi:[1,0] neg_lo:[0,1] neg_hi:[0,1]
    v_fmac_f32 v12, v6, v6
    v_fmac_f32 v13, v7, v7
    v_pk_add_f32 v[6:7], v[64:65], v[8:9] op_sel_hi:[1,0] neg_lo:[0,1] neg_hi:[0,1]
    v_fmac_f32 v12, v6, v6
    v_fmac_f32 v13, v7, v7
    v_pk_add_f32 v[6:7], v[66:67], v[8:9] op_sel_hi:[1,0] neg_lo:[0,1] neg_hi:[0,1]
    v_fmac_f32 v12, v6, v6
    v_fmac_f32 v13, v7, v7
    v_pk_add_f32 v[6:7], v[68:69], v[8:9] op_sel_hi:[1,0] neg_lo:[0,1] neg_hi:[0,1]
    v_fmac_f32 v12, v6, v6
    v_fmac_f32 v13, v7, v7
    v_pk_add_f32 v[6:7], v[70:71], v[8:9] op_sel_hi:[1,0] neg_lo:[0,1] neg_hi:[0,1]
    v_fmac_f32 v12, v6, v6
    v_fmac_f32 v13, v7, v7
    v_pk_add_f32 v[6:7], v[72:73], v[8:9] op_sel_hi:[1,0] neg_lo:[0,1] neg_hi:[0,1]
    v_fmac_f32 v12, v6, v6
    v_fmac_f32 v13, v7, v7
    v_pk_add_f32 v[6:7], v[74:75], v[8:9] op_sel_hi:[1,0] neg_lo:[0,1] neg_hi:[0,1]
    v_fmac_f32 v12, v6, v6
    v_fmac_f32 v13, v7, v7
    v_add_f32 v12, v12, v13
    s_nop 1
    v_add_f32_dpp v12, v12, v12 row_ror:8 row_mask:0xf bank_mask:0xf
    s_nop 1
    v_add_f32_dpp v12, v12, v12 row_ror:4 row_mask:0xf bank_mask:0xf
    s_nop 1
    v_add_f32_dpp v12, v12, v12 row_ror:2 row_mask:0xf bank_mask:0xf
    s_nop 1
    v_add_f32_dpp v12, v12, v12 row_ror:1 row_mask:0xf bank_mask:0xf
    v_mul_f32 v12, s20, v12
    v_cvt_pk_bf16_f32 v8, v8, v8
    v_lshlrev_b32 v8, 16, v8
    v_cvt_pk_bf16_f32 v12, v12, v12
    v_lshlrev_b32 v12, 16, v12
    v_add_f32 v12, s21, v12
    v_cvt_pk_bf16_f32 v12, v12, v12
    v_lshlrev_b32 v12, 16, v12
    v_sqrt_f32 v12, v12
    s_nop 0
    v_cvt_pk_bf16_f32 v12, v12, v12
    v_lshlrev_b32 v12, 16, v12
    v_rcp_f32 v14, v12
    v_pk_add_f32 v[40:41], v[40:41], v[8:9] op_sel_hi:[1,0] neg_lo:[0,1] neg_hi:[0,1]
    v_cvt_pk_bf16_f32 v6, v40, v41
    v_lshlrev_b32 v40, 16, v6
    v_and_b32 v41, 0xffff0000, v6
    v_pk_mul_f32 v[40:41], v[40:41], v[14:15] op_sel_hi:[1,0]
    v_cvt_pk_bf16_f32 v20, v40, v41
    v_pk_add_f32 v[42:43], v[42:43], v[8:9] op_sel_hi:[1,0] neg_lo:[0,1] neg_hi:[0,1]
    v_cvt_pk_bf16_f32 v6, v42, v43
    v_lshlrev_b32 v42, 16, v6
    v_and_b32 v43, 0xffff0000, v6
    v_pk_mul_f32 v[42:43], v[42:43], v[14:15] op_sel_hi:[1,0]
    v_cvt_pk_bf16_f32 v21, v42, v43
    v_pk_add_f32 v[44:45], v[44:45], v[8:9] op_sel_hi:[1,0] neg_lo:[0,1] neg_hi:[0,1]
    v_cvt_pk_bf16_f32 v6, v44, v45
    v_lshlrev_b32 v44, 16, v6
    v_and_b32 v45, 0xffff0000, v6
    v_pk_mul_f32 v[44:45], v[44:45], v[14:15] op_sel_hi:[1,0]
    v_cvt_pk_bf16_f32 v22, v44, v45
    v_pk_add_f32 v[46:47], v[46:47], v[8:9] op_sel_hi:[1,0] neg_lo:[0,1] neg_hi:[0,1]
    v_cvt_pk_bf16_f32 v6, v46, v47
    v_lshlrev_b32 v46, 16, v6
    v_and_b32 v47, 0xffff0000, v6
    v_pk_mul_f32 v[46:47], v[46:47], v[14:15] op_sel_hi:[1,0]
    v_cvt_pk_bf16_f32 v23, v46, v47
    v_pk_add_f32 v[48:49], v[48:49], v[8:9] op_sel_hi:[1,0] neg_lo:[0,1] neg_hi:[0,1]
    v_cvt_pk_bf16_f32 v6, v48, v49
    v_lshlrev_b32 v48, 16, v6
    v_and_b32 v49, 0xffff0000, v6
    v_pk_mul_f32 v[48:49], v[48:49], v[14:15] op_sel_hi:[1,0]
    v_cvt_pk_bf16_f32 v24, v48, v49
    v_pk_add_f32 v[50:51], v[50:51], v[8:9] op_sel_hi:[1,0] neg_lo:[0,1] neg_hi:[0,1]
    v_cvt_pk_bf16_f32 v6, v50, v51
    v_lshlrev_b32 v50, 16, v6
    v_and_b32 v51, 0xffff0000, v6
    v_pk_mul_f32 v[50:51], v[50:51], v[14:15] op_sel_hi:[1,0]
    v_cvt_pk_bf16_f32 v25, v50, v51
    v_pk_add_f32 v[52:53], v[52:53], v[8:9] op_sel_hi:[1,0] neg_lo:[0,1] neg_hi:[0,1]
    v_cvt_pk_bf16_f32 v6, v52, v53
    v_lshlrev_b32 v52, 16, v6
    v_and_b32 v53, 0xffff0000, v6
    v_pk_mul_f32 v[52:53], v[52:53], v[14:15] op_sel_hi:[1,0]
    v_cvt_pk_bf16_f32 v26, v52, v53
    v_pk_add_f32 v[54:55], v[54:55], v[8:9] op_sel_hi:[1,0] neg_lo:[0,1] neg_hi:[0,1]
    v_cvt_pk_bf16_f32 v6, v54, v55
    v_lshlrev_b32 v54, 16, v6
    v_and_b32 v55, 0xffff0000, v6
    v_pk_mul_f32 v[54:55], v[54:55], v[14:15] op_sel_hi:[1,0]
    v_cvt_pk_bf16_f32 v27, v54, v55
    v_pk_add_f32 v[56:57], v[56:57], v[8:9] op_sel_hi:[1,0] neg_lo:[0,1] neg_hi:[0,1]
    v_cvt_pk_bf16_f32 v6, v56, v57
    v_lshlrev_b32 v56, 16, v6
    v_and_b32 v57, 0xffff0000, v6
    v_pk_mul_f32 v[56:57], v[56:57], v[14:15] op_sel_hi:[1,0]
    v_cvt_pk_bf16_f32 v28, v56, v57
    v_pk_add_f32 v[58:59], v[58:59], v[8:9] op_sel_hi:[1,0] neg_lo:[0,1] neg_hi:[0,1]
    v_cvt_pk_bf16_f32 v6, v58, v59
    v_lshlrev_b32 v58, 16, v6
    v_and_b32 v59, 0xffff0000, v6
    v_pk_mul_f32 v[58:59], v[58:59], v[14:15] op_sel_hi:[1,0]
    v_cvt_pk_bf16_f32 v29, v58, v59
    v_pk_add_f32 v[60:61], v[60:61], v[8:9] op_sel_hi:[1,0] neg_lo:[0,1] neg_hi:[0,1]
    v_cvt_pk_bf16_f32 v6, v60, v61
    v_lshlrev_b32 v60, 16, v6
    v_and_b32 v61, 0xffff0000, v6
    v_pk_mul_f32 v[60:61], v[60:61], v[14:15] op_sel_hi:[1,0]
    v_cvt_pk_bf16_f32 v30, v60, v61
    v_pk_add_f32 v[62:63], v[62:63], v[8:9] op_sel_hi:[1,0] neg_lo:[0,1] neg_hi:[0,1]
    v_cvt_pk_bf16_f32 v6, v62, v63
    v_lshlrev_b32 v62, 16, v6
    v_and_b32 v63, 0xffff0000, v6
    v_pk_mul_f32 v[62:63], v[62:63], v[14:15] op_sel_hi:[1,0]
    v_cvt_pk_bf16_f32 v31, v62, v63
    v_pk_add_f32 v[64:65], v[64:65], v[8:9] op_sel_hi:[1,0] neg_lo:[0,1] neg_hi:[0,1]
    v_cvt_pk_bf16_f32 v6, v64, v65
    v_lshlrev_b32 v64, 16, v6
    v_and_b32 v65, 0xffff0000, v6
    v_pk_mul_f32 v[64:65], v[64:65], v[14:15] op_sel_hi:[1,0]
    v_cvt_pk_bf16_f32 v32, v64, v65
    v_pk_add_f32 v[66:67], v[66:67], v[8:9] op_sel_hi:[1,0] neg_lo:[0,1] neg_hi:[0,1]
    v_cvt_pk_bf16_f32 v6, v66, v67
    v_lshlrev_b32 v66, 16, v6
    v_and_b32 v67, 0xffff0000, v6
    v_pk_mul_f32 v[66:67], v[66:67], v[14:15] op_sel_hi:[1,0]
    v_cvt_pk_bf16_f32 v33, v66, v67
    v_pk_add_f32 v[68:69], v[68:69], v[8:9] op_sel_hi:[1,0] neg_lo:[0,1] neg_hi:[0,1]
    v_cvt_pk_bf16_f32 v6, v68, v69
    v_lshlrev_b32 v68, 16, v6
    v_and_b32 v69, 0xffff0000, v6
    v_pk_mul_f32 v[68:69], v[68:69], v[14:15] op_sel_hi:[1,0]
    v_cvt_pk_bf16_f32 v34, v68, v69
    v_pk_add_f32 v[70:71], v[70:71], v[8:9] op_sel_hi:[1,0] neg_lo:[0,1] neg_hi:[0,1]
    v_cvt_pk_bf16_f32 v6, v70, v71
    v_lshlrev_b32 v70, 16, v6
    v_and_b32 v71, 0xffff0000, v6
    v_pk_mul_f32 v[70:71], v[70:71], v[14:15] op_sel_hi:[1,0]
    v_cvt_pk_bf16_f32 v35, v70, v71
    v_pk_add_f32 v[72:73], v[72:73], v[8:9] op_sel_hi:[1,0] neg_lo:[0,1] neg_hi:[0,1]
    v_cvt_pk_bf16_f32 v6, v72, v73
    v_lshlrev_b32 v72, 16, v6
    v_and_b32 v73, 0xffff0000, v6
    v_pk_mul_f32 v[72:73], v[72:73], v[14:15] op_sel_hi:[1,0]
    v_cvt_pk_bf16_f32 v36, v72, v73
    v_pk_add_f32 v[74:75], v[74:75], v[8:9] op_sel_hi:[1,0] neg_lo:[0,1] neg_hi:[0,1]
    v_cvt_pk_bf16_f32 v6, v74, v75
    v_lshlrev_b32 v74, 16, v6
    v_and_b32 v75, 0xffff0000, v6
    v_pk_mul_f32 v[74:75], v[74:75], v[14:15] op_sel_hi:[1,0]
    v_cvt_pk_bf16_f32 v37, v74, v75
    v_cndmask_b32 v6, v20, v22, s[84:85]
    v_cndmask_b32 v7, v21, v23, s[84:85]
    s_nop 0
    v_mov_b32_dpp v8, v6 quad_perm:[2,3,0,1] row_mask:0xf bank_mask:0xf
    v_mov_b32_dpp v9, v7 quad_perm:[2,3,0,1] row_mask:0xf bank_mask:0xf
    v_cndmask_b32 v12, v8, v20, s[84:85]
    v_cndmask_b32 v13, v9, v21, s[84:85]
    v_cndmask_b32 v14, v22, v8, s[84:85]
    v_cndmask_b32 v15, v23, v9, s[84:85]
    s_add_u32 s22, s29, 109051904
    buffer_store_dwordx4 v[12:15], v18, s[8:11], s22 offen sc1
    v_cndmask_b32 v6, v24, v26, s[84:85]
    v_cndmask_b32 v7, v25, v27, s[84:85]
    s_nop 0
    v_mov_b32_dpp v8, v6 quad_perm:[2,3,0,1] row_mask:0xf bank_mask:0xf
    v_mov_b32_dpp v9, v7 quad_perm:[2,3,0,1] row_mask:0xf bank_mask:0xf
    v_cndmask_b32 v12, v8, v24, s[84:85]
    v_cndmask_b32 v13, v9, v25, s[84:85]
    v_cndmask_b32 v14, v26, v8, s[84:85]
    v_cndmask_b32 v15, v27, v9, s[84:85]
    s_add_u32 s22, s29, 109060096
    buffer_store_dwordx4 v[12:15], v18, s[8:11], s22 offen sc1
    v_cndmask_b32 v6, v28, v30, s[84:85]
    v_cndmask_b32 v7, v29, v31, s[84:85]
    s_nop 0
    v_mov_b32_dpp v8, v6 quad_perm:[2,3,0,1] row_mask:0xf bank_mask:0xf
    v_mov_b32_dpp v9, v7 quad_perm:[2,3,0,1] row_mask:0xf bank_mask:0xf
    v_cndmask_b32 v12, v8, v28, s[84:85]
    v_cndmask_b32 v13, v9, v29, s[84:85]
    v_cndmask_b32 v14, v30, v8, s[84:85]
    v_cndmask_b32 v15, v31, v9, s[84:85]
    s_add_u32 s22, s29, 109068288
    buffer_store_dwordx4 v[12:15], v18, s[8:11], s22 offen sc1
    v_cndmask_b32 v6, v32, v34, s[84:85]
    v_cndmask_b32 v7, v33, v35, s[84:85]
    s_nop 0
    v_mov_b32_dpp v8, v6 quad_perm:[2,3,0,1] row_mask:0xf bank_mask:0xf
    v_mov_b32_dpp v9, v7 quad_perm:[2,3,0,1] row_mask:0xf bank_mask:0xf
    v_cndmask_b32 v12, v8, v32, s[84:85]
    v_cndmask_b32 v13, v9, v33, s[84:85]
    v_cndmask_b32 v14, v34, v8, s[84:85]
    v_cndmask_b32 v15, v35, v9, s[84:85]
    s_add_u32 s22, s29, 109076480
    buffer_store_dwordx4 v[12:15], v18, s[8:11], s22 offen sc1
    v_cndmask_b32 v6, v36, v36, s[84:85]
    v_cndmask_b32 v7, v37, v37, s[84:85]
    s_nop 0
    v_mov_b32_dpp v8, v6 quad_perm:[2,3,0,1] row_mask:0xf bank_mask:0xf
    v_mov_b32_dpp v9, v7 quad_perm:[2,3,0,1] row_mask:0xf bank_mask:0xf
    v_cndmask_b32 v12, v8, v36, s[84:85]
    v_cndmask_b32 v13, v9, v37, s[84:85]
    v_cndmask_b32 v14, v36, v8, s[84:85]
    v_cndmask_b32 v15, v37, v9, s[84:85]
    s_add_u32 s22, s29, 109084672
    buffer_store_dwordx4 v[12:15], v19, s[8:11], s22 offen sc1
    s_cmp_eq_u32 s17, 0
    s_cbranch_scc0 L_wz_1_d
    s_mov_b32 s13, s3
L_wz_1:
    v_mov_b32 v2, 192
    global_load_dword v3, v2, s[42:43] sc1
    s_waitcnt vmcnt(0)
    v_readfirstlane_b32 s12, v3
    s_nop 0
    s_cmp_lg_u32 s12, 0
    s_cbranch_scc1 L_wz_1_d
    s_sleep 8
    s_sub_u32 s13, s13, 1
    s_cmp_lg_u32 s13, 0
    s_cbranch_scc1 L_wz_1
L_wz_1_d:
    s_barrier
    s_lshr_b32 s46, s46, 4
    s_lshl_b32 s46, s46, 7
    s_add_u32 s46, s46, 0x200080
    s_waitcnt vmcnt(0)
    s_barrier
    s_cmp_eq_u32 s17, 0
    s_cbranch_scc0 L_sig_2
    v_mov_b32 v2, 1
    s_mov_b64 exec, 1
    buffer_atomic_add v2, off, s[8:11], s46
    s_mov_b64 exec, -1
L_sig_2:
    s_branch L_roles
L_noln:
    s_cmp_eq_u32 s17, 0
    s_cbranch_scc0 L_wz_3_d
    s_mov_b32 s13, s3
L_wz_3:
    v_mov_b32 v2, 192
    global_load_dword v3, v2, s[42:43] sc1
    s_waitcnt vmcnt(0)
    v_readfirstlane_b32 s12, v3
    s_nop 0
    s_cmp_lg_u32 s12, 0
    s_cbranch_scc1 L_wz_3_d
    s_sleep 8
    s_sub_u32 s13, s13, 1
    s_cmp_lg_u32 s13, 0
    s_cbranch_scc1 L_wz_3
L_wz_3_d:
    s_barrier
L_roles:
    s_cmp_lt_u32 s7, 18
    s_cbranch_scc1 L_w6a
    s_sub_u32 s46, s7, 32
    s_cmp_lt_u32 s46, 18
    s_cbranch_scc1 L_w6b
    s_sub_u32 s46, s7, 192
    s_cmp_lt_u32 s46, 18
    s_cbranch_scc1 L_w6c
    s_sub_u32 s46, s7, 64
    s_cmp_lt_u32 s46, 16
    s_cbranch_scc1 L_w5
    s_branch L_gemm
L_gemm:
    s_mov_b32 s60, s7
    s_cmp_ge_u32 s7, 80
    s_cselect_b32 s46, 52, 0
    s_cmp_ge_u32 s7, 210
    s_cselect_b32 s46, 70, s46
    s_cmp_lt_u32 s7, 64
    s_cselect_b32 s47, 36, s46
    s_cmp_lt_u32 s7, 32
    s_cselect_b32 s47, 18, s47
    s_sub_u32 s60, s60, s47
    s_cmp_lt_u32 s60, 128
    s_cbranch_scc1 L_gm_first
    s_sub_u32 s60, s60, 64
    s_cmp_lt_u32 s60, 64
    s_cbranch_scc1 L_gm_decode
    s_mov_b32 s46, 0x204580
    s_cmp_eq_u32 s17, 0
    s_cbranch_scc0 L_wgw_4
    s_mov_b32 s20, s3
L_pg_5:
    s_mov_b64 exec, 1
    buffer_load_dword v2, off, s[8:11], s46 sc1
    s_waitcnt vmcnt(0)
    s_nop 0
    v_readfirstlane_b32 s19, v2
    s_mov_b64 exec, -1
    s_cmp_ge_u32 s19, 16
    s_cbranch_scc1 L_pg_5_d
    s_sleep 48
    s_sub_u32 s20, s20, 1
    s_cmp_lg_u32 s20, 0
    s_cbranch_scc1 L_pg_5
    s_mov_b32 s3, 1
L_pg_5_d:
L_wgw_4:
    s_barrier
    s_branch L_gm_decode
L_gm_next:
    s_waitcnt vmcnt(0) lgkmcnt(0)
    s_barrier
    s_cmp_eq_u32 s17, 0
    s_cbranch_scc0 L_gm_b
    s_mov_b32 s62, 0x200000
    v_mov_b32 v2, 1
    s_mov_b64 exec, 1
    buffer_atomic_add v2, off, s[8:11], s62 sc0
    s_mov_b64 exec, -1
    s_waitcnt vmcnt(0)
    v_mov_b32 v3, 0x10000
    s_mov_b64 exec, 1
    ds_write_b32 v3, v2
    s_waitcnt lgkmcnt(0)
    s_mov_b64 exec, -1
L_gm_b:
    s_barrier
    v_mov_b32 v3, 0x10000
    ds_read_b32 v2, v3
    s_waitcnt lgkmcnt(0)
    v_readfirstlane_b32 s60, v2
    s_nop 0
    s_add_u32 s60, s60, 90
L_gm_decode:
    s_mov_b32 s61, 1
    s_cmp_ge_u32 s60, 1248
    s_cbranch_scc1 L_end_drain
    s_cmp_lt_u32 s60, 264
    s_cbranch_scc0 L_gm_d2
    s_cmp_ge_u32 s60, 132
    s_cselect_b32 s43, 1, 0
    s_mul_i32 s46, s43, 132
    s_sub_u32 s44, s60, s46
    s_branch L_gm_kvqh
L_gm_d2:
    s_sub_u32 s46, s60, 264
    s_cmp_ge_u32 s46, 936
    s_cbranch_scc1 L_gm_d3
    s_mul_i32 s47, s46, 26887
    s_lshr_b32 s47, s47, 22
    s_mul_i32 s45, s47, 156
    s_sub_u32 s45, s46, s45
    s_cmp_lt_u32 s45, 24
    s_cbranch_scc0 L_gm_d2b
    s_mov_b32 s43, s47
    s_mov_b32 s44, s45
    s_branch L_gm_m2
L_gm_d2b:
    s_add_u32 s43, s47, 2
    s_sub_u32 s44, s45, 24
    s_branch L_gm_kvqh
L_gm_d3:
    s_sub_u32 s46, s46, 936
    s_cmp_ge_u32 s46, 24
    s_cselect_b32 s47, 1, 0
    s_add_u32 s43, s47, 6
    s_mul_i32 s47, s47, 24
    s_sub_u32 s44, s46, s47
L_gm_m2:
    s_lshl_b32 s63, s43, 7
    s_add_u32 s46, s63, 0x200c80
    s_cmp_eq_u32 s17, 0
    s_cbranch_scc0 L_wgw_6
    s_mov_b32 s20, s3
L_pg_7:
    s_mov_b64 exec, 1
    buffer_load_dword v2, off, s[8:11], s46 sc1
    s_waitcnt vmcnt(0)
    s_nop 0
    v_readfirstlane_b32 s19, v2
    s_mov_b64 exec, -1
    s_cmp_ge_u32 s19, 36
    s_cbranch_scc1 L_pg_7_d
    s_sleep 16
    s_sub_u32 s20, s20, 1
    s_cmp_lg_u32 s20, 0
    s_cbranch_scc1 L_pg_7
    s_mov_b32 s3, 1
L_pg_7_d:
L_wgw_6:
    s_barrier
    s_add_u32 s63, s63, 0x201080
    s_branch L_gm_run_m2
L_gm_kvqh:
    s_lshl_b32 s63, s43, 7
    s_add_u32 s46, s63, 0x200080
    s_cmp_eq_u32 s17, 0
    s_cbranch_scc0 L_wgw_8
    s_mov_b32 s20, s3
L_pg_9:
    s_mov_b64 exec, 1
    buffer_load_dword v2, off, s[8:11], s46 sc1
    s_waitcnt vmcnt(0)
    s_nop 0
    v_readfirstlane_b32 s19, v2
    s_mov_b64 exec, -1
    s_cmp_ge_u32 s19, 16
    s_cbranch_scc1 L_pg_9_d
    s_sleep 8
    s_sub_u32 s20, s20, 1
    s_cmp_lg_u32 s20, 0
    s_cbranch_scc1 L_pg_9
    s_mov_b32 s3, 1
L_pg_9_d:
L_wgw_8:
    s_barrier
    s_cmp_ge_u32 s44, 96
    s_cbranch_scc1 L_gm_h
    s_cmp_ge_u32 s44, 64
    s_mov_b32 s46, 0x200480
    s_cmp_ge_u32 s44, 64
    s_cselect_b32 s46, 0x200880, s46
    s_cselect_b32 s61, 1, 2
    s_add_u32 s63, s63, s46
    s_lshl_b32 s45, s43, 3
    s_lshl_b32 s19, s17, 1
    s_add_u32 s45, s45, s19
    v_lshlrev_b32 v78, 4, v0
    v_lshrrev_b32 v80, 5, v0
    v_bfe_u32 v81, v0, 2, 2
    v_lshl_add_u32 v82, v80, 2, v81
    s_movk_i32 s19, 256
    v_mul_lo_u32 v82, v82, s19
    v_bfe_u32 v83, v0, 4, 1
    v_and_b32 v84, 3, v0
    v_lshlrev_b32 v83, 5, v83
    v_lshl_add_u32 v83, v84, 3, v83
    v_add_u32 v82, v82, v83
    v_xor_b32 v84, 0, v81
    v_lshl_add_u32 v72, v84, 6, v82
    v_xor_b32 v84, 1, v81
    v_lshl_add_u32 v73, v84, 6, v82
    v_xor_b32 v84, 2, v81
    v_lshl_add_u32 v74, v84, 6, v82
    v_xor_b32 v84, 3, v81
    v_lshl_add_u32 v75, v84, 6, v82
    v_add_u32 v80, 0, v0
    s_mov_b32 s19, 0x10001
    v_mul_lo_u32 v81, v80, s19
    v_lshrrev_b32 v81, 20, v81
    s_movk_i32 s19, 16
    v_mul_lo_u32 v82, v81, s19
    v_sub_u32 v82, v80, v82
    v_and_b32 v83, 3, v81
    v_lshrrev_b32 v84, 2, v82
    v_xor_b32 v84, v84, v83
    v_and_b32 v82, 3, v82
    v_lshl_add_u32 v82, v84, 2, v82
    s_movk_i32 s19, 8192
    v_mul_lo_u32 v81, v81, s19
    v_lshl_add_u32 v76, v82, 4, v81
    v_add_u32 v80, 64, v0
    s_mov_b32 s19, 0x10001
    v_mul_lo_u32 v81, v80, s19
    v_lshrrev_b32 v81, 20, v81
    s_movk_i32 s19, 16
    v_mul_lo_u32 v82, v81, s19
    v_sub_u32 v82, v80, v82
    v_and_b32 v83, 3, v81
    v_lshrrev_b32 v84, 2, v82
    v_xor_b32 v84, v84, v83
    v_and_b32 v82, 3, v82
    v_lshl_add_u32 v82, v84, 2, v82
    s_movk_i32 s19, 8192
    v_mul_lo_u32 v81, v81, s19
    v_lshl_add_u32 v77, v82, 4, v81
    s_mul_i32 s31, s17, 2048
    s_lshr_b32 s46, s44, 5
    s_and_b32 s47, s44, 31
    s_mov_b32 s12, s48
    s_mov_b32 s13, s49
    s_cmp_eq_u32 s46, 1
    s_cselect_b32 s12, s50, s12
    s_cselect_b32 s13, s51, s13
    s_cmp_eq_u32 s46, 2
    s_cselect_b32 s12, s52, s12
    s_cselect_b32 s13, s53, s13
    s_mov_b32 s14, 0x480000
    s_mov_b32 s15, 0x20000
    s_lshl_b32 s25, s47, 8
    s_mul_i32 s19, s17, 65536
    s_add_u32 s25, s25, s19
    s_mul_i32 s24, s45, 36864
    s_add_u32 s24, s24, 0x6400000
    s_mov_b32 s30, 36864
    s_lshl_b32 s29, s45, 5
    s_add_u32 s29, s29, s47
    s_lshl_b32 s29, s29, 13
    s_lshl_b32 s19, s46, 24
    s_add_u32 s29, s29, s19
    s_add_u32 s29, s29, 0x1000000
    s_add_u32 s23, s24, s30
    s_mov_b32 s26, 0
    s_mov_b32 s27, 0
    s_barrier
    s_add_u32 m0, s26, s31
    s_nop 0
    buffer_load_dwordx4 v76, s[12:15], s25 offen lds
    s_add_u32 m0, m0, 1024
    s_nop 0
    buffer_load_dwordx4 v77, s[12:15], s25 offen lds
    s_add_u32 s25, s25, 262144
    s_add_u32 s26, s26, 8192
    s_cmp_eq_u32 s26, 32768
    s_cselect_b32 s26, 0, s26
    buffer_load_dwordx4 v[16:19], v78, s[8:11], s24 offen offset:0
    buffer_load_dwordx4 v[20:23], v78, s[8:11], s23 offen offset:0
    buffer_load_dwordx4 v[24:27], v78, s[8:11], s24 offen offset:1024
    buffer_load_dwordx4 v[28:31], v78, s[8:11], s23 offen offset:1024
    s_add_u32 s24, s24, 2048
    s_add_u32 s23, s23, 2048
    s_add_u32 m0, s26, s31
    s_nop 0
    buffer_load_dwordx4 v76, s[12:15], s25 offen lds
    s_add_u32 m0, m0, 1024
    s_nop 0
    buffer_load_dwordx4 v77, s[12:15], s25 offen lds
    s_add_u32 s25, s25, 262144
    s_add_u32 s26, s26, 8192
    s_cmp_eq_u32 s26, 32768
    s_cselect_b32 s26, 0, s26
    buffer_load_dwordx4 v[32:35], v78, s[8:11], s24 offen offset:0
    buffer_load_dwordx4 v[36:39], v78, s[8:11], s23 offen offset:0
    buffer_load_dwordx4 v[40:43], v78, s[8:11], s24 offen offset:1024
    buffer_load_dwordx4 v[44:47], v78, s[8:11], s23 offen offset:1024
    s_add_u32 s24, s24, 2048
    s_add_u32 s23, s23, 2048
    s_add_u32 m0, s26, s31
    s_nop 0
    buffer_load_dwordx4 v76, s[12:15], s25 offen lds
    s_add_u32 m0, m0, 1024
    s_nop 0
    buffer_load_dwordx4 v77, s[12:15], s25 offen lds
    s_add_u32 s25, s25, 262144
    s_add_u32 s26, s26, 8192
    s_cmp_eq_u32 s26, 32768
    s_cselect_b32 s26, 0, s26
    v_mov_b64 v[128:129], 0
    v_mov_b64 v[130:131], 0
    v_mov_b64 v[132:133], 0
    v_mov_b64 v[134:135], 0
    v_mov_b64 v[136:137], 0
    v_mov_b64 v[138:139], 0
    v_mov_b64 v[140:141], 0
    v_mov_b64 v[142:143], 0
    v_mov_b64 v[144:145], 0
    v_mov_b64 v[146:147], 0
    v_mov_b64 v[148:149], 0
    v_mov_b64 v[150:151], 0
    v_mov_b64 v[152:153], 0
    v_mov_b64 v[154:155], 0
    v_mov_b64 v[156:157], 0
    v_mov_b64 v[158:159], 0
    v_mov_b64 v[160:161], 0
    v_mov_b64 v[162:163], 0
    v_mov_b64 v[164:165], 0
    v_mov_b64 v[166:167], 0
    v_mov_b64 v[168:169], 0
    v_mov_b64 v[170:171], 0
    v_mov_b64 v[172:173], 0
    v_mov_b64 v[174:175], 0
    v_mov_b64 v[176:177], 0
    v_mov_b64 v[178:179], 0
    v_mov_b64 v[180:181], 0
    v_mov_b64 v[182:183], 0
    v_mov_b64 v[184:185], 0
    v_mov_b64 v[186:187], 0
    v_mov_b64 v[188:189], 0
    v_mov_b64 v[190:191], 0
    v_mov_b64 v[192:193], 0
    v_mov_b64 v[194:195], 0
    v_mov_b64 v[196:197], 0
    v_mov_b64 v[198:199], 0
    v_mov_b64 v[200:201], 0
    v_mov_b64 v[202:203], 0
    v_mov_b64 v[204:205], 0
    v_mov_b64 v[206:207], 0
    v_mov_b64 v[208:209], 0
    v_mov_b64 v[210:211], 0
    v_mov_b64 v[212:213], 0
    v_mov_b64 v[214:215], 0
    v_mov_b64 v[216:217], 0
    v_mov_b64 v[218:219], 0
    v_mov_b64 v[220:221], 0
    v_mov_b64 v[222:223], 0
    v_mov_b64 v[224:225], 0
    v_mov_b64 v[226:227], 0
    v_mov_b64 v[228:229], 0
    v_mov_b64 v[230:231], 0
    v_mov_b64 v[232:233], 0
    v_mov_b64 v[234:235], 0
    v_mov_b64 v[236:237], 0
    v_mov_b64 v[238:239], 0
    v_mov_b64 v[240:241], 0
    v_mov_b64 v[242:243], 0
    v_mov_b64 v[244:245], 0
    v_mov_b64 v[246:247], 0
    v_mov_b64 v[248:249], 0
    v_mov_b64 v[250:251], 0
    v_mov_b64 v[252:253], 0
    v_mov_b64 v[254:255], 0
    s_waitcnt vmcnt(12)
    s_barrier
    v_add_u32 v64, s27, v72
    v_add_u32 v65, s27, v73
    v_add_u32 v66, s27, v74
    v_add_u32 v67, s27, v75
    s_add_u32 s27, s27, 8192
    s_cmp_eq_u32 s27, 32768
    s_cselect_b32 s27, 0, s27
    ds_read_b64_tr_b16 v[48:49], v64 offset:0
    ds_read_b64_tr_b16 v[50:51], v64 offset:2048
    ds_read_b64_tr_b16 v[52:53], v65 offset:0
    ds_read_b64_tr_b16 v[54:55], v65 offset:2048
    ds_read_b64_tr_b16 v[56:57], v66 offset:0
    ds_read_b64_tr_b16 v[58:59], v66 offset:2048
    s_mov_b32 s28, 9
    s_cmp_eq_u32 s46, 1
    s_cbranch_scc1 L_gk_v
L_gk_kq_loop:
    s_cmp_eq_u32 s28, 1
    s_cselect_b32 s24, 0x40000000, s24
    s_cselect_b32 s23, 0x40000000, s23
    ds_read_b64_tr_b16 v[60:61], v67 offset:0
    ds_read_b64_tr_b16 v[62:63], v67 offset:2048
    s_waitcnt vmcnt(11) lgkmcnt(6)
    v_mfma_f32_32x32x16_bf16 v[128:143], v[48:51], v[16:19], v[128:143]
    s_waitcnt vmcnt(10)
    v_mfma_f32_32x32x16_bf16 v[192:207], v[48:51], v[20:23], v[192:207]
    ds_read_b64_tr_b16 v[48:49], v64 offset:4096
    ds_read_b64_tr_b16 v[50:51], v64 offset:6144
    s_waitcnt lgkmcnt(6)
    v_mfma_f32_32x32x16_bf16 v[144:159], v[52:55], v[16:19], v[144:159]
    v_mfma_f32_32x32x16_bf16 v[208:223], v[52:55], v[20:23], v[208:223]
    ds_read_b64_tr_b16 v[52:53], v65 offset:4096
    ds_read_b64_tr_b16 v[54:55], v65 offset:6144
    s_waitcnt lgkmcnt(6)
    v_mfma_f32_32x32x16_bf16 v[160:175], v[56:59], v[16:19], v[160:175]
    v_mfma_f32_32x32x16_bf16 v[224:239], v[56:59], v[20:23], v[224:239]
    ds_read_b64_tr_b16 v[56:57], v66 offset:4096
    ds_read_b64_tr_b16 v[58:59], v66 offset:6144
    s_waitcnt lgkmcnt(6)
    v_mfma_f32_32x32x16_bf16 v[176:191], v[60:63], v[16:19], v[176:191]
    v_mfma_f32_32x32x16_bf16 v[240:255], v[60:63], v[20:23], v[240:255]
    buffer_load_dwordx4 v[16:19], v78, s[8:11], s24 offen offset:0
    buffer_load_dwordx4 v[20:23], v78, s[8:11], s23 offen offset:0
    s_waitcnt vmcnt(8)
    s_barrier
    v_add_u32 v68, s27, v72
    v_add_u32 v69, s27, v73
    v_add_u32 v70, s27, v74
    v_add_u32 v71, s27, v75
    s_add_u32 s27, s27, 8192
    s_cmp_eq_u32 s27, 32768
    s_cselect_b32 s27, 0, s27
    s_add_u32 m0, s26, s31
    s_nop 0
    buffer_load_dwordx4 v76, s[12:15], s25 offen lds
    s_add_u32 m0, m0, 1024
    s_nop 0
    buffer_load_dwordx4 v77, s[12:15], s25 offen lds
    s_add_u32 s25, s25, 262144
    s_add_u32 s26, s26, 8192
    s_cmp_eq_u32 s26, 32768
    s_cselect_b32 s26, 0, s26
    ds_read_b64_tr_b16 v[60:61], v67 offset:4096
    ds_read_b64_tr_b16 v[62:63], v67 offset:6144
    s_waitcnt lgkmcnt(6)
    v_mfma_f32_32x32x16_bf16 v[128:143], v[48:51], v[24:27], v[128:143]
    v_mfma_f32_32x32x16_bf16 v[192:207], v[48:51], v[28:31], v[192:207]
    ds_read_b64_tr_b16 v[48:49], v68 offset:0
    ds_read_b64_tr_b16 v[50:51], v68 offset:2048
    s_waitcnt lgkmcnt(6)
    v_mfma_f32_32x32x16_bf16 v[144:159], v[52:55], v[24:27], v[144:159]
    v_mfma_f32_32x32x16_bf16 v[208:223], v[52:55], v[28:31], v[208:223]
    ds_read_b64_tr_b16 v[52:53], v69 offset:0
    ds_read_b64_tr_b16 v[54:55], v69 offset:2048
    s_waitcnt lgkmcnt(6)
    v_mfma_f32_32x32x16_bf16 v[160:175], v[56:59], v[24:27], v[160:175]
    v_mfma_f32_32x32x16_bf16 v[224:239], v[56:59], v[28:31], v[224:239]
    ds_read_b64_tr_b16 v[56:57], v70 offset:0
    ds_read_b64_tr_b16 v[58:59], v70 offset:2048
    s_waitcnt lgkmcnt(6)
    v_mfma_f32_32x32x16_bf16 v[176:191], v[60:63], v[24:27], v[176:191]
    v_mfma_f32_32x32x16_bf16 v[240:255], v[60:63], v[28:31], v[240:255]
    buffer_load_dwordx4 v[24:27], v78, s[8:11], s24 offen offset:1024
    buffer_load_dwordx4 v[28:31], v78, s[8:11], s23 offen offset:1024
    s_add_u32 s24, s24, 2048
    s_add_u32 s23, s23, 2048
    ds_read_b64_tr_b16 v[60:61], v71 offset:0
    ds_read_b64_tr_b16 v[62:63], v71 offset:2048
    s_waitcnt vmcnt(11) lgkmcnt(6)
    v_mfma_f32_32x32x16_bf16 v[128:143], v[48:51], v[32:35], v[128:143]
    s_waitcnt vmcnt(10)
    v_mfma_f32_32x32x16_bf16 v[192:207], v[48:51], v[36:39], v[192:207]
    ds_read_b64_tr_b16 v[48:49], v68 offset:4096
    ds_read_b64_tr_b16 v[50:51], v68 offset:6144
    s_waitcnt lgkmcnt(6)
    v_mfma_f32_32x32x16_bf16 v[144:159], v[52:55], v[32:35], v[144:159]
    v_mfma_f32_32x32x16_bf16 v[208:223], v[52:55], v[36:39], v[208:223]
    ds_read_b64_tr_b16 v[52:53], v69 offset:4096
    ds_read_b64_tr_b16 v[54:55], v69 offset:6144
    s_waitcnt lgkmcnt(6)
    v_mfma_f32_32x32x16_bf16 v[160:175], v[56:59], v[32:35], v[160:175]
    v_mfma_f32_32x32x16_bf16 v[224:239], v[56:59], v[36:39], v[224:239]
    ds_read_b64_tr_b16 v[56:57], v70 offset:4096
    ds_read_b64_tr_b16 v[58:59], v70 offset:6144
    s_waitcnt lgkmcnt(6)
    v_mfma_f32_32x32x16_bf16 v[176:191], v[60:63], v[32:35], v[176:191]
    v_mfma_f32_32x32x16_bf16 v[240:255], v[60:63], v[36:39], v[240:255]
    buffer_load_dwordx4 v[32:35], v78, s[8:11], s24 offen offset:0
    buffer_load_dwordx4 v[36:39], v78, s[8:11], s23 offen offset:0
    s_waitcnt vmcnt(8)
    s_barrier
    v_add_u32 v64, s27, v72
    v_add_u32 v65, s27, v73
    v_add_u32 v66, s27, v74
    v_add_u32 v67, s27, v75
    s_add_u32 s27, s27, 8192
    s_cmp_eq_u32 s27, 32768
    s_cselect_b32 s27, 0, s27
    s_add_u32 m0, s26, s31
    s_nop 0
    buffer_load_dwordx4 v76, s[12:15], s25 offen lds
    s_add_u32 m0, m0, 1024
    s_nop 0
    buffer_load_dwordx4 v77, s[12:15], s25 offen lds
    s_add_u32 s25, s25, 262144
    s_add_u32 s26, s26, 8192
    s_cmp_eq_u32 s26, 32768
    s_cselect_b32 s26, 0, s26
    ds_read_b64_tr_b16 v[60:61], v71 offset:4096
    ds_read_b64_tr_b16 v[62:63], v71 offset:6144
    s_waitcnt lgkmcnt(6)
    v_mfma_f32_32x32x16_bf16 v[128:143], v[48:51], v[40:43], v[128:143]
    v_mfma_f32_32x32x16_bf16 v[192:207], v[48:51], v[44:47], v[192:207]
    ds_read_b64_tr_b16 v[48:49], v64 offset:0
    ds_read_b64_tr_b16 v[50:51], v64 offset:2048
    s_waitcnt lgkmcnt(6)
    v_mfma_f32_32x32x16_bf16 v[144:159], v[52:55], v[40:43], v[144:159]
    v_mfma_f32_32x32x16_bf16 v[208:223], v[52:55], v[44:47], v[208:223]
    ds_read_b64_tr_b16 v[52:53], v65 offset:0
    ds_read_b64_tr_b16 v[54:55], v65 offset:2048
    s_waitcnt lgkmcnt(6)
    v_mfma_f32_32x32x16_bf16 v[160:175], v[56:59], v[40:43], v[160:175]
    v_mfma_f32_32x32x16_bf16 v[224:239], v[56:59], v[44:47], v[224:239]
    ds_read_b64_tr_b16 v[56:57], v66 offset:0
    ds_read_b64_tr_b16 v[58:59], v66 offset:2048
    s_waitcnt lgkmcnt(6)
    v_mfma_f32_32x32x16_bf16 v[176:191], v[60:63], v[40:43], v[176:191]
    v_mfma_f32_32x32x16_bf16 v[240:255], v[60:63], v[44:47], v[240:255]
    buffer_load_dwordx4 v[40:43], v78, s[8:11], s24 offen offset:1024
    buffer_load_dwordx4 v[44:47], v78, s[8:11], s23 offen offset:1024
    s_add_u32 s24, s24, 2048
    s_add_u32 s23, s23, 2048
    s_sub_u32 s28, s28, 1
    s_cmp_lg_u32 s28, 0
    s_cbranch_scc1 L_gk_kq_loop
    v_cvt_pk_bf16_f32 v80, v128, v129
    v_cvt_pk_bf16_f32 v81, v130, v131
    v_cvt_pk_bf16_f32 v82, v132, v133
    v_cvt_pk_bf16_f32 v83, v134, v135
    s_add_u32 s19, s29, 0
    buffer_store_dwordx4 v[80:83], v78, s[8:11], s19 offen offset:0 sc1
    v_cvt_pk_bf16_f32 v84, v136, v137
    v_cvt_pk_bf16_f32 v85, v138, v139
    v_cvt_pk_bf16_f32 v86, v140, v141
    v_cvt_pk_bf16_f32 v87, v142, v143
    s_add_u32 s19, s29, 0
    buffer_store_dwordx4 v[84:87], v78, s[8:11], s19 offen offset:1024 sc1
    v_cvt_pk_bf16_f32 v88, v144, v145
    v_cvt_pk_bf16_f32 v89, v146, v147
    v_cvt_pk_bf16_f32 v90, v148, v149
    v_cvt_pk_bf16_f32 v91, v150, v151
    s_add_u32 s19, s29, 0
    buffer_store_dwordx4 v[88:91], v78, s[8:11], s19 offen offset:2048 sc1
    v_cvt_pk_bf16_f32 v92, v152, v153
    v_cvt_pk_bf16_f32 v93, v154, v155
    v_cvt_pk_bf16_f32 v94, v156, v157
    v_cvt_pk_bf16_f32 v95, v158, v159
    s_add_u32 s19, s29, 0
    buffer_store_dwordx4 v[92:95], v78, s[8:11], s19 offen offset:3072 sc1
    v_cvt_pk_bf16_f32 v80, v160, v161
    v_cvt_pk_bf16_f32 v81, v162, v163
    v_cvt_pk_bf16_f32 v82, v164, v165
    v_cvt_pk_bf16_f32 v83, v166, v167
    s_add_u32 s19, s29, 4096
    buffer_store_dwordx4 v[80:83], v78, s[8:11], s19 offen offset:0 sc1
    v_cvt_pk_bf16_f32 v84, v168, v169
    v_cvt_pk_bf16_f32 v85, v170, v171
    v_cvt_pk_bf16_f32 v86, v172, v173
    v_cvt_pk_bf16_f32 v87, v174, v175
    s_add_u32 s19, s29, 4096
    buffer_store_dwordx4 v[84:87], v78, s[8:11], s19 offen offset:1024 sc1
    v_cvt_pk_bf16_f32 v88, v176, v177
    v_cvt_pk_bf16_f32 v89, v178, v179
    v_cvt_pk_bf16_f32 v90, v180, v181
    v_cvt_pk_bf16_f32 v91, v182, v183
    s_add_u32 s19, s29, 4096
    buffer_store_dwordx4 v[88:91], v78, s[8:11], s19 offen offset:2048 sc1
    v_cvt_pk_bf16_f32 v92, v184, v185
    v_cvt_pk_bf16_f32 v93, v186, v187
    v_cvt_pk_bf16_f32 v94, v188, v189
    v_cvt_pk_bf16_f32 v95, v190, v191
    s_add_u32 s19, s29, 4096
    buffer_store_dwordx4 v[92:95], v78, s[8:11], s19 offen offset:3072 sc1
    v_cvt_pk_bf16_f32 v80, v192, v193
    v_cvt_pk_bf16_f32 v81, v194, v195
    v_cvt_pk_bf16_f32 v82, v196, v197
    v_cvt_pk_bf16_f32 v83, v198, v199
    s_add_u32 s19, s29, 262144
    buffer_store_dwordx4 v[80:83], v78, s[8:11], s19 offen offset:0 sc1
    v_cvt_pk_bf16_f32 v84, v200, v201
    v_cvt_pk_bf16_f32 v85, v202, v203
    v_cvt_pk_bf16_f32 v86, v204, v205
    v_cvt_pk_bf16_f32 v87, v206, v207
    s_add_u32 s19, s29, 262144
    buffer_store_dwordx4 v[84:87], v78, s[8:11], s19 offen offset:1024 sc1
    v_cvt_pk_bf16_f32 v88, v208, v209
    v_cvt_pk_bf16_f32 v89, v210, v211
    v_cvt_pk_bf16_f32 v90, v212, v213
    v_cvt_pk_bf16_f32 v91, v214, v215
    s_add_u32 s19, s29, 262144
    buffer_store_dwordx4 v[88:91], v78, s[8:11], s19 offen offset:2048 sc1
    v_cvt_pk_bf16_f32 v92, v216, v217
    v_cvt_pk_bf16_f32 v93, v218, v219
    v_cvt_pk_bf16_f32 v94, v220, v221
    v_cvt_pk_bf16_f32 v95, v222, v223
    s_add_u32 s19, s29, 262144
    buffer_store_dwordx4 v[92:95], v78, s[8:11], s19 offen offset:3072 sc1
    v_cvt_pk_bf16_f32 v80, v224, v225
    v_cvt_pk_bf16_f32 v81, v226, v227
    v_cvt_pk_bf16_f32 v82, v228, v229
    v_cvt_pk_bf16_f32 v83, v230, v231
    s_add_u32 s19, s29, 266240
    buffer_store_dwordx4 v[80:83], v78, s[8:11], s19 offen offset:0 sc1
    v_cvt_pk_bf16_f32 v84, v232, v233
    v_cvt_pk_bf16_f32 v85, v234, v235
    v_cvt_pk_bf16_f32 v86, v236, v237
    v_cvt_pk_bf16_f32 v87, v238, v239
    s_add_u32 s19, s29, 266240
    buffer_store_dwordx4 v[84:87], v78, s[8:11], s19 offen offset:1024 sc1
    v_cvt_pk_bf16_f32 v88, v240, v241
    v_cvt_pk_bf16_f32 v89, v242, v243
    v_cvt_pk_bf16_f32 v90, v244, v245
    v_cvt_pk_bf16_f32 v91, v246, v247
    s_add_u32 s19, s29, 266240
    buffer_store_dwordx4 v[88:91], v78, s[8:11], s19 offen offset:2048 sc1
    v_cvt_pk_bf16_f32 v92, v248, v249
    v_cvt_pk_bf16_f32 v93, v250, v251
    v_cvt_pk_bf16_f32 v94, v252, v253
    v_cvt_pk_bf16_f32 v95, v254, v255
    s_add_u32 s19, s29, 266240
    buffer_store_dwordx4 v[92:95], v78, s[8:11], s19 offen offset:3072 sc1
    s_branch L_gm_sig
L_gk_v:
L_gk_v_loop:
    s_cmp_eq_u32 s28, 1
    s_cselect_b32 s24, 0x40000000, s24
    s_cselect_b32 s23, 0x40000000, s23
    ds_read_b64_tr_b16 v[60:61], v67 offset:0
    ds_read_b64_tr_b16 v[62:63], v67 offset:2048
    s_waitcnt vmcnt(11) lgkmcnt(6)
    v_mfma_f32_32x32x16_bf16 v[128:143], v[16:19], v[48:51], v[128:143]
    s_waitcnt vmcnt(10)
    v_mfma_f32_32x32x16_bf16 v[192:207], v[20:23], v[48:51], v[192:207]
    ds_read_b64_tr_b16 v[48:49], v64 offset:4096
    ds_read_b64_tr_b16 v[50:51], v64 offset:6144
    s_waitcnt lgkmcnt(6)
    v_mfma_f32_32x32x16_bf16 v[144:159], v[16:19], v[52:55], v[144:159]
    v_mfma_f32_32x32x16_bf16 v[208:223], v[20:23], v[52:55], v[208:223]
    ds_read_b64_tr_b16 v[52:53], v65 offset:4096
    ds_read_b64_tr_b16 v[54:55], v65 offset:6144
    s_waitcnt lgkmcnt(6)
    v_mfma_f32_32x32x16_bf16 v[160:175], v[16:19], v[56:59], v[160:175]
    v_mfma_f32_32x32x16_bf16 v[224:239], v[20:23], v[56:59], v[224:239]
    ds_read_b64_tr_b16 v[56:57], v66 offset:4096
    ds_read_b64_tr_b16 v[58:59], v66 offset:6144
    s_waitcnt lgkmcnt(6)
    v_mfma_f32_32x32x16_bf16 v[176:191], v[16:19], v[60:63], v[176:191]
    v_mfma_f32_32x32x16_bf16 v[240:255], v[20:23], v[60:63], v[240:255]
    buffer_load_dwordx4 v[16:19], v78, s[8:11], s24 offen offset:0
    buffer_load_dwordx4 v[20:23], v78, s[8:11], s23 offen offset:0
    s_waitcnt vmcnt(8)
    s_barrier
    v_add_u32 v68, s27, v72
    v_add_u32 v69, s27, v73
    v_add_u32 v70, s27, v74
    v_add_u32 v71, s27, v75
    s_add_u32 s27, s27, 8192
    s_cmp_eq_u32 s27, 32768
    s_cselect_b32 s27, 0, s27
    s_add_u32 m0, s26, s31
    s_nop 0
    buffer_load_dwordx4 v76, s[12:15], s25 offen lds
    s_add_u32 m0, m0, 1024
    s_nop 0
    buffer_load_dwordx4 v77, s[12:15], s25 offen lds
    s_add_u32 s25, s25, 262144
    s_add_u32 s26, s26, 8192
    s_cmp_eq_u32 s26, 32768
    s_cselect_b32 s26, 0, s26
    ds_read_b64_tr_b16 v[60:61], v67 offset:4096
    ds_read_b64_tr_b16 v[62:63], v67 offset:6144
    s_waitcnt lgkmcnt(6)
    v_mfma_f32_32x32x16_bf16 v[128:143], v[24:27], v[48:51], v[128:143]
    v_mfma_f32_32x32x16_bf16 v[192:207], v[28:31], v[48:51], v[192:207]
    ds_read_b64_tr_b16 v[48:49], v68 offset:0
    ds_read_b64_tr_b16 v[50:51], v68 offset:2048
    s_waitcnt lgkmcnt(6)
    v_mfma_f32_32x32x16_bf16 v[144:159], v[24:27], v[52:55], v[144:159]
    v_mfma_f32_32x32x16_bf16 v[208:223], v[28:31], v[52:55], v[208:223]
    ds_read_b64_tr_b16 v[52:53], v69 offset:0
    ds_read_b64_tr_b16 v[54:55], v69 offset:2048
    s_waitcnt lgkmcnt(6)
    v_mfma_f32_32x32x16_bf16 v[160:175], v[24:27], v[56:59], v[160:175]
    v_mfma_f32_32x32x16_bf16 v[224:239], v[28:31], v[56:59], v[224:239]
    ds_read_b64_tr_b16 v[56:57], v70 offset:0
    ds_read_b64_tr_b16 v[58:59], v70 offset:2048
    s_waitcnt lgkmcnt(6)
    v_mfma_f32_32x32x16_bf16 v[176:191], v[24:27], v[60:63], v[176:191]
    v_mfma_f32_32x32x16_bf16 v[240:255], v[28:31], v[60:63], v[240:255]
    buffer_load_dwordx4 v[24:27], v78, s[8:11], s24 offen offset:1024
    buffer_load_dwordx4 v[28:31], v78, s[8:11], s23 offen offset:1024
    s_add_u32 s24, s24, 2048
    s_add_u32 s23, s23, 2048
    ds_read_b64_tr_b16 v[60:61], v71 offset:0
    ds_read_b64_tr_b16 v[62:63], v71 offset:2048
    s_waitcnt vmcnt(11) lgkmcnt(6)
    v_mfma_f32_32x32x16_bf16 v[128:143], v[32:35], v[48:51], v[128:143]
    s_waitcnt vmcnt(10)
    v_mfma_f32_32x32x16_bf16 v[192:207], v[36:39], v[48:51], v[192:207]
    ds_read_b64_tr_b16 v[48:49], v68 offset:4096
    ds_read_b64_tr_b16 v[50:51], v68 offset:6144
    s_waitcnt lgkmcnt(6)
    v_mfma_f32_32x32x16_bf16 v[144:159], v[32:35], v[52:55], v[144:159]
    v_mfma_f32_32x32x16_bf16 v[208:223], v[36:39], v[52:55], v[208:223]
    ds_read_b64_tr_b16 v[52:53], v69 offset:4096
    ds_read_b64_tr_b16 v[54:55], v69 offset:6144
    s_waitcnt lgkmcnt(6)
    v_mfma_f32_32x32x16_bf16 v[160:175], v[32:35], v[56:59], v[160:175]
    v_mfma_f32_32x32x16_bf16 v[224:239], v[36:39], v[56:59], v[224:239]
    ds_read_b64_tr_b16 v[56:57], v70 offset:4096
    ds_read_b64_tr_b16 v[58:59], v70 offset:6144
    s_waitcnt lgkmcnt(6)
    v_mfma_f32_32x32x16_bf16 v[176:191], v[32:35], v[60:63], v[176:191]
    v_mfma_f32_32x32x16_bf16 v[240:255], v[36:39], v[60:63], v[240:255]
    buffer_load_dwordx4 v[32:35], v78, s[8:11], s24 offen offset:0
    buffer_load_dwordx4 v[36:39], v78, s[8:11], s23 offen offset:0
    s_waitcnt vmcnt(8)
    s_barrier
    v_add_u32 v64, s27, v72
    v_add_u32 v65, s27, v73
    v_add_u32 v66, s27, v74
    v_add_u32 v67, s27, v75
    s_add_u32 s27, s27, 8192
    s_cmp_eq_u32 s27, 32768
    s_cselect_b32 s27, 0, s27
    s_add_u32 m0, s26, s31
    s_nop 0
    buffer_load_dwordx4 v76, s[12:15], s25 offen lds
    s_add_u32 m0, m0, 1024
    s_nop 0
    buffer_load_dwordx4 v77, s[12:15], s25 offen lds
    s_add_u32 s25, s25, 262144
    s_add_u32 s26, s26, 8192
    s_cmp_eq_u32 s26, 32768
    s_cselect_b32 s26, 0, s26
    ds_read_b64_tr_b16 v[60:61], v71 offset:4096
    ds_read_b64_tr_b16 v[62:63], v71 offset:6144
    s_waitcnt lgkmcnt(6)
    v_mfma_f32_32x32x16_bf16 v[128:143], v[40:43], v[48:51], v[128:143]
    v_mfma_f32_32x32x16_bf16 v[192:207], v[44:47], v[48:51], v[192:207]
    ds_read_b64_tr_b16 v[48:49], v64 offset:0
    ds_read_b64_tr_b16 v[50:51], v64 offset:2048
    s_waitcnt lgkmcnt(6)
    v_mfma_f32_32x32x16_bf16 v[144:159], v[40:43], v[52:55], v[144:159]
    v_mfma_f32_32x32x16_bf16 v[208:223], v[44:47], v[52:55], v[208:223]
    ds_read_b64_tr_b16 v[52:53], v65 offset:0
    ds_read_b64_tr_b16 v[54:55], v65 offset:2048
    s_waitcnt lgkmcnt(6)
    v_mfma_f32_32x32x16_bf16 v[160:175], v[40:43], v[56:59], v[160:175]
    v_mfma_f32_32x32x16_bf16 v[224:239], v[44:47], v[56:59], v[224:239]
    ds_read_b64_tr_b16 v[56:57], v66 offset:0
    ds_read_b64_tr_b16 v[58:59], v66 offset:2048
    s_waitcnt lgkmcnt(6)
    v_mfma_f32_32x32x16_bf16 v[176:191], v[40:43], v[60:63], v[176:191]
    v_mfma_f32_32x32x16_bf16 v[240:255], v[44:47], v[60:63], v[240:255]
    buffer_load_dwordx4 v[40:43], v78, s[8:11], s24 offen offset:1024
    buffer_load_dwordx4 v[44:47], v78, s[8:11], s23 offen offset:1024
    s_add_u32 s24, s24, 2048
    s_add_u32 s23, s23, 2048
    s_sub_u32 s28, s28, 1
    s_cmp_lg_u32 s28, 0
    s_cbranch_scc1 L_gk_v_loop
    v_lshrrev_b32 v96, 5, v0
    v_lshlrev_b32 v96, 11, v96
    v_and_b32 v97, 31, v0
    v_lshl_add_u32 v96, v97, 4, v96
    v_cvt_pk_bf16_f32 v80, v128, v129
    v_cvt_pk_bf16_f32 v81, v130, v131
    v_cvt_pk_bf16_f32 v82, v132, v133
    v_cvt_pk_bf16_f32 v83, v134, v135
    s_add_u32 s19, s29, 0
    buffer_store_dwordx4 v[80:83], v96, s[8:11], s19 offen offset:0 sc1
    v_cvt_pk_bf16_f32 v84, v136, v137
    v_cvt_pk_bf16_f32 v85, v138, v139
    v_cvt_pk_bf16_f32 v86, v140, v141
    v_cvt_pk_bf16_f32 v87, v142, v143
    s_add_u32 s19, s29, 4096
    buffer_store_dwordx4 v[84:87], v96, s[8:11], s19 offen offset:0 sc1
    v_cvt_pk_bf16_f32 v88, v144, v145
    v_cvt_pk_bf16_f32 v89, v146, v147
    v_cvt_pk_bf16_f32 v90, v148, v149
    v_cvt_pk_bf16_f32 v91, v150, v151
    s_add_u32 s19, s29, 0
    buffer_store_dwordx4 v[88:91], v96, s[8:11], s19 offen offset:512 sc1
    v_cvt_pk_bf16_f32 v92, v152, v153
    v_cvt_pk_bf16_f32 v93, v154, v155
    v_cvt_pk_bf16_f32 v94, v156, v157
    v_cvt_pk_bf16_f32 v95, v158, v159
    s_add_u32 s19, s29, 4096
    buffer_store_dwordx4 v[92:95], v96, s[8:11], s19 offen offset:512 sc1
    v_cvt_pk_bf16_f32 v80, v160, v161
    v_cvt_pk_bf16_f32 v81, v162, v163
    v_cvt_pk_bf16_f32 v82, v164, v165
    v_cvt_pk_bf16_f32 v83, v166, v167
    s_add_u32 s19, s29, 0
    buffer_store_dwordx4 v[80:83], v96, s[8:11], s19 offen offset:1024 sc1
    v_cvt_pk_bf16_f32 v84, v168, v169
    v_cvt_pk_bf16_f32 v85, v170, v171
    v_cvt_pk_bf16_f32 v86, v172, v173
    v_cvt_pk_bf16_f32 v87, v174, v175
    s_add_u32 s19, s29, 4096
    buffer_store_dwordx4 v[84:87], v96, s[8:11], s19 offen offset:1024 sc1
    v_cvt_pk_bf16_f32 v88, v176, v177
    v_cvt_pk_bf16_f32 v89, v178, v179
    v_cvt_pk_bf16_f32 v90, v180, v181
    v_cvt_pk_bf16_f32 v91, v182, v183
    s_add_u32 s19, s29, 0
    buffer_store_dwordx4 v[88:91], v96, s[8:11], s19 offen offset:1536 sc1
    v_cvt_pk_bf16_f32 v92, v184, v185
    v_cvt_pk_bf16_f32 v93, v186, v187
    v_cvt_pk_bf16_f32 v94, v188, v189
    v_cvt_pk_bf16_f32 v95, v190, v191
    s_add_u32 s19, s29, 4096
    buffer_store_dwordx4 v[92:95], v96, s[8:11], s19 offen offset:1536 sc1
    v_cvt_pk_bf16_f32 v80, v192, v193
    v_cvt_pk_bf16_f32 v81, v194, v195
    v_cvt_pk_bf16_f32 v82, v196, v197
    v_cvt_pk_bf16_f32 v83, v198, v199
    s_add_u32 s19, s29, 262144
    buffer_store_dwordx4 v[80:83], v96, s[8:11], s19 offen offset:0 sc1
    v_cvt_pk_bf16_f32 v84, v200, v201
    v_cvt_pk_bf16_f32 v85, v202, v203
    v_cvt_pk_bf16_f32 v86, v204, v205
    v_cvt_pk_bf16_f32 v87, v206, v207
    s_add_u32 s19, s29, 266240
    buffer_store_dwordx4 v[84:87], v96, s[8:11], s19 offen offset:0 sc1
    v_cvt_pk_bf16_f32 v88, v208, v209
    v_cvt_pk_bf16_f32 v89, v210, v211
    v_cvt_pk_bf16_f32 v90, v212, v213
    v_cvt_pk_bf16_f32 v91, v214, v215
    s_add_u32 s19, s29, 262144
    buffer_store_dwordx4 v[88:91], v96, s[8:11], s19 offen offset:512 sc1
    v_cvt_pk_bf16_f32 v92, v216, v217
    v_cvt_pk_bf16_f32 v93, v218, v219
    v_cvt_pk_bf16_f32 v94, v220, v221
    v_cvt_pk_bf16_f32 v95, v222, v223
    s_add_u32 s19, s29, 266240
    buffer_store_dwordx4 v[92:95], v96, s[8:11], s19 offen offset:512 sc1
    v_cvt_pk_bf16_f32 v80, v224, v225
    v_cvt_pk_bf16_f32 v81, v226, v227
    v_cvt_pk_bf16_f32 v82, v228, v229
    v_cvt_pk_bf16_f32 v83, v230, v231
    s_add_u32 s19, s29, 262144
    buffer_store_dwordx4 v[80:83], v96, s[8:11], s19 offen offset:1024 sc1
    v_cvt_pk_bf16_f32 v84, v232, v233
    v_cvt_pk_bf16_f32 v85, v234, v235
    v_cvt_pk_bf16_f32 v86, v236, v237
    v_cvt_pk_bf16_f32 v87, v238, v239
    s_add_u32 s19, s29, 266240
    buffer_store_dwordx4 v[84:87], v96, s[8:11], s19 offen offset:1024 sc1
    v_cvt_pk_bf16_f32 v88, v240, v241
    v_cvt_pk_bf16_f32 v89, v242, v243
    v_cvt_pk_bf16_f32 v90, v244, v245
    v_cvt_pk_bf16_f32 v91, v246, v247
    s_add_u32 s19, s29, 262144
    buffer_store_dwordx4 v[88:91], v96, s[8:11], s19 offen offset:1536 sc1
    v_cvt_pk_bf16_f32 v92, v248, v249
    v_cvt_pk_bf16_f32 v93, v250, v251
    v_cvt_pk_bf16_f32 v94, v252, v253
    v_cvt_pk_bf16_f32 v95, v254, v255
    s_add_u32 s19, s29, 266240
    buffer_store_dwordx4 v[92:95], v96, s[8:11], s19 offen offset:1536 sc1
    s_branch L_gm_sig
L_gm_h:
    s_sub_u32 s44, s44, 96
    s_add_u32 s63, s63, 0x200c80
    s_lshl_b32 s45, s43, 3
    s_lshl_b32 s19, s17, 1
    s_add_u32 s45, s45, s19
    v_lshlrev_b32 v78, 4, v0
    v_lshrrev_b32 v80, 5, v0
    v_bfe_u32 v81, v0, 2, 2
    v_lshl_add_u32 v82, v80, 2, v81
    s_movk_i32 s19, 256
    v_mul_lo_u32 v82, v82, s19
    v_bfe_u32 v83, v0, 4, 1
    v_and_b32 v84, 3, v0
    v_lshlrev_b32 v83, 5, v83
    v_lshl_add_u32 v83, v84, 3, v83
    v_add_u32 v82, v82, v83
    v_xor_b32 v84, 0, v81
    v_lshl_add_u32 v72, v84, 6, v82
    v_xor_b32 v84, 1, v81
    v_lshl_add_u32 v73, v84, 6, v82
    v_xor_b32 v84, 2, v81
    v_lshl_add_u32 v74, v84, 6, v82
    v_xor_b32 v84, 3, v81
    v_lshl_add_u32 v75, v84, 6, v82
    v_add_u32 v80, 0, v0
    s_mov_b32 s19, 0x10001
    v_mul_lo_u32 v81, v80, s19
    v_lshrrev_b32 v81, 20, v81
    s_movk_i32 s19, 16
    v_mul_lo_u32 v82, v81, s19
    v_sub_u32 v82, v80, v82
    v_and_b32 v83, 3, v81
    v_lshrrev_b32 v84, 2, v82
    v_xor_b32 v84, v84, v83
    v_and_b32 v82, 3, v82
    v_lshl_add_u32 v82, v84, 2, v82
    s_movk_i32 s19, 9216
    v_mul_lo_u32 v81, v81, s19
    v_lshl_add_u32 v76, v82, 4, v81
    v_add_u32 v80, 64, v0
    s_mov_b32 s19, 0x10001
    v_mul_lo_u32 v81, v80, s19
    v_lshrrev_b32 v81, 20, v81
    s_movk_i32 s19, 16
    v_mul_lo_u32 v82, v81, s19
    v_sub_u32 v82, v80, v82
    v_and_b32 v83, 3, v81
    v_lshrrev_b32 v84, 2, v82
    v_xor_b32 v84, v84, v83
    v_and_b32 v82, 3, v82
    v_lshl_add_u32 v82, v84, 2, v82
    s_movk_i32 s19, 9216
    v_mul_lo_u32 v81, v81, s19
    v_lshl_add_u32 v77, v82, 4, v81
    s_mul_i32 s31, s17, 2048
    s_mov_b32 s12, s54
    s_mov_b32 s13, s55
    s_mov_b32 s14, 0x510000
    s_mov_b32 s15, 0x20000
    s_mov_b32 s32, s56
    s_mov_b32 s33, s57
    s_mov_b32 s34, 0x2400
    s_mov_b32 s35, 0x20000
    s_lshl_b32 s25, s44, 8
    s_mov_b32 s22, s25
    s_mul_i32 s19, s17, 73728
    s_add_u32 s25, s25, s19
    s_mul_i32 s24, s45, 36864
    s_add_u32 s24, s24, 0x6800000
    s_mov_b32 s30, 36864
    s_mul_i32 s29, s45, 294912
    s_lshl_b32 s19, s44, 13
    s_add_u32 s29, s29, s19
    s_add_u32 s29, s29, 0x5000000
    s_add_u32 s23, s24, s30
    s_mov_b32 s26, 0
    s_mov_b32 s27, 0
    s_barrier
    s_add_u32 m0, s26, s31
    s_nop 0
    buffer_load_dwordx4 v76, s[12:15], s25 offen lds
    s_add_u32 m0, m0, 1024
    s_nop 0
    buffer_load_dwordx4 v77, s[12:15], s25 offen lds
    s_add_u32 s25, s25, 294912
    s_add_u32 s26, s26, 8192
    s_cmp_eq_u32 s26, 32768
    s_cselect_b32 s26, 0, s26
    buffer_load_dwordx4 v[16:19], v78, s[8:11], s24 offen offset:0
    buffer_load_dwordx4 v[20:23], v78, s[8:11], s23 offen offset:0
    buffer_load_dwordx4 v[24:27], v78, s[8:11], s24 offen offset:1024
    buffer_load_dwordx4 v[28:31], v78, s[8:11], s23 offen offset:1024
    s_add_u32 s24, s24, 2048
    s_add_u32 s23, s23, 2048
    s_add_u32 m0, s26, s31
    s_nop 0
    buffer_load_dwordx4 v76, s[12:15], s25 offen lds
    s_add_u32 m0, m0, 1024
    s_nop 0
    buffer_load_dwordx4 v77, s[12:15], s25 offen lds
    s_add_u32 s25, s25, 294912
    s_add_u32 s26, s26, 8192
    s_cmp_eq_u32 s26, 32768
    s_cselect_b32 s26, 0, s26
    buffer_load_dwordx4 v[32:35], v78, s[8:11], s24 offen offset:0
    buffer_load_dwordx4 v[36:39], v78, s[8:11], s23 offen offset:0
    buffer_load_dwordx4 v[40:43], v78, s[8:11], s24 offen offset:1024
    buffer_load_dwordx4 v[44:47], v78, s[8:11], s23 offen offset:1024
    s_add_u32 s24, s24, 2048
    s_add_u32 s23, s23, 2048
    s_add_u32 m0, s26, s31
    s_nop 0
    buffer_load_dwordx4 v76, s[12:15], s25 offen lds
    s_add_u32 m0, m0, 1024
    s_nop 0
    buffer_load_dwordx4 v77, s[12:15], s25 offen lds
    s_add_u32 s25, s25, 294912
    s_add_u32 s26, s26, 8192
    s_cmp_eq_u32 s26, 32768
    s_cselect_b32 s26, 0, s26
    v_lshrrev_b32 v80, 5, v0
    v_lshlrev_b32 v80, 3, v80
    buffer_load_dwordx2 v[82:83], v80, s[32:35], s22 offen offset:0
    buffer_load_dwordx2 v[84:85], v80, s[32:35], s22 offen offset:16
    buffer_load_dwordx2 v[86:87], v80, s[32:35], s22 offen offset:32
    buffer_load_dwordx2 v[88:89], v80, s[32:35], s22 offen offset:48
    s_waitcnt vmcnt(3)
    v_lshlrev_b32 v128, 16, v82
    v_and_b32 v129, 0xffff0000, v82
    v_lshlrev_b32 v130, 16, v83
    v_and_b32 v131, 0xffff0000, v83
    v_lshlrev_b32 v192, 16, v82
    v_and_b32 v193, 0xffff0000, v82
    v_lshlrev_b32 v194, 16, v83
    v_and_b32 v195, 0xffff0000, v83
    s_waitcnt vmcnt(2)
    v_lshlrev_b32 v132, 16, v84
    v_and_b32 v133, 0xffff0000, v84
    v_lshlrev_b32 v134, 16, v85
    v_and_b32 v135, 0xffff0000, v85
    v_lshlrev_b32 v196, 16, v84
    v_and_b32 v197, 0xffff0000, v84
    v_lshlrev_b32 v198, 16, v85
    v_and_b32 v199, 0xffff0000, v85
    s_waitcnt vmcnt(1)
    v_lshlrev_b32 v136, 16, v86
    v_and_b32 v137, 0xffff0000, v86
    v_lshlrev_b32 v138, 16, v87
    v_and_b32 v139, 0xffff0000, v87
    v_lshlrev_b32 v200, 16, v86
    v_and_b32 v201, 0xffff0000, v86
    v_lshlrev_b32 v202, 16, v87
    v_and_b32 v203, 0xffff0000, v87
    s_waitcnt vmcnt(0)
    v_lshlrev_b32 v140, 16, v88
    v_and_b32 v141, 0xffff0000, v88
    v_lshlrev_b32 v142, 16, v89
    v_and_b32 v143, 0xffff0000, v89
    v_lshlrev_b32 v204, 16, v88
    v_and_b32 v205, 0xffff0000, v88
    v_lshlrev_b32 v206, 16, v89
    v_and_b32 v207, 0xffff0000, v89
    buffer_load_dwordx2 v[82:83], v80, s[32:35], s22 offen offset:64
    buffer_load_dwordx2 v[84:85], v80, s[32:35], s22 offen offset:80
    buffer_load_dwordx2 v[86:87], v80, s[32:35], s22 offen offset:96
    buffer_load_dwordx2 v[88:89], v80, s[32:35], s22 offen offset:112
    s_waitcnt vmcnt(3)
    v_lshlrev_b32 v144, 16, v82
    v_and_b32 v145, 0xffff0000, v82
    v_lshlrev_b32 v146, 16, v83
    v_and_b32 v147, 0xffff0000, v83
    v_lshlrev_b32 v208, 16, v82
    v_and_b32 v209, 0xffff0000, v82
    v_lshlrev_b32 v210, 16, v83
    v_and_b32 v211, 0xffff0000, v83
    s_waitcnt vmcnt(2)
    v_lshlrev_b32 v148, 16, v84
    v_and_b32 v149, 0xffff0000, v84
    v_lshlrev_b32 v150, 16, v85
    v_and_b32 v151, 0xffff0000, v85
    v_lshlrev_b32 v212, 16, v84
    v_and_b32 v213, 0xffff0000, v84
    v_lshlrev_b32 v214, 16, v85
    v_and_b32 v215, 0xffff0000, v85
    s_waitcnt vmcnt(1)
    v_lshlrev_b32 v152, 16, v86
    v_and_b32 v153, 0xffff0000, v86
    v_lshlrev_b32 v154, 16, v87
    v_and_b32 v155, 0xffff0000, v87
    v_lshlrev_b32 v216, 16, v86
    v_and_b32 v217, 0xffff0000, v86
    v_lshlrev_b32 v218, 16, v87
    v_and_b32 v219, 0xffff0000, v87
    s_waitcnt vmcnt(0)
    v_lshlrev_b32 v156, 16, v88
    v_and_b32 v157, 0xffff0000, v88
    v_lshlrev_b32 v158, 16, v89
    v_and_b32 v159, 0xffff0000, v89
    v_lshlrev_b32 v220, 16, v88
    v_and_b32 v221, 0xffff0000, v88
    v_lshlrev_b32 v222, 16, v89
    v_and_b32 v223, 0xffff0000, v89
    buffer_load_dwordx2 v[82:83], v80, s[32:35], s22 offen offset:128
    buffer_load_dwordx2 v[84:85], v80, s[32:35], s22 offen offset:144
    buffer_load_dwordx2 v[86:87], v80, s[32:35], s22 offen offset:160
    buffer_load_dwordx2 v[88:89], v80, s[32:35], s22 offen offset:176
    s_waitcnt vmcnt(3)
    v_lshlrev_b32 v160, 16, v82
    v_and_b32 v161, 0xffff0000, v82
    v_lshlrev_b32 v162, 16, v83
    v_and_b32 v163, 0xffff0000, v83
    v_lshlrev_b32 v224, 16, v82
    v_and_b32 v225, 0xffff0000, v82
    v_lshlrev_b32 v226, 16, v83
    v_and_b32 v227, 0xffff0000, v83
    s_waitcnt vmcnt(2)
    v_lshlrev_b32 v164, 16, v84
    v_and_b32 v165, 0xffff0000, v84
    v_lshlrev_b32 v166, 16, v85
    v_and_b32 v167, 0xffff0000, v85
    v_lshlrev_b32 v228, 16, v84
    v_and_b32 v229, 0xffff0000, v84
    v_lshlrev_b32 v230, 16, v85
    v_and_b32 v231, 0xffff0000, v85
    s_waitcnt vmcnt(1)
    v_lshlrev_b32 v168, 16, v86
    v_and_b32 v169, 0xffff0000, v86
    v_lshlrev_b32 v170, 16, v87
    v_and_b32 v171, 0xffff0000, v87
    v_lshlrev_b32 v232, 16, v86
    v_and_b32 v233, 0xffff0000, v86
    v_lshlrev_b32 v234, 16, v87
    v_and_b32 v235, 0xffff0000, v87
    s_waitcnt vmcnt(0)
    v_lshlrev_b32 v172, 16, v88
    v_and_b32 v173, 0xffff0000, v88
    v_lshlrev_b32 v174, 16, v89
    v_and_b32 v175, 0xffff0000, v89
    v_lshlrev_b32 v236, 16, v88
    v_and_b32 v237, 0xffff0000, v88
    v_lshlrev_b32 v238, 16, v89
    v_and_b32 v239, 0xffff0000, v89
    buffer_load_dwordx2 v[82:83], v80, s[32:35], s22 offen offset:192
    buffer_load_dwordx2 v[84:85], v80, s[32:35], s22 offen offset:208
    buffer_load_dwordx2 v[86:87], v80, s[32:35], s22 offen offset:224
    buffer_load_dwordx2 v[88:89], v80, s[32:35], s22 offen offset:240
    s_waitcnt vmcnt(3)
    v_lshlrev_b32 v176, 16, v82
    v_and_b32 v177, 0xffff0000, v82
    v_lshlrev_b32 v178, 16, v83
    v_and_b32 v179, 0xffff0000, v83
    v_lshlrev_b32 v240, 16, v82
    v_and_b32 v241, 0xffff0000, v82
    v_lshlrev_b32 v242, 16, v83
    v_and_b32 v243, 0xffff0000, v83
    s_waitcnt vmcnt(2)
    v_lshlrev_b32 v180, 16, v84
    v_and_b32 v181, 0xffff0000, v84
    v_lshlrev_b32 v182, 16, v85
    v_and_b32 v183, 0xffff0000, v85
    v_lshlrev_b32 v244, 16, v84
    v_and_b32 v245, 0xffff0000, v84
    v_lshlrev_b32 v246, 16, v85
    v_and_b32 v247, 0xffff0000, v85
    s_waitcnt vmcnt(1)
    v_lshlrev_b32 v184, 16, v86
    v_and_b32 v185, 0xffff0000, v86
    v_lshlrev_b32 v186, 16, v87
    v_and_b32 v187, 0xffff0000, v87
    v_lshlrev_b32 v248, 16, v86
    v_and_b32 v249, 0xffff0000, v86
    v_lshlrev_b32 v250, 16, v87
    v_and_b32 v251, 0xffff0000, v87
    s_waitcnt vmcnt(0)
    v_lshlrev_b32 v188, 16, v88
    v_and_b32 v189, 0xffff0000, v88
    v_lshlrev_b32 v190, 16, v89
    v_and_b32 v191, 0xffff0000, v89
    v_lshlrev_b32 v252, 16, v88
    v_and_b32 v253, 0xffff0000, v88
    v_lshlrev_b32 v254, 16, v89
    v_and_b32 v255, 0xffff0000, v89
    s_waitcnt vmcnt(0)
    s_barrier
    v_add_u32 v64, s27, v72
    v_add_u32 v65, s27, v73
    v_add_u32 v66, s27, v74
    v_add_u32 v67, s27, v75
    s_add_u32 s27, s27, 8192
    s_cmp_eq_u32 s27, 32768
    s_cselect_b32 s27, 0, s27
    ds_read_b64_tr_b16 v[48:49], v64 offset:0
    ds_read_b64_tr_b16 v[50:51], v64 offset:2048
    ds_read_b64_tr_b16 v[52:53], v65 offset:0
    ds_read_b64_tr_b16 v[54:55], v65 offset:2048
    ds_read_b64_tr_b16 v[56:57], v66 offset:0
    ds_read_b64_tr_b16 v[58:59], v66 offset:2048
    s_mov_b32 s28, 9
L_gh_h_loop:
    s_cmp_eq_u32 s28, 1
    s_cselect_b32 s24, 0x40000000, s24
    s_cselect_b32 s23, 0x40000000, s23
    ds_read_b64_tr_b16 v[60:61], v67 offset:0
    ds_read_b64_tr_b16 v[62:63], v67 offset:2048
    s_waitcnt lgkmcnt(6)
    s_waitcnt vmcnt(11)
    v_mfma_f32_32x32x16_bf16 v[128:143], v[48:51], v[16:19], v[128:143]
    s_waitcnt vmcnt(10)
    v_mfma_f32_32x32x16_bf16 v[192:207], v[48:51], v[20:23], v[192:207]
    ds_read_b64_tr_b16 v[48:49], v64 offset:4096
    ds_read_b64_tr_b16 v[50:51], v64 offset:6144
    s_waitcnt lgkmcnt(6)
    v_mfma_f32_32x32x16_bf16 v[144:159], v[52:55], v[16:19], v[144:159]
    v_mfma_f32_32x32x16_bf16 v[208:223], v[52:55], v[20:23], v[208:223]
    ds_read_b64_tr_b16 v[52:53], v65 offset:4096
    ds_read_b64_tr_b16 v[54:55], v65 offset:6144
    s_waitcnt lgkmcnt(6)
    v_mfma_f32_32x32x16_bf16 v[160:175], v[56:59], v[16:19], v[160:175]
    v_mfma_f32_32x32x16_bf16 v[224:239], v[56:59], v[20:23], v[224:239]
    ds_read_b64_tr_b16 v[56:57], v66 offset:4096
    ds_read_b64_tr_b16 v[58:59], v66 offset:6144
    s_waitcnt lgkmcnt(6)
    v_mfma_f32_32x32x16_bf16 v[176:191], v[60:63], v[16:19], v[176:191]
    v_mfma_f32_32x32x16_bf16 v[240:255], v[60:63], v[20:23], v[240:255]
    buffer_load_dwordx4 v[16:19], v78, s[8:11], s24 offen offset:0
    buffer_load_dwordx4 v[20:23], v78, s[8:11], s23 offen offset:0
    s_waitcnt vmcnt(8)
    s_barrier
    v_add_u32 v68, s27, v72
    v_add_u32 v69, s27, v73
    v_add_u32 v70, s27, v74
    v_add_u32 v71, s27, v75
    s_add_u32 s27, s27, 8192
    s_cmp_eq_u32 s27, 32768
    s_cselect_b32 s27, 0, s27
    s_add_u32 m0, s26, s31
    s_nop 0
    buffer_load_dwordx4 v76, s[12:15], s25 offen lds
    s_add_u32 m0, m0, 1024
    s_nop 0
    buffer_load_dwordx4 v77, s[12:15], s25 offen lds
    s_add_u32 s25, s25, 294912
    s_add_u32 s26, s26, 8192
    s_cmp_eq_u32 s26, 32768
    s_cselect_b32 s26, 0, s26
    ds_read_b64_tr_b16 v[60:61], v67 offset:4096
    ds_read_b64_tr_b16 v[62:63], v67 offset:6144
    s_waitcnt lgkmcnt(6)
    v_mfma_f32_32x32x16_bf16 v[128:143], v[48:51], v[24:27], v[128:143]
    v_mfma_f32_32x32x16_bf16 v[192:207], v[48:51], v[28:31], v[192:207]
    ds_read_b64_tr_b16 v[48:49], v68 offset:0
    ds_read_b64_tr_b16 v[50:51], v68 offset:2048
    s_waitcnt lgkmcnt(6)
    v_mfma_f32_32x32x16_bf16 v[144:159], v[52:55], v[24:27], v[144:159]
    v_mfma_f32_32x32x16_bf16 v[208:223], v[52:55], v[28:31], v[208:223]
    ds_read_b64_tr_b16 v[52:53], v69 offset:0
    ds_read_b64_tr_b16 v[54:55], v69 offset:2048
    s_waitcnt lgkmcnt(6)
    v_mfma_f32_32x32x16_bf16 v[160:175], v[56:59], v[24:27], v[160:175]
    v_mfma_f32_32x32x16_bf16 v[224:239], v[56:59], v[28:31], v[224:239]
    ds_read_b64_tr_b16 v[56:57], v70 offset:0
    ds_read_b64_tr_b16 v[58:59], v70 offset:2048
    s_waitcnt lgkmcnt(6)
    v_mfma_f32_32x32x16_bf16 v[176:191], v[60:63], v[24:27], v[176:191]
    v_mfma_f32_32x32x16_bf16 v[240:255], v[60:63], v[28:31], v[240:255]
    buffer_load_dwordx4 v[24:27], v78, s[8:11], s24 offen offset:1024
    buffer_load_dwordx4 v[28:31], v78, s[8:11], s23 offen offset:1024
    s_add_u32 s24, s24, 2048
    s_add_u32 s23, s23, 2048
    ds_read_b64_tr_b16 v[60:61], v71 offset:0
    ds_read_b64_tr_b16 v[62:63], v71 offset:2048
    s_waitcnt lgkmcnt(6)
    s_waitcnt vmcnt(11)
    v_mfma_f32_32x32x16_bf16 v[128:143], v[48:51], v[32:35], v[128:143]
    s_waitcnt vmcnt(10)
    v_mfma_f32_32x32x16_bf16 v[192:207], v[48:51], v[36:39], v[192:207]
    ds_read_b64_tr_b16 v[48:49], v68 offset:4096
    ds_read_b64_tr_b16 v[50:51], v68 offset:6144
    s_waitcnt lgkmcnt(6)
    v_mfma_f32_32x32x16_bf16 v[144:159], v[52:55], v[32:35], v[144:159]
    v_mfma_f32_32x32x16_bf16 v[208:223], v[52:55], v[36:39], v[208:223]
    ds_read_b64_tr_b16 v[52:53], v69 offset:4096
    ds_read_b64_tr_b16 v[54:55], v69 offset:6144
    s_waitcnt lgkmcnt(6)
    v_mfma_f32_32x32x16_bf16 v[160:175], v[56:59], v[32:35], v[160:175]
    v_mfma_f32_32x32x16_bf16 v[224:239], v[56:59], v[36:39], v[224:239]
    ds_read_b64_tr_b16 v[56:57], v70 offset:4096
    ds_read_b64_tr_b16 v[58:59], v70 offset:6144
    s_waitcnt lgkmcnt(6)
    v_mfma_f32_32x32x16_bf16 v[176:191], v[60:63], v[32:35], v[176:191]
    v_mfma_f32_32x32x16_bf16 v[240:255], v[60:63], v[36:39], v[240:255]
    buffer_load_dwordx4 v[32:35], v78, s[8:11], s24 offen offset:0
    buffer_load_dwordx4 v[36:39], v78, s[8:11], s23 offen offset:0
    s_waitcnt vmcnt(8)
    s_barrier
    v_add_u32 v64, s27, v72
    v_add_u32 v65, s27, v73
    v_add_u32 v66, s27, v74
    v_add_u32 v67, s27, v75
    s_add_u32 s27, s27, 8192
    s_cmp_eq_u32 s27, 32768
    s_cselect_b32 s27, 0, s27
    s_add_u32 m0, s26, s31
    s_nop 0
    buffer_load_dwordx4 v76, s[12:15], s25 offen lds
    s_add_u32 m0, m0, 1024
    s_nop 0
    buffer_load_dwordx4 v77, s[12:15], s25 offen lds
    s_add_u32 s25, s25, 294912
    s_add_u32 s26, s26, 8192
    s_cmp_eq_u32 s26, 32768
    s_cselect_b32 s26, 0, s26
    ds_read_b64_tr_b16 v[60:61], v71 offset:4096
    ds_read_b64_tr_b16 v[62:63], v71 offset:6144
    s_waitcnt lgkmcnt(6)
    v_mfma_f32_32x32x16_bf16 v[128:143], v[48:51], v[40:43], v[128:143]
    v_mfma_f32_32x32x16_bf16 v[192:207], v[48:51], v[44:47], v[192:207]
    ds_read_b64_tr_b16 v[48:49], v64 offset:0
    ds_read_b64_tr_b16 v[50:51], v64 offset:2048
    s_waitcnt lgkmcnt(6)
    v_mfma_f32_32x32x16_bf16 v[144:159], v[52:55], v[40:43], v[144:159]
    v_mfma_f32_32x32x16_bf16 v[208:223], v[52:55], v[44:47], v[208:223]
    ds_read_b64_tr_b16 v[52:53], v65 offset:0
    ds_read_b64_tr_b16 v[54:55], v65 offset:2048
    s_waitcnt lgkmcnt(6)
    v_mfma_f32_32x32x16_bf16 v[160:175], v[56:59], v[40:43], v[160:175]
    v_mfma_f32_32x32x16_bf16 v[224:239], v[56:59], v[44:47], v[224:239]
    ds_read_b64_tr_b16 v[56:57], v66 offset:0
    ds_read_b64_tr_b16 v[58:59], v66 offset:2048
    s_waitcnt lgkmcnt(6)
    v_mfma_f32_32x32x16_bf16 v[176:191], v[60:63], v[40:43], v[176:191]
    v_mfma_f32_32x32x16_bf16 v[240:255], v[60:63], v[44:47], v[240:255]
    buffer_load_dwordx4 v[40:43], v78, s[8:11], s24 offen offset:1024
    buffer_load_dwordx4 v[44:47], v78, s[8:11], s23 offen offset:1024
    s_add_u32 s24, s24, 2048
    s_add_u32 s23, s23, 2048
    s_sub_u32 s28, s28, 1
    s_cmp_lg_u32 s28, 0
    s_cbranch_scc1 L_gh_h_loop
    v_mov_b32 v100, s40
    v_pk_mul_f32 v[96:97], v[128:129], v[128:129]
    v_pk_mul_f32 v[98:99], v[130:131], v[130:131]
    v_fma_f32 v96, v96, s41, v100
    v_fma_f32 v97, v97, s41, v100
    v_fma_f32 v98, v98, s41, v100
    v_fma_f32 v99, v99, s41, v100
    v_pk_mul_f32 v[96:97], v[96:97], v[128:129]
    v_pk_mul_f32 v[98:99], v[98:99], v[130:131]
    v_exp_f32 v96, v96
    v_exp_f32 v97, v97
    v_exp_f32 v98, v98
    v_exp_f32 v99, v99
    v_add_f32 v96, 1.0, v96
    v_add_f32 v97, 1.0, v97
    v_add_f32 v98, 1.0, v98
    v_add_f32 v99, 1.0, v99
    v_rcp_f32 v96, v96
    v_rcp_f32 v97, v97
    v_rcp_f32 v98, v98
    v_rcp_f32 v99, v99
    v_pk_mul_f32 v[128:129], v[128:129], v[96:97]
    v_pk_mul_f32 v[130:131], v[130:131], v[98:99]
    v_pk_mul_f32 v[96:97], v[132:133], v[132:133]
    v_pk_mul_f32 v[98:99], v[134:135], v[134:135]
    v_fma_f32 v96, v96, s41, v100
    v_fma_f32 v97, v97, s41, v100
    v_fma_f32 v98, v98, s41, v100
    v_fma_f32 v99, v99, s41, v100
    v_pk_mul_f32 v[96:97], v[96:97], v[132:133]
    v_pk_mul_f32 v[98:99], v[98:99], v[134:135]
    v_exp_f32 v96, v96
    v_exp_f32 v97, v97
    v_exp_f32 v98, v98
    v_exp_f32 v99, v99
    v_add_f32 v96, 1.0, v96
    v_add_f32 v97, 1.0, v97
    v_add_f32 v98, 1.0, v98
    v_add_f32 v99, 1.0, v99
    v_rcp_f32 v96, v96
    v_rcp_f32 v97, v97
    v_rcp_f32 v98, v98
    v_rcp_f32 v99, v99
    v_pk_mul_f32 v[132:133], v[132:133], v[96:97]
    v_pk_mul_f32 v[134:135], v[134:135], v[98:99]
    v_pk_mul_f32 v[96:97], v[136:137], v[136:137]
    v_pk_mul_f32 v[98:99], v[138:139], v[138:139]
    v_fma_f32 v96, v96, s41, v100
    v_fma_f32 v97, v97, s41, v100
    v_fma_f32 v98, v98, s41, v100
    v_fma_f32 v99, v99, s41, v100
    v_pk_mul_f32 v[96:97], v[96:97], v[136:137]
    v_pk_mul_f32 v[98:99], v[98:99], v[138:139]
    v_exp_f32 v96, v96
    v_exp_f32 v97, v97
    v_exp_f32 v98, v98
    v_exp_f32 v99, v99
    v_add_f32 v96, 1.0, v96
    v_add_f32 v97, 1.0, v97
    v_add_f32 v98, 1.0, v98
    v_add_f32 v99, 1.0, v99
    v_rcp_f32 v96, v96
    v_rcp_f32 v97, v97
    v_rcp_f32 v98, v98
    v_rcp_f32 v99, v99
    v_pk_mul_f32 v[136:137], v[136:137], v[96:97]
    v_pk_mul_f32 v[138:139], v[138:139], v[98:99]
    v_pk_mul_f32 v[96:97], v[140:141], v[140:141]
    v_pk_mul_f32 v[98:99], v[142:143], v[142:143]
    v_fma_f32 v96, v96, s41, v100
    v_fma_f32 v97, v97, s41, v100
    v_fma_f32 v98, v98, s41, v100
    v_fma_f32 v99, v99, s41, v100
    v_pk_mul_f32 v[96:97], v[96:97], v[140:141]
    v_pk_mul_f32 v[98:99], v[98:99], v[142:143]
    v_exp_f32 v96, v96
    v_exp_f32 v97, v97
    v_exp_f32 v98, v98
    v_exp_f32 v99, v99
    v_add_f32 v96, 1.0, v96
    v_add_f32 v97, 1.0, v97
    v_add_f32 v98, 1.0, v98
    v_add_f32 v99, 1.0, v99
    v_rcp_f32 v96, v96
    v_rcp_f32 v97, v97
    v_rcp_f32 v98, v98
    v_rcp_f32 v99, v99
    v_pk_mul_f32 v[140:141], v[140:141], v[96:97]
    v_pk_mul_f32 v[142:143], v[142:143], v[98:99]
    v_cvt_pk_bf16_f32 v80, v128, v129
    v_cvt_pk_bf16_f32 v81, v130, v131
    v_cvt_pk_bf16_f32 v82, v132, v133
    v_cvt_pk_bf16_f32 v83, v134, v135
    s_add_u32 s19, s29, 0
    buffer_store_dwordx4 v[80:83], v78, s[8:11], s19 offen offset:0 sc1
    v_cvt_pk_bf16_f32 v84, v136, v137
    v_cvt_pk_bf16_f32 v85, v138, v139
    v_cvt_pk_bf16_f32 v86, v140, v141
    v_cvt_pk_bf16_f32 v87, v142, v143
    s_add_u32 s19, s29, 0
    buffer_store_dwordx4 v[84:87], v78, s[8:11], s19 offen offset:1024 sc1
    v_pk_mul_f32 v[96:97], v[144:145], v[144:145]
    v_pk_mul_f32 v[98:99], v[146:147], v[146:147]
    v_fma_f32 v96, v96, s41, v100
    v_fma_f32 v97, v97, s41, v100
    v_fma_f32 v98, v98, s41, v100
    v_fma_f32 v99, v99, s41, v100
    v_pk_mul_f32 v[96:97], v[96:97], v[144:145]
    v_pk_mul_f32 v[98:99], v[98:99], v[146:147]
    v_exp_f32 v96, v96
    v_exp_f32 v97, v97
    v_exp_f32 v98, v98
    v_exp_f32 v99, v99
    v_add_f32 v96, 1.0, v96
    v_add_f32 v97, 1.0, v97
    v_add_f32 v98, 1.0, v98
    v_add_f32 v99, 1.0, v99
    v_rcp_f32 v96, v96
    v_rcp_f32 v97, v97
    v_rcp_f32 v98, v98
    v_rcp_f32 v99, v99
    v_pk_mul_f32 v[144:145], v[144:145], v[96:97]
    v_pk_mul_f32 v[146:147], v[146:147], v[98:99]
    v_pk_mul_f32 v[96:97], v[148:149], v[148:149]
    v_pk_mul_f32 v[98:99], v[150:151], v[150:151]
    v_fma_f32 v96, v96, s41, v100
    v_fma_f32 v97, v97, s41, v100
    v_fma_f32 v98, v98, s41, v100
    v_fma_f32 v99, v99, s41, v100
    v_pk_mul_f32 v[96:97], v[96:97], v[148:149]
    v_pk_mul_f32 v[98:99], v[98:99], v[150:151]
    v_exp_f32 v96, v96
    v_exp_f32 v97, v97
    v_exp_f32 v98, v98
    v_exp_f32 v99, v99
    v_add_f32 v96, 1.0, v96
    v_add_f32 v97, 1.0, v97
    v_add_f32 v98, 1.0, v98
    v_add_f32 v99, 1.0, v99
    v_rcp_f32 v96, v96
    v_rcp_f32 v97, v97
    v_rcp_f32 v98, v98
    v_rcp_f32 v99, v99
    v_pk_mul_f32 v[148:149], v[148:149], v[96:97]
    v_pk_mul_f32 v[150:151], v[150:151], v[98:99]
    v_pk_mul_f32 v[96:97], v[152:153], v[152:153]
    v_pk_mul_f32 v[98:99], v[154:155], v[154:155]
    v_fma_f32 v96, v96, s41, v100
    v_fma_f32 v97, v97, s41, v100
    v_fma_f32 v98, v98, s41, v100
    v_fma_f32 v99, v99, s41, v100
    v_pk_mul_f32 v[96:97], v[96:97], v[152:153]
    v_pk_mul_f32 v[98:99], v[98:99], v[154:155]
    v_exp_f32 v96, v96
    v_exp_f32 v97, v97
    v_exp_f32 v98, v98
    v_exp_f32 v99, v99
    v_add_f32 v96, 1.0, v96
    v_add_f32 v97, 1.0, v97
    v_add_f32 v98, 1.0, v98
    v_add_f32 v99, 1.0, v99
    v_rcp_f32 v96, v96
    v_rcp_f32 v97, v97
    v_rcp_f32 v98, v98
    v_rcp_f32 v99, v99
    v_pk_mul_f32 v[152:153], v[152:153], v[96:97]
    v_pk_mul_f32 v[154:155], v[154:155], v[98:99]
    v_pk_mul_f32 v[96:97], v[156:157], v[156:157]
    v_pk_mul_f32 v[98:99], v[158:159], v[158:159]
    v_fma_f32 v96, v96, s41, v100
    v_fma_f32 v97, v97, s41, v100
    v_fma_f32 v98, v98, s41, v100
    v_fma_f32 v99, v99, s41, v100
    v_pk_mul_f32 v[96:97], v[96:97], v[156:157]
    v_pk_mul_f32 v[98:99], v[98:99], v[158:159]
    v_exp_f32 v96, v96
    v_exp_f32 v97, v97
    v_exp_f32 v98, v98
    v_exp_f32 v99, v99
    v_add_f32 v96, 1.0, v96
    v_add_f32 v97, 1.0, v97
    v_add_f32 v98, 1.0, v98
    v_add_f32 v99, 1.0, v99
    v_rcp_f32 v96, v96
    v_rcp_f32 v97, v97
    v_rcp_f32 v98, v98
    v_rcp_f32 v99, v99
    v_pk_mul_f32 v[156:157], v[156:157], v[96:97]
    v_pk_mul_f32 v[158:159], v[158:159], v[98:99]
    v_cvt_pk_bf16_f32 v88, v144, v145
    v_cvt_pk_bf16_f32 v89, v146, v147
    v_cvt_pk_bf16_f32 v90, v148, v149
    v_cvt_pk_bf16_f32 v91, v150, v151
    s_add_u32 s19, s29, 0
    buffer_store_dwordx4 v[88:91], v78, s[8:11], s19 offen offset:2048 sc1
    v_cvt_pk_bf16_f32 v92, v152, v153
    v_cvt_pk_bf16_f32 v93, v154, v155
    v_cvt_pk_bf16_f32 v94, v156, v157
    v_cvt_pk_bf16_f32 v95, v158, v159
    s_add_u32 s19, s29, 0
    buffer_store_dwordx4 v[92:95], v78, s[8:11], s19 offen offset:3072 sc1
    v_pk_mul_f32 v[96:97], v[160:161], v[160:161]
    v_pk_mul_f32 v[98:99], v[162:163], v[162:163]
    v_fma_f32 v96, v96, s41, v100
    v_fma_f32 v97, v97, s41, v100
    v_fma_f32 v98, v98, s41, v100
    v_fma_f32 v99, v99, s41, v100
    v_pk_mul_f32 v[96:97], v[96:97], v[160:161]
    v_pk_mul_f32 v[98:99], v[98:99], v[162:163]
    v_exp_f32 v96, v96
    v_exp_f32 v97, v97
    v_exp_f32 v98, v98
    v_exp_f32 v99, v99
    v_add_f32 v96, 1.0, v96
    v_add_f32 v97, 1.0, v97
    v_add_f32 v98, 1.0, v98
    v_add_f32 v99, 1.0, v99
    v_rcp_f32 v96, v96
    v_rcp_f32 v97, v97
    v_rcp_f32 v98, v98
    v_rcp_f32 v99, v99
    v_pk_mul_f32 v[160:161], v[160:161], v[96:97]
    v_pk_mul_f32 v[162:163], v[162:163], v[98:99]
    v_pk_mul_f32 v[96:97], v[164:165], v[164:165]
    v_pk_mul_f32 v[98:99], v[166:167], v[166:167]
    v_fma_f32 v96, v96, s41, v100
    v_fma_f32 v97, v97, s41, v100
    v_fma_f32 v98, v98, s41, v100
    v_fma_f32 v99, v99, s41, v100
    v_pk_mul_f32 v[96:97], v[96:97], v[164:165]
    v_pk_mul_f32 v[98:99], v[98:99], v[166:167]
    v_exp_f32 v96, v96
    v_exp_f32 v97, v97
    v_exp_f32 v98, v98
    v_exp_f32 v99, v99
    v_add_f32 v96, 1.0, v96
    v_add_f32 v97, 1.0, v97
    v_add_f32 v98, 1.0, v98
    v_add_f32 v99, 1.0, v99
    v_rcp_f32 v96, v96
    v_rcp_f32 v97, v97
    v_rcp_f32 v98, v98
    v_rcp_f32 v99, v99
    v_pk_mul_f32 v[164:165], v[164:165], v[96:97]
    v_pk_mul_f32 v[166:167], v[166:167], v[98:99]
    v_pk_mul_f32 v[96:97], v[168:169], v[168:169]
    v_pk_mul_f32 v[98:99], v[170:171], v[170:171]
    v_fma_f32 v96, v96, s41, v100
    v_fma_f32 v97, v97, s41, v100
    v_fma_f32 v98, v98, s41, v100
    v_fma_f32 v99, v99, s41, v100
    v_pk_mul_f32 v[96:97], v[96:97], v[168:169]
    v_pk_mul_f32 v[98:99], v[98:99], v[170:171]
    v_exp_f32 v96, v96
    v_exp_f32 v97, v97
    v_exp_f32 v98, v98
    v_exp_f32 v99, v99
    v_add_f32 v96, 1.0, v96
    v_add_f32 v97, 1.0, v97
    v_add_f32 v98, 1.0, v98
    v_add_f32 v99, 1.0, v99
    v_rcp_f32 v96, v96
    v_rcp_f32 v97, v97
    v_rcp_f32 v98, v98
    v_rcp_f32 v99, v99
    v_pk_mul_f32 v[168:169], v[168:169], v[96:97]
    v_pk_mul_f32 v[170:171], v[170:171], v[98:99]
    v_pk_mul_f32 v[96:97], v[172:173], v[172:173]
    v_pk_mul_f32 v[98:99], v[174:175], v[174:175]
    v_fma_f32 v96, v96, s41, v100
    v_fma_f32 v97, v97, s41, v100
    v_fma_f32 v98, v98, s41, v100
    v_fma_f32 v99, v99, s41, v100
    v_pk_mul_f32 v[96:97], v[96:97], v[172:173]
    v_pk_mul_f32 v[98:99], v[98:99], v[174:175]
    v_exp_f32 v96, v96
    v_exp_f32 v97, v97
    v_exp_f32 v98, v98
    v_exp_f32 v99, v99
    v_add_f32 v96, 1.0, v96
    v_add_f32 v97, 1.0, v97
    v_add_f32 v98, 1.0, v98
    v_add_f32 v99, 1.0, v99
    v_rcp_f32 v96, v96
    v_rcp_f32 v97, v97
    v_rcp_f32 v98, v98
    v_rcp_f32 v99, v99
    v_pk_mul_f32 v[172:173], v[172:173], v[96:97]
    v_pk_mul_f32 v[174:175], v[174:175], v[98:99]
    v_cvt_pk_bf16_f32 v80, v160, v161
    v_cvt_pk_bf16_f32 v81, v162, v163
    v_cvt_pk_bf16_f32 v82, v164, v165
    v_cvt_pk_bf16_f32 v83, v166, v167
    s_add_u32 s19, s29, 4096
    buffer_store_dwordx4 v[80:83], v78, s[8:11], s19 offen offset:0 sc1
    v_cvt_pk_bf16_f32 v84, v168, v169
    v_cvt_pk_bf16_f32 v85, v170, v171
    v_cvt_pk_bf16_f32 v86, v172, v173
    v_cvt_pk_bf16_f32 v87, v174, v175
    s_add_u32 s19, s29, 4096
    buffer_store_dwordx4 v[84:87], v78, s[8:11], s19 offen offset:1024 sc1
    v_pk_mul_f32 v[96:97], v[176:177], v[176:177]
    v_pk_mul_f32 v[98:99], v[178:179], v[178:179]
    v_fma_f32 v96, v96, s41, v100
    v_fma_f32 v97, v97, s41, v100
    v_fma_f32 v98, v98, s41, v100
    v_fma_f32 v99, v99, s41, v100
    v_pk_mul_f32 v[96:97], v[96:97], v[176:177]
    v_pk_mul_f32 v[98:99], v[98:99], v[178:179]
    v_exp_f32 v96, v96
    v_exp_f32 v97, v97
    v_exp_f32 v98, v98
    v_exp_f32 v99, v99
    v_add_f32 v96, 1.0, v96
    v_add_f32 v97, 1.0, v97
    v_add_f32 v98, 1.0, v98
    v_add_f32 v99, 1.0, v99
    v_rcp_f32 v96, v96
    v_rcp_f32 v97, v97
    v_rcp_f32 v98, v98
    v_rcp_f32 v99, v99
    v_pk_mul_f32 v[176:177], v[176:177], v[96:97]
    v_pk_mul_f32 v[178:179], v[178:179], v[98:99]
    v_pk_mul_f32 v[96:97], v[180:181], v[180:181]
    v_pk_mul_f32 v[98:99], v[182:183], v[182:183]
    v_fma_f32 v96, v96, s41, v100
    v_fma_f32 v97, v97, s41, v100
    v_fma_f32 v98, v98, s41, v100
    v_fma_f32 v99, v99, s41, v100
    v_pk_mul_f32 v[96:97], v[96:97], v[180:181]
    v_pk_mul_f32 v[98:99], v[98:99], v[182:183]
    v_exp_f32 v96, v96
    v_exp_f32 v97, v97
    v_exp_f32 v98, v98
    v_exp_f32 v99, v99
    v_add_f32 v96, 1.0, v96
    v_add_f32 v97, 1.0, v97
    v_add_f32 v98, 1.0, v98
    v_add_f32 v99, 1.0, v99
    v_rcp_f32 v96, v96
    v_rcp_f32 v97, v97
    v_rcp_f32 v98, v98
    v_rcp_f32 v99, v99
    v_pk_mul_f32 v[180:181], v[180:181], v[96:97]
    v_pk_mul_f32 v[182:183], v[182:183], v[98:99]
    v_pk_mul_f32 v[96:97], v[184:185], v[184:185]
    v_pk_mul_f32 v[98:99], v[186:187], v[186:187]
    v_fma_f32 v96, v96, s41, v100
    v_fma_f32 v97, v97, s41, v100
    v_fma_f32 v98, v98, s41, v100
    v_fma_f32 v99, v99, s41, v100
    v_pk_mul_f32 v[96:97], v[96:97], v[184:185]
    v_pk_mul_f32 v[98:99], v[98:99], v[186:187]
    v_exp_f32 v96, v96
    v_exp_f32 v97, v97
    v_exp_f32 v98, v98
    v_exp_f32 v99, v99
    v_add_f32 v96, 1.0, v96
    v_add_f32 v97, 1.0, v97
    v_add_f32 v98, 1.0, v98
    v_add_f32 v99, 1.0, v99
    v_rcp_f32 v96, v96
    v_rcp_f32 v97, v97
    v_rcp_f32 v98, v98
    v_rcp_f32 v99, v99
    v_pk_mul_f32 v[184:185], v[184:185], v[96:97]
    v_pk_mul_f32 v[186:187], v[186:187], v[98:99]
    v_pk_mul_f32 v[96:97], v[188:189], v[188:189]
    v_pk_mul_f32 v[98:99], v[190:191], v[190:191]
    v_fma_f32 v96, v96, s41, v100
    v_fma_f32 v97, v97, s41, v100
    v_fma_f32 v98, v98, s41, v100
    v_fma_f32 v99, v99, s41, v100
    v_pk_mul_f32 v[96:97], v[96:97], v[188:189]
    v_pk_mul_f32 v[98:99], v[98:99], v[190:191]
    v_exp_f32 v96, v96
    v_exp_f32 v97, v97
    v_exp_f32 v98, v98
    v_exp_f32 v99, v99
    v_add_f32 v96, 1.0, v96
    v_add_f32 v97, 1.0, v97
    v_add_f32 v98, 1.0, v98
    v_add_f32 v99, 1.0, v99
    v_rcp_f32 v96, v96
    v_rcp_f32 v97, v97
    v_rcp_f32 v98, v98
    v_rcp_f32 v99, v99
    v_pk_mul_f32 v[188:189], v[188:189], v[96:97]
    v_pk_mul_f32 v[190:191], v[190:191], v[98:99]
    v_cvt_pk_bf16_f32 v88, v176, v177
    v_cvt_pk_bf16_f32 v89, v178, v179
    v_cvt_pk_bf16_f32 v90, v180, v181
    v_cvt_pk_bf16_f32 v91, v182, v183
    s_add_u32 s19, s29, 4096
    buffer_store_dwordx4 v[88:91], v78, s[8:11], s19 offen offset:2048 sc1
    v_cvt_pk_bf16_f32 v92, v184, v185
    v_cvt_pk_bf16_f32 v93, v186, v187
    v_cvt_pk_bf16_f32 v94, v188, v189
    v_cvt_pk_bf16_f32 v95, v190, v191
    s_add_u32 s19, s29, 4096
    buffer_store_dwordx4 v[92:95], v78, s[8:11], s19 offen offset:3072 sc1
    v_pk_mul_f32 v[96:97], v[192:193], v[192:193]
    v_pk_mul_f32 v[98:99], v[194:195], v[194:195]
    v_fma_f32 v96, v96, s41, v100
    v_fma_f32 v97, v97, s41, v100
    v_fma_f32 v98, v98, s41, v100
    v_fma_f32 v99, v99, s41, v100
    v_pk_mul_f32 v[96:97], v[96:97], v[192:193]
    v_pk_mul_f32 v[98:99], v[98:99], v[194:195]
    v_exp_f32 v96, v96
    v_exp_f32 v97, v97
    v_exp_f32 v98, v98
    v_exp_f32 v99, v99
    v_add_f32 v96, 1.0, v96
    v_add_f32 v97, 1.0, v97
    v_add_f32 v98, 1.0, v98
    v_add_f32 v99, 1.0, v99
    v_rcp_f32 v96, v96
    v_rcp_f32 v97, v97
    v_rcp_f32 v98, v98
    v_rcp_f32 v99, v99
    v_pk_mul_f32 v[192:193], v[192:193], v[96:97]
    v_pk_mul_f32 v[194:195], v[194:195], v[98:99]
    v_pk_mul_f32 v[96:97], v[196:197], v[196:197]
    v_pk_mul_f32 v[98:99], v[198:199], v[198:199]
    v_fma_f32 v96, v96, s41, v100
    v_fma_f32 v97, v97, s41, v100
    v_fma_f32 v98, v98, s41, v100
    v_fma_f32 v99, v99, s41, v100
    v_pk_mul_f32 v[96:97], v[96:97], v[196:197]
    v_pk_mul_f32 v[98:99], v[98:99], v[198:199]
    v_exp_f32 v96, v96
    v_exp_f32 v97, v97
    v_exp_f32 v98, v98
    v_exp_f32 v99, v99
    v_add_f32 v96, 1.0, v96
    v_add_f32 v97, 1.0, v97
    v_add_f32 v98, 1.0, v98
    v_add_f32 v99, 1.0, v99
    v_rcp_f32 v96, v96
    v_rcp_f32 v97, v97
    v_rcp_f32 v98, v98
    v_rcp_f32 v99, v99
    v_pk_mul_f32 v[196:197], v[196:197], v[96:97]
    v_pk_mul_f32 v[198:199], v[198:199], v[98:99]
    v_pk_mul_f32 v[96:97], v[200:201], v[200:201]
    v_pk_mul_f32 v[98:99], v[202:203], v[202:203]
    v_fma_f32 v96, v96, s41, v100
    v_fma_f32 v97, v97, s41, v100
    v_fma_f32 v98, v98, s41, v100
    v_fma_f32 v99, v99, s41, v100
    v_pk_mul_f32 v[96:97], v[96:97], v[200:201]
    v_pk_mul_f32 v[98:99], v[98:99], v[202:203]
    v_exp_f32 v96, v96
    v_exp_f32 v97, v97
    v_exp_f32 v98, v98
    v_exp_f32 v99, v99
    v_add_f32 v96, 1.0, v96
    v_add_f32 v97, 1.0, v97
    v_add_f32 v98, 1.0, v98
    v_add_f32 v99, 1.0, v99
    v_rcp_f32 v96, v96
    v_rcp_f32 v97, v97
    v_rcp_f32 v98, v98
    v_rcp_f32 v99, v99
    v_pk_mul_f32 v[200:201], v[200:201], v[96:97]
    v_pk_mul_f32 v[202:203], v[202:203], v[98:99]
    v_pk_mul_f32 v[96:97], v[204:205], v[204:205]
    v_pk_mul_f32 v[98:99], v[206:207], v[206:207]
    v_fma_f32 v96, v96, s41, v100
    v_fma_f32 v97, v97, s41, v100
    v_fma_f32 v98, v98, s41, v100
    v_fma_f32 v99, v99, s41, v100
    v_pk_mul_f32 v[96:97], v[96:97], v[204:205]
    v_pk_mul_f32 v[98:99], v[98:99], v[206:207]
    v_exp_f32 v96, v96
    v_exp_f32 v97, v97
    v_exp_f32 v98, v98
    v_exp_f32 v99, v99
    v_add_f32 v96, 1.0, v96
    v_add_f32 v97, 1.0, v97
    v_add_f32 v98, 1.0, v98
    v_add_f32 v99, 1.0, v99
    v_rcp_f32 v96, v96
    v_rcp_f32 v97, v97
    v_rcp_f32 v98, v98
    v_rcp_f32 v99, v99
    v_pk_mul_f32 v[204:205], v[204:205], v[96:97]
    v_pk_mul_f32 v[206:207], v[206:207], v[98:99]
    v_cvt_pk_bf16_f32 v80, v192, v193
    v_cvt_pk_bf16_f32 v81, v194, v195
    v_cvt_pk_bf16_f32 v82, v196, v197
    v_cvt_pk_bf16_f32 v83, v198, v199
    s_add_u32 s19, s29, 294912
    buffer_store_dwordx4 v[80:83], v78, s[8:11], s19 offen offset:0 sc1
    v_cvt_pk_bf16_f32 v84, v200, v201
    v_cvt_pk_bf16_f32 v85, v202, v203
    v_cvt_pk_bf16_f32 v86, v204, v205
    v_cvt_pk_bf16_f32 v87, v206, v207
    s_add_u32 s19, s29, 294912
    buffer_store_dwordx4 v[84:87], v78, s[8:11], s19 offen offset:1024 sc1
    v_pk_mul_f32 v[96:97], v[208:209], v[208:209]
    v_pk_mul_f32 v[98:99], v[210:211], v[210:211]
    v_fma_f32 v96, v96, s41, v100
    v_fma_f32 v97, v97, s41, v100
    v_fma_f32 v98, v98, s41, v100
    v_fma_f32 v99, v99, s41, v100
    v_pk_mul_f32 v[96:97], v[96:97], v[208:209]
    v_pk_mul_f32 v[98:99], v[98:99], v[210:211]
    v_exp_f32 v96, v96
    v_exp_f32 v97, v97
    v_exp_f32 v98, v98
    v_exp_f32 v99, v99
    v_add_f32 v96, 1.0, v96
    v_add_f32 v97, 1.0, v97
    v_add_f32 v98, 1.0, v98
    v_add_f32 v99, 1.0, v99
    v_rcp_f32 v96, v96
    v_rcp_f32 v97, v97
    v_rcp_f32 v98, v98
    v_rcp_f32 v99, v99
    v_pk_mul_f32 v[208:209], v[208:209], v[96:97]
    v_pk_mul_f32 v[210:211], v[210:211], v[98:99]
    v_pk_mul_f32 v[96:97], v[212:213], v[212:213]
    v_pk_mul_f32 v[98:99], v[214:215], v[214:215]
    v_fma_f32 v96, v96, s41, v100
    v_fma_f32 v97, v97, s41, v100
    v_fma_f32 v98, v98, s41, v100
    v_fma_f32 v99, v99, s41, v100
    v_pk_mul_f32 v[96:97], v[96:97], v[212:213]
    v_pk_mul_f32 v[98:99], v[98:99], v[214:215]
    v_exp_f32 v96, v96
    v_exp_f32 v97, v97
    v_exp_f32 v98, v98
    v_exp_f32 v99, v99
    v_add_f32 v96, 1.0, v96
    v_add_f32 v97, 1.0, v97
    v_add_f32 v98, 1.0, v98
    v_add_f32 v99, 1.0, v99
    v_rcp_f32 v96, v96
    v_rcp_f32 v97, v97
    v_rcp_f32 v98, v98
    v_rcp_f32 v99, v99
    v_pk_mul_f32 v[212:213], v[212:213], v[96:97]
    v_pk_mul_f32 v[214:215], v[214:215], v[98:99]
    v_pk_mul_f32 v[96:97], v[216:217], v[216:217]
    v_pk_mul_f32 v[98:99], v[218:219], v[218:219]
    v_fma_f32 v96, v96, s41, v100
    v_fma_f32 v97, v97, s41, v100
    v_fma_f32 v98, v98, s41, v100
    v_fma_f32 v99, v99, s41, v100
    v_pk_mul_f32 v[96:97], v[96:97], v[216:217]
    v_pk_mul_f32 v[98:99], v[98:99], v[218:219]
    v_exp_f32 v96, v96
    v_exp_f32 v97, v97
    v_exp_f32 v98, v98
    v_exp_f32 v99, v99
    v_add_f32 v96, 1.0, v96
    v_add_f32 v97, 1.0, v97
    v_add_f32 v98, 1.0, v98
    v_add_f32 v99, 1.0, v99
    v_rcp_f32 v96, v96
    v_rcp_f32 v97, v97
    v_rcp_f32 v98, v98
    v_rcp_f32 v99, v99
    v_pk_mul_f32 v[216:217], v[216:217], v[96:97]
    v_pk_mul_f32 v[218:219], v[218:219], v[98:99]
    v_pk_mul_f32 v[96:97], v[220:221], v[220:221]
    v_pk_mul_f32 v[98:99], v[222:223], v[222:223]
    v_fma_f32 v96, v96, s41, v100
    v_fma_f32 v97, v97, s41, v100
    v_fma_f32 v98, v98, s41, v100
    v_fma_f32 v99, v99, s41, v100
    v_pk_mul_f32 v[96:97], v[96:97], v[220:221]
    v_pk_mul_f32 v[98:99], v[98:99], v[222:223]
    v_exp_f32 v96, v96
    v_exp_f32 v97, v97
    v_exp_f32 v98, v98
    v_exp_f32 v99, v99
    v_add_f32 v96, 1.0, v96
    v_add_f32 v97, 1.0, v97
    v_add_f32 v98, 1.0, v98
    v_add_f32 v99, 1.0, v99
    v_rcp_f32 v96, v96
    v_rcp_f32 v97, v97
    v_rcp_f32 v98, v98
    v_rcp_f32 v99, v99
    v_pk_mul_f32 v[220:221], v[220:221], v[96:97]
    v_pk_mul_f32 v[222:223], v[222:223], v[98:99]
    v_cvt_pk_bf16_f32 v88, v208, v209
    v_cvt_pk_bf16_f32 v89, v210, v211
    v_cvt_pk_bf16_f32 v90, v212, v213
    v_cvt_pk_bf16_f32 v91, v214, v215
    s_add_u32 s19, s29, 294912
    buffer_store_dwordx4 v[88:91], v78, s[8:11], s19 offen offset:2048 sc1
    v_cvt_pk_bf16_f32 v92, v216, v217
    v_cvt_pk_bf16_f32 v93, v218, v219
    v_cvt_pk_bf16_f32 v94, v220, v221
    v_cvt_pk_bf16_f32 v95, v222, v223
    s_add_u32 s19, s29, 294912
    buffer_store_dwordx4 v[92:95], v78, s[8:11], s19 offen offset:3072 sc1
    v_pk_mul_f32 v[96:97], v[224:225], v[224:225]
    v_pk_mul_f32 v[98:99], v[226:227], v[226:227]
    v_fma_f32 v96, v96, s41, v100
    v_fma_f32 v97, v97, s41, v100
    v_fma_f32 v98, v98, s41, v100
    v_fma_f32 v99, v99, s41, v100
    v_pk_mul_f32 v[96:97], v[96:97], v[224:225]
    v_pk_mul_f32 v[98:99], v[98:99], v[226:227]
    v_exp_f32 v96, v96
    v_exp_f32 v97, v97
    v_exp_f32 v98, v98
    v_exp_f32 v99, v99
    v_add_f32 v96, 1.0, v96
    v_add_f32 v97, 1.0, v97
    v_add_f32 v98, 1.0, v98
    v_add_f32 v99, 1.0, v99
    v_rcp_f32 v96, v96
    v_rcp_f32 v97, v97
    v_rcp_f32 v98, v98
    v_rcp_f32 v99, v99
    v_pk_mul_f32 v[224:225], v[224:225], v[96:97]
    v_pk_mul_f32 v[226:227], v[226:227], v[98:99]
    v_pk_mul_f32 v[96:97], v[228:229], v[228:229]
    v_pk_mul_f32 v[98:99], v[230:231], v[230:231]
    v_fma_f32 v96, v96, s41, v100
    v_fma_f32 v97, v97, s41, v100
    v_fma_f32 v98, v98, s41, v100
    v_fma_f32 v99, v99, s41, v100
    v_pk_mul_f32 v[96:97], v[96:97], v[228:229]
    v_pk_mul_f32 v[98:99], v[98:99], v[230:231]
    v_exp_f32 v96, v96
    v_exp_f32 v97, v97
    v_exp_f32 v98, v98
    v_exp_f32 v99, v99
    v_add_f32 v96, 1.0, v96
    v_add_f32 v97, 1.0, v97
    v_add_f32 v98, 1.0, v98
    v_add_f32 v99, 1.0, v99
    v_rcp_f32 v96, v96
    v_rcp_f32 v97, v97
    v_rcp_f32 v98, v98
    v_rcp_f32 v99, v99
    v_pk_mul_f32 v[228:229], v[228:229], v[96:97]
    v_pk_mul_f32 v[230:231], v[230:231], v[98:99]
    v_pk_mul_f32 v[96:97], v[232:233], v[232:233]
    v_pk_mul_f32 v[98:99], v[234:235], v[234:235]
    v_fma_f32 v96, v96, s41, v100
    v_fma_f32 v97, v97, s41, v100
    v_fma_f32 v98, v98, s41, v100
    v_fma_f32 v99, v99, s41, v100
    v_pk_mul_f32 v[96:97], v[96:97], v[232:233]
    v_pk_mul_f32 v[98:99], v[98:99], v[234:235]
    v_exp_f32 v96, v96
    v_exp_f32 v97, v97
    v_exp_f32 v98, v98
    v_exp_f32 v99, v99
    v_add_f32 v96, 1.0, v96
    v_add_f32 v97, 1.0, v97
    v_add_f32 v98, 1.0, v98
    v_add_f32 v99, 1.0, v99
    v_rcp_f32 v96, v96
    v_rcp_f32 v97, v97
    v_rcp_f32 v98, v98
    v_rcp_f32 v99, v99
    v_pk_mul_f32 v[232:233], v[232:233], v[96:97]
    v_pk_mul_f32 v[234:235], v[234:235], v[98:99]
    v_pk_mul_f32 v[96:97], v[236:237], v[236:237]
    v_pk_mul_f32 v[98:99], v[238:239], v[238:239]
    v_fma_f32 v96, v96, s41, v100
    v_fma_f32 v97, v97, s41, v100
    v_fma_f32 v98, v98, s41, v100
    v_fma_f32 v99, v99, s41, v100
    v_pk_mul_f32 v[96:97], v[96:97], v[236:237]
    v_pk_mul_f32 v[98:99], v[98:99], v[238:239]
    v_exp_f32 v96, v96
    v_exp_f32 v97, v97
    v_exp_f32 v98, v98
    v_exp_f32 v99, v99
    v_add_f32 v96, 1.0, v96
    v_add_f32 v97, 1.0, v97
    v_add_f32 v98, 1.0, v98
    v_add_f32 v99, 1.0, v99
    v_rcp_f32 v96, v96
    v_rcp_f32 v97, v97
    v_rcp_f32 v98, v98
    v_rcp_f32 v99, v99
    v_pk_mul_f32 v[236:237], v[236:237], v[96:97]
    v_pk_mul_f32 v[238:239], v[238:239], v[98:99]
    v_cvt_pk_bf16_f32 v80, v224, v225
    v_cvt_pk_bf16_f32 v81, v226, v227
    v_cvt_pk_bf16_f32 v82, v228, v229
    v_cvt_pk_bf16_f32 v83, v230, v231
    s_add_u32 s19, s29, 299008
    buffer_store_dwordx4 v[80:83], v78, s[8:11], s19 offen offset:0 sc1
    v_cvt_pk_bf16_f32 v84, v232, v233
    v_cvt_pk_bf16_f32 v85, v234, v235
    v_cvt_pk_bf16_f32 v86, v236, v237
    v_cvt_pk_bf16_f32 v87, v238, v239
    s_add_u32 s19, s29, 299008
    buffer_store_dwordx4 v[84:87], v78, s[8:11], s19 offen offset:1024 sc1
    v_pk_mul_f32 v[96:97], v[240:241], v[240:241]
    v_pk_mul_f32 v[98:99], v[242:243], v[242:243]
    v_fma_f32 v96, v96, s41, v100
    v_fma_f32 v97, v97, s41, v100
    v_fma_f32 v98, v98, s41, v100
    v_fma_f32 v99, v99, s41, v100
    v_pk_mul_f32 v[96:97], v[96:97], v[240:241]
    v_pk_mul_f32 v[98:99], v[98:99], v[242:243]
    v_exp_f32 v96, v96
    v_exp_f32 v97, v97
    v_exp_f32 v98, v98
    v_exp_f32 v99, v99
    v_add_f32 v96, 1.0, v96
    v_add_f32 v97, 1.0, v97
    v_add_f32 v98, 1.0, v98
    v_add_f32 v99, 1.0, v99
    v_rcp_f32 v96, v96
    v_rcp_f32 v97, v97
    v_rcp_f32 v98, v98
    v_rcp_f32 v99, v99
    v_pk_mul_f32 v[240:241], v[240:241], v[96:97]
    v_pk_mul_f32 v[242:243], v[242:243], v[98:99]
    v_pk_mul_f32 v[96:97], v[244:245], v[244:245]
    v_pk_mul_f32 v[98:99], v[246:247], v[246:247]
    v_fma_f32 v96, v96, s41, v100
    v_fma_f32 v97, v97, s41, v100
    v_fma_f32 v98, v98, s41, v100
    v_fma_f32 v99, v99, s41, v100
    v_pk_mul_f32 v[96:97], v[96:97], v[244:245]
    v_pk_mul_f32 v[98:99], v[98:99], v[246:247]
    v_exp_f32 v96, v96
    v_exp_f32 v97, v97
    v_exp_f32 v98, v98
    v_exp_f32 v99, v99
    v_add_f32 v96, 1.0, v96
    v_add_f32 v97, 1.0, v97
    v_add_f32 v98, 1.0, v98
    v_add_f32 v99, 1.0, v99
    v_rcp_f32 v96, v96
    v_rcp_f32 v97, v97
    v_rcp_f32 v98, v98
    v_rcp_f32 v99, v99
    v_pk_mul_f32 v[244:245], v[244:245], v[96:97]
    v_pk_mul_f32 v[246:247], v[246:247], v[98:99]
    v_pk_mul_f32 v[96:97], v[248:249], v[248:249]
    v_pk_mul_f32 v[98:99], v[250:251], v[250:251]
    v_fma_f32 v96, v96, s41, v100
    v_fma_f32 v97, v97, s41, v100
    v_fma_f32 v98, v98, s41, v100
    v_fma_f32 v99, v99, s41, v100
    v_pk_mul_f32 v[96:97], v[96:97], v[248:249]
    v_pk_mul_f32 v[98:99], v[98:99], v[250:251]
    v_exp_f32 v96, v96
    v_exp_f32 v97, v97
    v_exp_f32 v98, v98
    v_exp_f32 v99, v99
    v_add_f32 v96, 1.0, v96
    v_add_f32 v97, 1.0, v97
    v_add_f32 v98, 1.0, v98
    v_add_f32 v99, 1.0, v99
    v_rcp_f32 v96, v96
    v_rcp_f32 v97, v97
    v_rcp_f32 v98, v98
    v_rcp_f32 v99, v99
    v_pk_mul_f32 v[248:249], v[248:249], v[96:97]
    v_pk_mul_f32 v[250:251], v[250:251], v[98:99]
    v_pk_mul_f32 v[96:97], v[252:253], v[252:253]
    v_pk_mul_f32 v[98:99], v[254:255], v[254:255]
    v_fma_f32 v96, v96, s41, v100
    v_fma_f32 v97, v97, s41, v100
    v_fma_f32 v98, v98, s41, v100
    v_fma_f32 v99, v99, s41, v100
    v_pk_mul_f32 v[96:97], v[96:97], v[252:253]
    v_pk_mul_f32 v[98:99], v[98:99], v[254:255]
    v_exp_f32 v96, v96
    v_exp_f32 v97, v97
    v_exp_f32 v98, v98
    v_exp_f32 v99, v99
    v_add_f32 v96, 1.0, v96
    v_add_f32 v97, 1.0, v97
    v_add_f32 v98, 1.0, v98
    v_add_f32 v99, 1.0, v99
    v_rcp_f32 v96, v96
    v_rcp_f32 v97, v97
    v_rcp_f32 v98, v98
    v_rcp_f32 v99, v99
    v_pk_mul_f32 v[252:253], v[252:253], v[96:97]
    v_pk_mul_f32 v[254:255], v[254:255], v[98:99]
    v_cvt_pk_bf16_f32 v88, v240, v241
    v_cvt_pk_bf16_f32 v89, v242, v243
    v_cvt_pk_bf16_f32 v90, v244, v245
    v_cvt_pk_bf16_f32 v91, v246, v247
    s_add_u32 s19, s29, 299008
    buffer_store_dwordx4 v[88:91], v78, s[8:11], s19 offen offset:2048 sc1
    v_cvt_pk_bf16_f32 v92, v248, v249
    v_cvt_pk_bf16_f32 v93, v250, v251
    v_cvt_pk_bf16_f32 v94, v252, v253
    v_cvt_pk_bf16_f32 v95, v254, v255
    s_add_u32 s19, s29, 299008
    buffer_store_dwordx4 v[92:95], v78, s[8:11], s19 offen offset:3072 sc1
    s_branch L_gm_sig
L_gm_run_m2:
    s_lshl_b32 s45, s43, 3
    s_lshl_b32 s19, s17, 1
    s_add_u32 s45, s45, s19
    v_lshlrev_b32 v69, 4, v0
    v_lshrrev_b32 v70, 5, v0
    v_bfe_u32 v71, v0, 2, 2
    v_lshl_add_u32 v72, v70, 2, v71
    s_movk_i32 s19, 192
    v_mul_lo_u32 v72, v72, s19
    v_bfe_u32 v73, v0, 4, 1
    v_and_b32 v74, 3, v0
    v_lshlrev_b32 v73, 5, v73
    v_lshl_add_u32 v73, v74, 3, v73
    v_add_u32 v72, v72, v73
    v_mov_b32 v66, v72
    v_add_u32 v70, 0, v0
    s_mov_b32 s19, 0x15556
    v_mul_lo_u32 v71, v70, s19
    v_lshrrev_b32 v71, 20, v71
    s_movk_i32 s19, 12
    v_mul_lo_u32 v72, v71, s19
    v_sub_u32 v72, v70, v72
    s_movk_i32 s19, 1152
    v_mul_lo_u32 v71, v71, s19
    v_lshl_add_u32 v67, v72, 4, v71
    v_add_u32 v70, 64, v0
    s_mov_b32 s19, 0x15556
    v_mul_lo_u32 v71, v70, s19
    v_lshrrev_b32 v71, 20, v71
    s_movk_i32 s19, 12
    v_mul_lo_u32 v72, v71, s19
    v_sub_u32 v72, v70, v72
    s_movk_i32 s19, 1152
    v_mul_lo_u32 v71, v71, s19
    v_lshl_add_u32 v68, v72, 4, v71
    v_mov_b32 v73, 0x40000000
    v_cmp_gt_u32 vcc, 96, v70
    s_nop 1
    v_cndmask_b32 v68, v73, v68, vcc
    s_mul_i32 s31, s17, 1536
    s_mov_b32 s12, s58
    s_mov_b32 s13, s59
    s_mov_b32 s14, 0x510000
    s_mov_b32 s15, 0x20000
    s_mul_i32 s46, s44, 43
    s_lshr_b32 s46, s46, 8
    s_mul_i32 s47, s46, 6
    s_sub_u32 s47, s44, s47
    s_mul_i32 s25, s46, 1327104
    s_mul_i32 s19, s47, 192
    s_add_u32 s25, s25, s19
    s_mul_i32 s19, s17, 9216
    s_add_u32 s25, s25, s19
    s_mul_i32 s24, s45, 294912
    s_mul_i32 s19, s46, 73728
    s_add_u32 s24, s24, s19
    s_add_u32 s24, s24, 0x5000000
    s_mov_b32 s30, 294912
    s_lshl_b32 s29, s46, 6
    s_add_u32 s29, s29, s45
    s_mul_i32 s29, s29, 18
    s_mul_i32 s19, s47, 3
    s_add_u32 s29, s29, s19
    s_lshl_b32 s29, s29, 12
    s_add_u32 s29, s29, 0x7400000
    s_add_u32 s23, s24, s30
    s_mov_b32 s26, 0
    s_mov_b32 s27, 0
    s_barrier
    s_add_u32 m0, s26, s31
    s_nop 0
    buffer_load_dwordx4 v67, s[12:15], s25 offen lds
    s_add_u32 m0, m0, 1024
    s_mov_b32 exec_hi, 0
    buffer_load_dwordx4 v68, s[12:15], s25 offen lds
    s_mov_b32 exec_hi, -1
    s_add_u32 s25, s25, 36864
    s_add_u32 s26, s26, 6144
    s_cmp_eq_u32 s26, 24576
    s_cselect_b32 s26, 0, s26
    buffer_load_dwordx4 v[16:19], v69, s[8:11], s24 offen offset:0
    buffer_load_dwordx4 v[20:23], v69, s[8:11], s23 offen offset:0
    buffer_load_dwordx4 v[24:27], v69, s[8:11], s24 offen offset:1024
    buffer_load_dwordx4 v[28:31], v69, s[8:11], s23 offen offset:1024
    s_add_u32 s24, s24, 2048
    s_add_u32 s23, s23, 2048
    s_add_u32 m0, s26, s31
    s_nop 0
    buffer_load_dwordx4 v67, s[12:15], s25 offen lds
    s_add_u32 m0, m0, 1024
    s_mov_b32 exec_hi, 0
    buffer_load_dwordx4 v68, s[12:15], s25 offen lds
    s_mov_b32 exec_hi, -1
    s_add_u32 s25, s25, 36864
    s_add_u32 s26, s26, 6144
    s_cmp_eq_u32 s26, 24576
    s_cselect_b32 s26, 0, s26
    buffer_load_dwordx4 v[32:35], v69, s[8:11], s24 offen offset:0
    buffer_load_dwordx4 v[36:39], v69, s[8:11], s23 offen offset:0
    buffer_load_dwordx4 v[40:43], v69, s[8:11], s24 offen offset:1024
    buffer_load_dwordx4 v[44:47], v69, s[8:11], s23 offen offset:1024
    s_add_u32 s24, s24, 2048
    s_add_u32 s23, s23, 2048
    s_add_u32 m0, s26, s31
    s_nop 0
    buffer_load_dwordx4 v67, s[12:15], s25 offen lds
    s_add_u32 m0, m0, 1024
    s_mov_b32 exec_hi, 0
    buffer_load_dwordx4 v68, s[12:15], s25 offen lds
    s_mov_b32 exec_hi, -1
    s_add_u32 s25, s25, 36864
    s_add_u32 s26, s26, 6144
    s_cmp_eq_u32 s26, 24576
    s_cselect_b32 s26, 0, s26
    v_mov_b64 v[160:161], 0
    v_mov_b64 v[162:163], 0
    v_mov_b64 v[164:165], 0
    v_mov_b64 v[166:167], 0
    v_mov_b64 v[168:169], 0
    v_mov_b64 v[170:171], 0
    v_mov_b64 v[172:173], 0
    v_mov_b64 v[174:175], 0
    v_mov_b64 v[176:177], 0
    v_mov_b64 v[178:179], 0
    v_mov_b64 v[180:181], 0
    v_mov_b64 v[182:183], 0
    v_mov_b64 v[184:185], 0
    v_mov_b64 v[186:187], 0
    v_mov_b64 v[188:189], 0
    v_mov_b64 v[190:191], 0
    v_mov_b64 v[192:193], 0
    v_mov_b64 v[194:195], 0
    v_mov_b64 v[196:197], 0
    v_mov_b64 v[198:199], 0
    v_mov_b64 v[200:201], 0
    v_mov_b64 v[202:203], 0
    v_mov_b64 v[204:205], 0
    v_mov_b64 v[206:207], 0
    v_mov_b64 v[208:209], 0
    v_mov_b64 v[210:211], 0
    v_mov_b64 v[212:213], 0
    v_mov_b64 v[214:215], 0
    v_mov_b64 v[216:217], 0
    v_mov_b64 v[218:219], 0
    v_mov_b64 v[220:221], 0
    v_mov_b64 v[222:223], 0
    v_mov_b64 v[224:225], 0
    v_mov_b64 v[226:227], 0
    v_mov_b64 v[228:229], 0
    v_mov_b64 v[230:231], 0
    v_mov_b64 v[232:233], 0
    v_mov_b64 v[234:235], 0
    v_mov_b64 v[236:237], 0
    v_mov_b64 v[238:239], 0
    v_mov_b64 v[240:241], 0
    v_mov_b64 v[242:243], 0
    v_mov_b64 v[244:245], 0
    v_mov_b64 v[246:247], 0
    v_mov_b64 v[248:249], 0
    v_mov_b64 v[250:251], 0
    v_mov_b64 v[252:253], 0
    v_mov_b64 v[254:255], 0
    s_waitcnt vmcnt(12)
    s_barrier
    v_add_u32 v64, s27, v66
    s_add_u32 s27, s27, 6144
    s_cmp_eq_u32 s27, 24576
    s_cselect_b32 s27, 0, s27
    ds_read_b64_tr_b16 v[48:49], v64 offset:0
    ds_read_b64_tr_b16 v[50:51], v64 offset:1536
    ds_read_b64_tr_b16 v[52:53], v64 offset:64
    ds_read_b64_tr_b16 v[54:55], v64 offset:1600
    ds_read_b64_tr_b16 v[56:57], v64 offset:128
    ds_read_b64_tr_b16 v[58:59], v64 offset:1664
    s_mov_b32 s28, 18
L_g2m_m2_loop:
    s_cmp_eq_u32 s28, 1
    s_cselect_b32 s24, 0x40000000, s24
    s_cselect_b32 s23, 0x40000000, s23
    ds_read_b64_tr_b16 v[60:61], v64 offset:3072
    ds_read_b64_tr_b16 v[62:63], v64 offset:4608
    s_waitcnt vmcnt(11) lgkmcnt(6)
    v_mfma_f32_32x32x16_bf16 v[160:175], v[48:51], v[16:19], v[160:175]
    s_waitcnt vmcnt(10)
    v_mfma_f32_32x32x16_bf16 v[208:223], v[48:51], v[20:23], v[208:223]
    ds_read_b64_tr_b16 v[48:49], v64 offset:3136
    ds_read_b64_tr_b16 v[50:51], v64 offset:4672
    s_waitcnt lgkmcnt(6)
    v_mfma_f32_32x32x16_bf16 v[176:191], v[52:55], v[16:19], v[176:191]
    v_mfma_f32_32x32x16_bf16 v[224:239], v[52:55], v[20:23], v[224:239]
    ds_read_b64_tr_b16 v[52:53], v64 offset:3200
    ds_read_b64_tr_b16 v[54:55], v64 offset:4736
    s_waitcnt lgkmcnt(6)
    v_mfma_f32_32x32x16_bf16 v[192:207], v[56:59], v[16:19], v[192:207]
    v_mfma_f32_32x32x16_bf16 v[240:255], v[56:59], v[20:23], v[240:255]
    buffer_load_dwordx4 v[16:19], v69, s[8:11], s24 offen offset:0
    buffer_load_dwordx4 v[20:23], v69, s[8:11], s23 offen offset:0
    s_waitcnt vmcnt(8)
    s_barrier
    v_add_u32 v65, s27, v66
    s_add_u32 s27, s27, 6144
    s_cmp_eq_u32 s27, 24576
    s_cselect_b32 s27, 0, s27
    s_add_u32 m0, s26, s31
    s_nop 0
    buffer_load_dwordx4 v67, s[12:15], s25 offen lds
    s_add_u32 m0, m0, 1024
    s_mov_b32 exec_hi, 0
    buffer_load_dwordx4 v68, s[12:15], s25 offen lds
    s_mov_b32 exec_hi, -1
    s_add_u32 s25, s25, 36864
    s_add_u32 s26, s26, 6144
    s_cmp_eq_u32 s26, 24576
    s_cselect_b32 s26, 0, s26
    ds_read_b64_tr_b16 v[56:57], v65 offset:0
    ds_read_b64_tr_b16 v[58:59], v65 offset:1536
    s_waitcnt lgkmcnt(6)
    v_mfma_f32_32x32x16_bf16 v[160:175], v[60:63], v[24:27], v[160:175]
    v_mfma_f32_32x32x16_bf16 v[208:223], v[60:63], v[28:31], v[208:223]
    ds_read_b64_tr_b16 v[60:61], v65 offset:64
    ds_read_b64_tr_b16 v[62:63], v65 offset:1600
    s_waitcnt lgkmcnt(6)
    v_mfma_f32_32x32x16_bf16 v[176:191], v[48:51], v[24:27], v[176:191]
    v_mfma_f32_32x32x16_bf16 v[224:239], v[48:51], v[28:31], v[224:239]
    ds_read_b64_tr_b16 v[48:49], v65 offset:128
    ds_read_b64_tr_b16 v[50:51], v65 offset:1664
    s_waitcnt lgkmcnt(6)
    v_mfma_f32_32x32x16_bf16 v[192:207], v[52:55], v[24:27], v[192:207]
    v_mfma_f32_32x32x16_bf16 v[240:255], v[52:55], v[28:31], v[240:255]
    buffer_load_dwordx4 v[24:27], v69, s[8:11], s24 offen offset:1024
    buffer_load_dwordx4 v[28:31], v69, s[8:11], s23 offen offset:1024
    s_add_u32 s24, s24, 2048
    s_add_u32 s23, s23, 2048
    ds_read_b64_tr_b16 v[52:53], v65 offset:3072
    ds_read_b64_tr_b16 v[54:55], v65 offset:4608
    s_waitcnt vmcnt(11) lgkmcnt(6)
    v_mfma_f32_32x32x16_bf16 v[160:175], v[56:59], v[32:35], v[160:175]
    s_waitcnt vmcnt(10)
    v_mfma_f32_32x32x16_bf16 v[208:223], v[56:59], v[36:39], v[208:223]
    ds_read_b64_tr_b16 v[56:57], v65 offset:3136
    ds_read_b64_tr_b16 v[58:59], v65 offset:4672
    s_waitcnt lgkmcnt(6)
    v_mfma_f32_32x32x16_bf16 v[176:191], v[60:63], v[32:35], v[176:191]
    v_mfma_f32_32x32x16_bf16 v[224:239], v[60:63], v[36:39], v[224:239]
    ds_read_b64_tr_b16 v[60:61], v65 offset:3200
    ds_read_b64_tr_b16 v[62:63], v65 offset:4736
    s_waitcnt lgkmcnt(6)
    v_mfma_f32_32x32x16_bf16 v[192:207], v[48:51], v[32:35], v[192:207]
    v_mfma_f32_32x32x16_bf16 v[240:255], v[48:51], v[36:39], v[240:255]
    buffer_load_dwordx4 v[32:35], v69, s[8:11], s24 offen offset:0
    buffer_load_dwordx4 v[36:39], v69, s[8:11], s23 offen offset:0
    s_waitcnt vmcnt(8)
    s_barrier
    v_add_u32 v64, s27, v66
    s_add_u32 s27, s27, 6144
    s_cmp_eq_u32 s27, 24576
    s_cselect_b32 s27, 0, s27
    s_add_u32 m0, s26, s31
    s_nop 0
    buffer_load_dwordx4 v67, s[12:15], s25 offen lds
    s_add_u32 m0, m0, 1024
    s_mov_b32 exec_hi, 0
    buffer_load_dwordx4 v68, s[12:15], s25 offen lds
    s_mov_b32 exec_hi, -1
    s_add_u32 s25, s25, 36864
    s_add_u32 s26, s26, 6144
    s_cmp_eq_u32 s26, 24576
    s_cselect_b32 s26, 0, s26
    ds_read_b64_tr_b16 v[48:49], v64 offset:0
    ds_read_b64_tr_b16 v[50:51], v64 offset:1536
    s_waitcnt lgkmcnt(6)
    v_mfma_f32_32x32x16_bf16 v[160:175], v[52:55], v[40:43], v[160:175]
    v_mfma_f32_32x32x16_bf16 v[208:223], v[52:55], v[44:47], v[208:223]
    ds_read_b64_tr_b16 v[52:53], v64 offset:64
    ds_read_b64_tr_b16 v[54:55], v64 offset:1600
    s_waitcnt lgkmcnt(6)
    v_mfma_f32_32x32x16_bf16 v[176:191], v[56:59], v[40:43], v[176:191]
    v_mfma_f32_32x32x16_bf16 v[224:239], v[56:59], v[44:47], v[224:239]
    ds_read_b64_tr_b16 v[56:57], v64 offset:128
    ds_read_b64_tr_b16 v[58:59], v64 offset:1664
    s_waitcnt lgkmcnt(6)
    v_mfma_f32_32x32x16_bf16 v[192:207], v[60:63], v[40:43], v[192:207]
    v_mfma_f32_32x32x16_bf16 v[240:255], v[60:63], v[44:47], v[240:255]
    buffer_load_dwordx4 v[40:43], v69, s[8:11], s24 offen offset:1024
    buffer_load_dwordx4 v[44:47], v69, s[8:11], s23 offen offset:1024
    s_add_u32 s24, s24, 2048
    s_add_u32 s23, s23, 2048
    s_sub_u32 s28, s28, 1
    s_cmp_lg_u32 s28, 0
    s_cbranch_scc1 L_g2m_m2_loop
    s_add_u32 s19, s29, 0
    buffer_store_dwordx4 v[160:163], v69, s[8:11], s19 offen offset:0 sc1
    buffer_store_dwordx4 v[164:167], v69, s[8:11], s19 offen offset:1024 sc1
    buffer_store_dwordx4 v[168:171], v69, s[8:11], s19 offen offset:2048 sc1
    buffer_store_dwordx4 v[172:175], v69, s[8:11], s19 offen offset:3072 sc1
    s_add_u32 s19, s29, 4096
    buffer_store_dwordx4 v[176:179], v69, s[8:11], s19 offen offset:0 sc1
    buffer_store_dwordx4 v[180:183], v69, s[8:11], s19 offen offset:1024 sc1
    buffer_store_dwordx4 v[184:187], v69, s[8:11], s19 offen offset:2048 sc1
    buffer_store_dwordx4 v[188:191], v69, s[8:11], s19 offen offset:3072 sc1
    s_add_u32 s19, s29, 8192
    buffer_store_dwordx4 v[192:195], v69, s[8:11], s19 offen offset:0 sc1
    buffer_store_dwordx4 v[196:199], v69, s[8:11], s19 offen offset:1024 sc1
    buffer_store_dwordx4 v[200:203], v69, s[8:11], s19 offen offset:2048 sc1
    buffer_store_dwordx4 v[204:207], v69, s[8:11], s19 offen offset:3072 sc1
    s_add_u32 s19, s29, 73728
    buffer_store_dwordx4 v[208:211], v69, s[8:11], s19 offen offset:0 sc1
    buffer_store_dwordx4 v[212:215], v69, s[8:11], s19 offen offset:1024 sc1
    buffer_store_dwordx4 v[216:219], v69, s[8:11], s19 offen offset:2048 sc1
    buffer_store_dwordx4 v[220:223], v69, s[8:11], s19 offen offset:3072 sc1
    s_add_u32 s19, s29, 77824
    buffer_store_dwordx4 v[224:227], v69, s[8:11], s19 offen offset:0 sc1
    buffer_store_dwordx4 v[228:231], v69, s[8:11], s19 offen offset:1024 sc1
    buffer_store_dwordx4 v[232:235], v69, s[8:11], s19 offen offset:2048 sc1
    buffer_store_dwordx4 v[236:239], v69, s[8:11], s19 offen offset:3072 sc1
    s_add_u32 s19, s29, 81920
    buffer_store_dwordx4 v[240:243], v69, s[8:11], s19 offen offset:0 sc1
    buffer_store_dwordx4 v[244:247], v69, s[8:11], s19 offen offset:1024 sc1
    buffer_store_dwordx4 v[248:251], v69, s[8:11], s19 offen offset:2048 sc1
    buffer_store_dwordx4 v[252:255], v69, s[8:11], s19 offen offset:3072 sc1
    s_branch L_gm_sig
L_gm_first:
    s_lshr_b32 s43, s60, 6
    s_and_b32 s44, s60, 63
    s_mov_b32 s63, 0x200480
    s_mov_b32 s61, 1
    s_mov_b32 s60, 0
    s_lshl_b32 s45, s43, 2
    s_add_u32 s45, s45, s17
    v_lshlrev_b32 v62, 4, v0
    v_lshrrev_b32 v64, 5, v0
    v_bfe_u32 v65, v0, 2, 2
    v_lshl_add_u32 v66, v64, 2, v65
    s_movk_i32 s19, 256
    v_mul_lo_u32 v66, v66, s19
    v_bfe_u32 v67, v0, 4, 1
    v_and_b32 v68, 3, v0
    v_lshlrev_b32 v67, 5, v67
    v_lshl_add_u32 v67, v68, 3, v67
    v_add_u32 v66, v66, v67
    v_xor_b32 v68, 0, v65
    v_lshl_add_u32 v56, v68, 6, v66
    v_xor_b32 v68, 1, v65
    v_lshl_add_u32 v57, v68, 6, v66
    v_xor_b32 v68, 2, v65
    v_lshl_add_u32 v58, v68, 6, v66
    v_xor_b32 v68, 3, v65
    v_lshl_add_u32 v59, v68, 6, v66
    v_add_u32 v64, 0, v0
    s_mov_b32 s19, 0x10001
    v_mul_lo_u32 v65, v64, s19
    v_lshrrev_b32 v65, 20, v65
    s_movk_i32 s19, 16
    v_mul_lo_u32 v66, v65, s19
    v_sub_u32 v66, v64, v66
    v_and_b32 v67, 3, v65
    v_lshrrev_b32 v68, 2, v66
    v_xor_b32 v68, v68, v67
    v_and_b32 v66, 3, v66
    v_lshl_add_u32 v66, v68, 2, v66
    s_movk_i32 s19, 8192
    v_mul_lo_u32 v65, v65, s19
    v_lshl_add_u32 v60, v66, 4, v65
    v_add_u32 v64, 64, v0
    s_mov_b32 s19, 0x10001
    v_mul_lo_u32 v65, v64, s19
    v_lshrrev_b32 v65, 20, v65
    s_movk_i32 s19, 16
    v_mul_lo_u32 v66, v65, s19
    v_sub_u32 v66, v64, v66
    v_and_b32 v67, 3, v65
    v_lshrrev_b32 v68, 2, v66
    v_xor_b32 v68, v68, v67
    v_and_b32 v66, 3, v66
    v_lshl_add_u32 v66, v68, 2, v66
    s_movk_i32 s19, 8192
    v_mul_lo_u32 v65, v65, s19
    v_lshl_add_u32 v61, v66, 4, v65
    s_mul_i32 s31, s17, 2048
    s_lshr_b32 s46, s44, 5
    s_and_b32 s47, s44, 31
    s_mov_b32 s12, s48
    s_mov_b32 s13, s49
    s_cmp_eq_u32 s46, 1
    s_cselect_b32 s12, s50, s12
    s_cselect_b32 s13, s51, s13
    s_cmp_eq_u32 s46, 2
    s_cselect_b32 s12, s52, s12
    s_cselect_b32 s13, s53, s13
    s_mov_b32 s14, 0x480000
    s_mov_b32 s15, 0x20000
    s_lshl_b32 s25, s47, 8
    s_mul_i32 s19, s17, 65536
    s_add_u32 s25, s25, s19
    s_mul_i32 s24, s45, 36864
    s_add_u32 s24, s24, 0x6400000
    s_mov_b32 s30, 36864
    s_lshl_b32 s29, s45, 5
    s_add_u32 s29, s29, s47
    s_lshl_b32 s29, s29, 13
    s_lshl_b32 s19, s46, 24
    s_add_u32 s29, s29, s19
    s_add_u32 s29, s29, 0x1000000
    s_mov_b32 s26, 0
    s_mov_b32 s27, 0
    s_barrier
    s_add_u32 m0, s26, s31
    s_nop 0
    buffer_load_dwordx4 v60, s[12:15], s25 offen lds
    s_add_u32 m0, m0, 1024
    s_nop 0
    buffer_load_dwordx4 v61, s[12:15], s25 offen lds
    s_add_u32 s25, s25, 262144
    s_add_u32 s26, s26, 8192
    s_cmp_eq_u32 s26, 147456
    s_cselect_b32 s26, 0, s26
    s_add_u32 m0, s26, s31
    s_nop 0
    buffer_load_dwordx4 v60, s[12:15], s25 offen lds
    s_add_u32 m0, m0, 1024
    s_nop 0
    buffer_load_dwordx4 v61, s[12:15], s25 offen lds
    s_add_u32 s25, s25, 262144
    s_add_u32 s26, s26, 8192
    s_cmp_eq_u32 s26, 147456
    s_cselect_b32 s26, 0, s26
    s_add_u32 m0, s26, s31
    s_nop 0
    buffer_load_dwordx4 v60, s[12:15], s25 offen lds
    s_add_u32 m0, m0, 1024
    s_nop 0
    buffer_load_dwordx4 v61, s[12:15], s25 offen lds
    s_add_u32 s25, s25, 262144
    s_add_u32 s26, s26, 8192
    s_cmp_eq_u32 s26, 147456
    s_cselect_b32 s26, 0, s26
    s_add_u32 m0, s26, s31
    s_nop 0
    buffer_load_dwordx4 v60, s[12:15], s25 offen lds
    s_add_u32 m0, m0, 1024
    s_nop 0
    buffer_load_dwordx4 v61, s[12:15], s25 offen lds
    s_add_u32 s25, s25, 262144
    s_add_u32 s26, s26, 8192
    s_cmp_eq_u32 s26, 147456
    s_cselect_b32 s26, 0, s26
    s_add_u32 m0, s26, s31
    s_nop 0
    buffer_load_dwordx4 v60, s[12:15], s25 offen lds
    s_add_u32 m0, m0, 1024
    s_nop 0
    buffer_load_dwordx4 v61, s[12:15], s25 offen lds
    s_add_u32 s25, s25, 262144
    s_add_u32 s26, s26, 8192
    s_cmp_eq_u32 s26, 147456
    s_cselect_b32 s26, 0, s26
    s_add_u32 m0, s26, s31
    s_nop 0
    buffer_load_dwordx4 v60, s[12:15], s25 offen lds
    s_add_u32 m0, m0, 1024
    s_nop 0
    buffer_load_dwordx4 v61, s[12:15], s25 offen lds
    s_add_u32 s25, s25, 262144
    s_add_u32 s26, s26, 8192
    s_cmp_eq_u32 s26, 147456
    s_cselect_b32 s26, 0, s26
    s_add_u32 m0, s26, s31
    s_nop 0
    buffer_load_dwordx4 v60, s[12:15], s25 offen lds
    s_add_u32 m0, m0, 1024
    s_nop 0
    buffer_load_dwordx4 v61, s[12:15], s25 offen lds
    s_add_u32 s25, s25, 262144
    s_add_u32 s26, s26, 8192
    s_cmp_eq_u32 s26, 147456
    s_cselect_b32 s26, 0, s26
    s_add_u32 m0, s26, s31
    s_nop 0
    buffer_load_dwordx4 v60, s[12:15], s25 offen lds
    s_add_u32 m0, m0, 1024
    s_nop 0
    buffer_load_dwordx4 v61, s[12:15], s25 offen lds
    s_add_u32 s25, s25, 262144
    s_add_u32 s26, s26, 8192
    s_cmp_eq_u32 s26, 147456
    s_cselect_b32 s26, 0, s26
    s_add_u32 m0, s26, s31
    s_nop 0
    buffer_load_dwordx4 v60, s[12:15], s25 offen lds
    s_add_u32 m0, m0, 1024
    s_nop 0
    buffer_load_dwordx4 v61, s[12:15], s25 offen lds
    s_add_u32 s25, s25, 262144
    s_add_u32 s26, s26, 8192
    s_cmp_eq_u32 s26, 147456
    s_cselect_b32 s26, 0, s26
    s_add_u32 m0, s26, s31
    s_nop 0
    buffer_load_dwordx4 v60, s[12:15], s25 offen lds
    s_add_u32 m0, m0, 1024
    s_nop 0
    buffer_load_dwordx4 v61, s[12:15], s25 offen lds
    s_add_u32 s25, s25, 262144
    s_add_u32 s26, s26, 8192
    s_cmp_eq_u32 s26, 147456
    s_cselect_b32 s26, 0, s26
    s_add_u32 m0, s26, s31
    s_nop 0
    buffer_load_dwordx4 v60, s[12:15], s25 offen lds
    s_add_u32 m0, m0, 1024
    s_nop 0
    buffer_load_dwordx4 v61, s[12:15], s25 offen lds
    s_add_u32 s25, s25, 262144
    s_add_u32 s26, s26, 8192
    s_cmp_eq_u32 s26, 147456
    s_cselect_b32 s26, 0, s26
    s_add_u32 m0, s26, s31
    s_nop 0
    buffer_load_dwordx4 v60, s[12:15], s25 offen lds
    s_add_u32 m0, m0, 1024
    s_nop 0
    buffer_load_dwordx4 v61, s[12:15], s25 offen lds
    s_add_u32 s25, s25, 262144
    s_add_u32 s26, s26, 8192
    s_cmp_eq_u32 s26, 147456
    s_cselect_b32 s26, 0, s26
    s_add_u32 m0, s26, s31
    s_nop 0
    buffer_load_dwordx4 v60, s[12:15], s25 offen lds
    s_add_u32 m0, m0, 1024
    s_nop 0
    buffer_load_dwordx4 v61, s[12:15], s25 offen lds
    s_add_u32 s25, s25, 262144
    s_add_u32 s26, s26, 8192
    s_cmp_eq_u32 s26, 147456
    s_cselect_b32 s26, 0, s26
    s_add_u32 m0, s26, s31
    s_nop 0
    buffer_load_dwordx4 v60, s[12:15], s25 offen lds
    s_add_u32 m0, m0, 1024
    s_nop 0
    buffer_load_dwordx4 v61, s[12:15], s25 offen lds
    s_add_u32 s25, s25, 262144
    s_add_u32 s26, s26, 8192
    s_cmp_eq_u32 s26, 147456
    s_cselect_b32 s26, 0, s26
    s_add_u32 m0, s26, s31
    s_nop 0
    buffer_load_dwordx4 v60, s[12:15], s25 offen lds
    s_add_u32 m0, m0, 1024
    s_nop 0
    buffer_load_dwordx4 v61, s[12:15], s25 offen lds
    s_add_u32 s25, s25, 262144
    s_add_u32 s26, s26, 8192
    s_cmp_eq_u32 s26, 147456
    s_cselect_b32 s26, 0, s26
    s_add_u32 m0, s26, s31
    s_nop 0
    buffer_load_dwordx4 v60, s[12:15], s25 offen lds
    s_add_u32 m0, m0, 1024
    s_nop 0
    buffer_load_dwordx4 v61, s[12:15], s25 offen lds
    s_add_u32 s25, s25, 262144
    s_add_u32 s26, s26, 8192
    s_cmp_eq_u32 s26, 147456
    s_cselect_b32 s26, 0, s26
    s_add_u32 m0, s26, s31
    s_nop 0
    buffer_load_dwordx4 v60, s[12:15], s25 offen lds
    s_add_u32 m0, m0, 1024
    s_nop 0
    buffer_load_dwordx4 v61, s[12:15], s25 offen lds
    s_add_u32 s25, s25, 262144
    s_add_u32 s26, s26, 8192
    s_cmp_eq_u32 s26, 147456
    s_cselect_b32 s26, 0, s26
    s_add_u32 m0, s26, s31
    s_nop 0
    buffer_load_dwordx4 v60, s[12:15], s25 offen lds
    s_add_u32 m0, m0, 1024
    s_nop 0
    buffer_load_dwordx4 v61, s[12:15], s25 offen lds
    s_add_u32 s25, s25, 262144
    s_add_u32 s26, s26, 8192
    s_cmp_eq_u32 s26, 147456
    s_cselect_b32 s26, 0, s26
    v_mov_b64 v[192:193], 0
    v_mov_b64 v[194:195], 0
    v_mov_b64 v[196:197], 0
    v_mov_b64 v[198:199], 0
    v_mov_b64 v[200:201], 0
    v_mov_b64 v[202:203], 0
    v_mov_b64 v[204:205], 0
    v_mov_b64 v[206:207], 0
    v_mov_b64 v[208:209], 0
    v_mov_b64 v[210:211], 0
    v_mov_b64 v[212:213], 0
    v_mov_b64 v[214:215], 0
    v_mov_b64 v[216:217], 0
    v_mov_b64 v[218:219], 0
    v_mov_b64 v[220:221], 0
    v_mov_b64 v[222:223], 0
    v_mov_b64 v[224:225], 0
    v_mov_b64 v[226:227], 0
    v_mov_b64 v[228:229], 0
    v_mov_b64 v[230:231], 0
    v_mov_b64 v[232:233], 0
    v_mov_b64 v[234:235], 0
    v_mov_b64 v[236:237], 0
    v_mov_b64 v[238:239], 0
    v_mov_b64 v[240:241], 0
    v_mov_b64 v[242:243], 0
    v_mov_b64 v[244:245], 0
    v_mov_b64 v[246:247], 0
    v_mov_b64 v[248:249], 0
    v_mov_b64 v[250:251], 0
    v_mov_b64 v[252:253], 0
    v_mov_b64 v[254:255], 0
    s_mov_b32 s62, 0x200080
    s_cmp_eq_u32 s17, 0
    s_cbranch_scc0 L_wgw_10
    s_mov_b32 s20, s3
L_pg_11:
    s_mov_b64 exec, 1
    buffer_load_dword v2, off, s[8:11], s62 sc1
    s_waitcnt vmcnt(0)
    s_nop 0
    v_readfirstlane_b32 s19, v2
    s_mov_b64 exec, -1
    s_cmp_ge_u32 s19, 16
    s_cbranch_scc1 L_pg_11_d
    s_sleep 4
    s_sub_u32 s20, s20, 1
    s_cmp_lg_u32 s20, 0
    s_cbranch_scc1 L_pg_11
    s_mov_b32 s3, 1
L_pg_11_d:
L_wgw_10:
    s_barrier
    buffer_load_dwordx4 v[16:19], v62, s[8:11], s24 offen offset:0
    buffer_load_dwordx4 v[20:23], v62, s[8:11], s24 offen offset:1024
    s_add_u32 s24, s24, 2048
    buffer_load_dwordx4 v[24:27], v62, s[8:11], s24 offen offset:0
    buffer_load_dwordx4 v[28:31], v62, s[8:11], s24 offen offset:1024
    s_add_u32 s24, s24, 2048
    s_waitcnt vmcnt(4)
    s_barrier
    v_add_u32 v48, s27, v56
    v_add_u32 v49, s27, v57
    v_add_u32 v50, s27, v58
    v_add_u32 v51, s27, v59
    s_add_u32 s27, s27, 8192
    s_cmp_eq_u32 s27, 147456
    s_cselect_b32 s27, 0, s27
    ds_read_b64_tr_b16 v[32:33], v48 offset:0
    ds_read_b64_tr_b16 v[34:35], v48 offset:2048
    ds_read_b64_tr_b16 v[36:37], v49 offset:0
    ds_read_b64_tr_b16 v[38:39], v49 offset:2048
    ds_read_b64_tr_b16 v[40:41], v50 offset:0
    ds_read_b64_tr_b16 v[42:43], v50 offset:2048
    s_mov_b32 s28, 9
    s_cmp_eq_u32 s46, 1
    s_cbranch_scc1 L_gf_v
L_gf_kq_loop:
    s_cmp_eq_u32 s28, 1
    s_cselect_b32 s24, 0x40000000, s24
    ds_read_b64_tr_b16 v[44:45], v51 offset:0
    ds_read_b64_tr_b16 v[46:47], v51 offset:2048
    s_waitcnt vmcnt(3) lgkmcnt(6)
    v_mfma_f32_32x32x16_bf16 v[192:207], v[32:35], v[16:19], v[192:207]
    ds_read_b64_tr_b16 v[32:33], v48 offset:4096
    ds_read_b64_tr_b16 v[34:35], v48 offset:6144
    s_waitcnt lgkmcnt(6)
    v_mfma_f32_32x32x16_bf16 v[208:223], v[36:39], v[16:19], v[208:223]
    ds_read_b64_tr_b16 v[36:37], v49 offset:4096
    ds_read_b64_tr_b16 v[38:39], v49 offset:6144
    s_waitcnt lgkmcnt(6)
    v_mfma_f32_32x32x16_bf16 v[224:239], v[40:43], v[16:19], v[224:239]
    ds_read_b64_tr_b16 v[40:41], v50 offset:4096
    ds_read_b64_tr_b16 v[42:43], v50 offset:6144
    s_waitcnt lgkmcnt(6)
    v_mfma_f32_32x32x16_bf16 v[240:255], v[44:47], v[16:19], v[240:255]
    buffer_load_dwordx4 v[16:19], v62, s[8:11], s24 offen offset:0
    v_add_u32 v52, s27, v56
    v_add_u32 v53, s27, v57
    v_add_u32 v54, s27, v58
    v_add_u32 v55, s27, v59
    s_add_u32 s27, s27, 8192
    s_cmp_eq_u32 s27, 147456
    s_cselect_b32 s27, 0, s27
    ds_read_b64_tr_b16 v[44:45], v51 offset:4096
    ds_read_b64_tr_b16 v[46:47], v51 offset:6144
    s_waitcnt vmcnt(3) lgkmcnt(6)
    v_mfma_f32_32x32x16_bf16 v[192:207], v[32:35], v[20:23], v[192:207]
    ds_read_b64_tr_b16 v[32:33], v52 offset:0
    ds_read_b64_tr_b16 v[34:35], v52 offset:2048
    s_waitcnt lgkmcnt(6)
    v_mfma_f32_32x32x16_bf16 v[208:223], v[36:39], v[20:23], v[208:223]
    ds_read_b64_tr_b16 v[36:37], v53 offset:0
    ds_read_b64_tr_b16 v[38:39], v53 offset:2048
    s_waitcnt lgkmcnt(6)
    v_mfma_f32_32x32x16_bf16 v[224:239], v[40:43], v[20:23], v[224:239]
    ds_read_b64_tr_b16 v[40:41], v54 offset:0
    ds_read_b64_tr_b16 v[42:43], v54 offset:2048
    s_waitcnt lgkmcnt(6)
    v_mfma_f32_32x32x16_bf16 v[240:255], v[44:47], v[20:23], v[240:255]
    buffer_load_dwordx4 v[20:23], v62, s[8:11], s24 offen offset:1024
    s_add_u32 s24, s24, 2048
    ds_read_b64_tr_b16 v[44:45], v55 offset:0
    ds_read_b64_tr_b16 v[46:47], v55 offset:2048
    s_waitcnt vmcnt(3) lgkmcnt(6)
    v_mfma_f32_32x32x16_bf16 v[192:207], v[32:35], v[24:27], v[192:207]
    ds_read_b64_tr_b16 v[32:33], v52 offset:4096
    ds_read_b64_tr_b16 v[34:35], v52 offset:6144
    s_waitcnt lgkmcnt(6)
    v_mfma_f32_32x32x16_bf16 v[208:223], v[36:39], v[24:27], v[208:223]
    ds_read_b64_tr_b16 v[36:37], v53 offset:4096
    ds_read_b64_tr_b16 v[38:39], v53 offset:6144
    s_waitcnt lgkmcnt(6)
    v_mfma_f32_32x32x16_bf16 v[224:239], v[40:43], v[24:27], v[224:239]
    ds_read_b64_tr_b16 v[40:41], v54 offset:4096
    ds_read_b64_tr_b16 v[42:43], v54 offset:6144
    s_waitcnt lgkmcnt(6)
    v_mfma_f32_32x32x16_bf16 v[240:255], v[44:47], v[24:27], v[240:255]
    buffer_load_dwordx4 v[24:27], v62, s[8:11], s24 offen offset:0
    v_add_u32 v48, s27, v56
    v_add_u32 v49, s27, v57
    v_add_u32 v50, s27, v58
    v_add_u32 v51, s27, v59
    s_add_u32 s27, s27, 8192
    s_cmp_eq_u32 s27, 147456
    s_cselect_b32 s27, 0, s27
    ds_read_b64_tr_b16 v[44:45], v55 offset:4096
    ds_read_b64_tr_b16 v[46:47], v55 offset:6144
    s_waitcnt vmcnt(3) lgkmcnt(6)
    v_mfma_f32_32x32x16_bf16 v[192:207], v[32:35], v[28:31], v[192:207]
    ds_read_b64_tr_b16 v[32:33], v48 offset:0
    ds_read_b64_tr_b16 v[34:35], v48 offset:2048
    s_waitcnt lgkmcnt(6)
    v_mfma_f32_32x32x16_bf16 v[208:223], v[36:39], v[28:31], v[208:223]
    ds_read_b64_tr_b16 v[36:37], v49 offset:0
    ds_read_b64_tr_b16 v[38:39], v49 offset:2048
    s_waitcnt lgkmcnt(6)
    v_mfma_f32_32x32x16_bf16 v[224:239], v[40:43], v[28:31], v[224:239]
    ds_read_b64_tr_b16 v[40:41], v50 offset:0
    ds_read_b64_tr_b16 v[42:43], v50 offset:2048
    s_waitcnt lgkmcnt(6)
    v_mfma_f32_32x32x16_bf16 v[240:255], v[44:47], v[28:31], v[240:255]
    buffer_load_dwordx4 v[28:31], v62, s[8:11], s24 offen offset:1024
    s_add_u32 s24, s24, 2048
    s_sub_u32 s28, s28, 1
    s_cmp_lg_u32 s28, 0
    s_cbranch_scc1 L_gf_kq_loop
    v_cvt_pk_bf16_f32 v64, v192, v193
    v_cvt_pk_bf16_f32 v65, v194, v195
    v_cvt_pk_bf16_f32 v66, v196, v197
    v_cvt_pk_bf16_f32 v67, v198, v199
    s_add_u32 s19, s29, 0
    buffer_store_dwordx4 v[64:67], v62, s[8:11], s19 offen offset:0 sc1
    v_cvt_pk_bf16_f32 v68, v200, v201
    v_cvt_pk_bf16_f32 v69, v202, v203
    v_cvt_pk_bf16_f32 v70, v204, v205
    v_cvt_pk_bf16_f32 v71, v206, v207
    s_add_u32 s19, s29, 0
    buffer_store_dwordx4 v[68:71], v62, s[8:11], s19 offen offset:1024 sc1
    v_cvt_pk_bf16_f32 v72, v208, v209
    v_cvt_pk_bf16_f32 v73, v210, v211
    v_cvt_pk_bf16_f32 v74, v212, v213
    v_cvt_pk_bf16_f32 v75, v214, v215
    s_add_u32 s19, s29, 0
    buffer_store_dwordx4 v[72:75], v62, s[8:11], s19 offen offset:2048 sc1
    v_cvt_pk_bf16_f32 v76, v216, v217
    v_cvt_pk_bf16_f32 v77, v218, v219
    v_cvt_pk_bf16_f32 v78, v220, v221
    v_cvt_pk_bf16_f32 v79, v222, v223
    s_add_u32 s19, s29, 0
    buffer_store_dwordx4 v[76:79], v62, s[8:11], s19 offen offset:3072 sc1
    v_cvt_pk_bf16_f32 v64, v224, v225
    v_cvt_pk_bf16_f32 v65, v226, v227
    v_cvt_pk_bf16_f32 v66, v228, v229
    v_cvt_pk_bf16_f32 v67, v230, v231
    s_add_u32 s19, s29, 4096
    buffer_store_dwordx4 v[64:67], v62, s[8:11], s19 offen offset:0 sc1
    v_cvt_pk_bf16_f32 v68, v232, v233
    v_cvt_pk_bf16_f32 v69, v234, v235
    v_cvt_pk_bf16_f32 v70, v236, v237
    v_cvt_pk_bf16_f32 v71, v238, v239
    s_add_u32 s19, s29, 4096
    buffer_store_dwordx4 v[68:71], v62, s[8:11], s19 offen offset:1024 sc1
    v_cvt_pk_bf16_f32 v72, v240, v241
    v_cvt_pk_bf16_f32 v73, v242, v243
    v_cvt_pk_bf16_f32 v74, v244, v245
    v_cvt_pk_bf16_f32 v75, v246, v247
    s_add_u32 s19, s29, 4096
    buffer_store_dwordx4 v[72:75], v62, s[8:11], s19 offen offset:2048 sc1
    v_cvt_pk_bf16_f32 v76, v248, v249
    v_cvt_pk_bf16_f32 v77, v250, v251
    v_cvt_pk_bf16_f32 v78, v252, v253
    v_cvt_pk_bf16_f32 v79, v254, v255
    s_add_u32 s19, s29, 4096
    buffer_store_dwordx4 v[76:79], v62, s[8:11], s19 offen offset:3072 sc1
    s_branch L_gm_sig
L_gf_v:
L_gf_v_loop:
    s_cmp_eq_u32 s28, 1
    s_cselect_b32 s24, 0x40000000, s24
    ds_read_b64_tr_b16 v[44:45], v51 offset:0
    ds_read_b64_tr_b16 v[46:47], v51 offset:2048
    s_waitcnt vmcnt(3) lgkmcnt(6)
    v_mfma_f32_32x32x16_bf16 v[192:207], v[16:19], v[32:35], v[192:207]
    ds_read_b64_tr_b16 v[32:33], v48 offset:4096
    ds_read_b64_tr_b16 v[34:35], v48 offset:6144
    s_waitcnt lgkmcnt(6)
    v_mfma_f32_32x32x16_bf16 v[208:223], v[16:19], v[36:39], v[208:223]
    ds_read_b64_tr_b16 v[36:37], v49 offset:4096
    ds_read_b64_tr_b16 v[38:39], v49 offset:6144
    s_waitcnt lgkmcnt(6)
    v_mfma_f32_32x32x16_bf16 v[224:239], v[16:19], v[40:43], v[224:239]
    ds_read_b64_tr_b16 v[40:41], v50 offset:4096
    ds_read_b64_tr_b16 v[42:43], v50 offset:6144
    s_waitcnt lgkmcnt(6)
    v_mfma_f32_32x32x16_bf16 v[240:255], v[16:19], v[44:47], v[240:255]
    buffer_load_dwordx4 v[16:19], v62, s[8:11], s24 offen offset:0
    v_add_u32 v52, s27, v56
    v_add_u32 v53, s27, v57
    v_add_u32 v54, s27, v58
    v_add_u32 v55, s27, v59
    s_add_u32 s27, s27, 8192
    s_cmp_eq_u32 s27, 147456
    s_cselect_b32 s27, 0, s27
    ds_read_b64_tr_b16 v[44:45], v51 offset:4096
    ds_read_b64_tr_b16 v[46:47], v51 offset:6144
    s_waitcnt vmcnt(3) lgkmcnt(6)
    v_mfma_f32_32x32x16_bf16 v[192:207], v[20:23], v[32:35], v[192:207]
    ds_read_b64_tr_b16 v[32:33], v52 offset:0
    ds_read_b64_tr_b16 v[34:35], v52 offset:2048
    s_waitcnt lgkmcnt(6)
    v_mfma_f32_32x32x16_bf16 v[208:223], v[20:23], v[36:39], v[208:223]
    ds_read_b64_tr_b16 v[36:37], v53 offset:0
    ds_read_b64_tr_b16 v[38:39], v53 offset:2048
    s_waitcnt lgkmcnt(6)
    v_mfma_f32_32x32x16_bf16 v[224:239], v[20:23], v[40:43], v[224:239]
    ds_read_b64_tr_b16 v[40:41], v54 offset:0
    ds_read_b64_tr_b16 v[42:43], v54 offset:2048
    s_waitcnt lgkmcnt(6)
    v_mfma_f32_32x32x16_bf16 v[240:255], v[20:23], v[44:47], v[240:255]
    buffer_load_dwordx4 v[20:23], v62, s[8:11], s24 offen offset:1024
    s_add_u32 s24, s24, 2048
    ds_read_b64_tr_b16 v[44:45], v55 offset:0
    ds_read_b64_tr_b16 v[46:47], v55 offset:2048
    s_waitcnt vmcnt(3) lgkmcnt(6)
    v_mfma_f32_32x32x16_bf16 v[192:207], v[24:27], v[32:35], v[192:207]
    ds_read_b64_tr_b16 v[32:33], v52 offset:4096
    ds_read_b64_tr_b16 v[34:35], v52 offset:6144
    s_waitcnt lgkmcnt(6)
    v_mfma_f32_32x32x16_bf16 v[208:223], v[24:27], v[36:39], v[208:223]
    ds_read_b64_tr_b16 v[36:37], v53 offset:4096
    ds_read_b64_tr_b16 v[38:39], v53 offset:6144
    s_waitcnt lgkmcnt(6)
    v_mfma_f32_32x32x16_bf16 v[224:239], v[24:27], v[40:43], v[224:239]
    ds_read_b64_tr_b16 v[40:41], v54 offset:4096
    ds_read_b64_tr_b16 v[42:43], v54 offset:6144
    s_waitcnt lgkmcnt(6)
    v_mfma_f32_32x32x16_bf16 v[240:255], v[24:27], v[44:47], v[240:255]
    buffer_load_dwordx4 v[24:27], v62, s[8:11], s24 offen offset:0
    v_add_u32 v48, s27, v56
    v_add_u32 v49, s27, v57
    v_add_u32 v50, s27, v58
    v_add_u32 v51, s27, v59
    s_add_u32 s27, s27, 8192
    s_cmp_eq_u32 s27, 147456
    s_cselect_b32 s27, 0, s27
    ds_read_b64_tr_b16 v[44:45], v55 offset:4096
    ds_read_b64_tr_b16 v[46:47], v55 offset:6144
    s_waitcnt vmcnt(3) lgkmcnt(6)
    v_mfma_f32_32x32x16_bf16 v[192:207], v[28:31], v[32:35], v[192:207]
    ds_read_b64_tr_b16 v[32:33], v48 offset:0
    ds_read_b64_tr_b16 v[34:35], v48 offset:2048
    s_waitcnt lgkmcnt(6)
    v_mfma_f32_32x32x16_bf16 v[208:223], v[28:31], v[36:39], v[208:223]
    ds_read_b64_tr_b16 v[36:37], v49 offset:0
    ds_read_b64_tr_b16 v[38:39], v49 offset:2048
    s_waitcnt lgkmcnt(6)
    v_mfma_f32_32x32x16_bf16 v[224:239], v[28:31], v[40:43], v[224:239]
    ds_read_b64_tr_b16 v[40:41], v50 offset:0
    ds_read_b64_tr_b16 v[42:43], v50 offset:2048
    s_waitcnt lgkmcnt(6)
    v_mfma_f32_32x32x16_bf16 v[240:255], v[28:31], v[44:47], v[240:255]
    buffer_load_dwordx4 v[28:31], v62, s[8:11], s24 offen offset:1024
    s_add_u32 s24, s24, 2048
    s_sub_u32 s28, s28, 1
    s_cmp_lg_u32 s28, 0
    s_cbranch_scc1 L_gf_v_loop
    v_lshrrev_b32 v80, 5, v0
    v_lshlrev_b32 v80, 11, v80
    v_and_b32 v81, 31, v0
    v_lshl_add_u32 v80, v81, 4, v80
    v_cvt_pk_bf16_f32 v64, v192, v193
    v_cvt_pk_bf16_f32 v65, v194, v195
    v_cvt_pk_bf16_f32 v66, v196, v197
    v_cvt_pk_bf16_f32 v67, v198, v199
    s_add_u32 s19, s29, 0
    buffer_store_dwordx4 v[64:67], v80, s[8:11], s19 offen offset:0 sc1
    v_cvt_pk_bf16_f32 v68, v200, v201
    v_cvt_pk_bf16_f32 v69, v202, v203
    v_cvt_pk_bf16_f32 v70, v204, v205
    v_cvt_pk_bf16_f32 v71, v206, v207
    s_add_u32 s19, s29, 4096
    buffer_store_dwordx4 v[68:71], v80, s[8:11], s19 offen offset:0 sc1
    v_cvt_pk_bf16_f32 v72, v208, v209
    v_cvt_pk_bf16_f32 v73, v210, v211
    v_cvt_pk_bf16_f32 v74, v212, v213
    v_cvt_pk_bf16_f32 v75, v214, v215
    s_add_u32 s19, s29, 0
    buffer_store_dwordx4 v[72:75], v80, s[8:11], s19 offen offset:512 sc1
    v_cvt_pk_bf16_f32 v76, v216, v217
    v_cvt_pk_bf16_f32 v77, v218, v219
    v_cvt_pk_bf16_f32 v78, v220, v221
    v_cvt_pk_bf16_f32 v79, v222, v223
    s_add_u32 s19, s29, 4096
    buffer_store_dwordx4 v[76:79], v80, s[8:11], s19 offen offset:512 sc1
    v_cvt_pk_bf16_f32 v64, v224, v225
    v_cvt_pk_bf16_f32 v65, v226, v227
    v_cvt_pk_bf16_f32 v66, v228, v229
    v_cvt_pk_bf16_f32 v67, v230, v231
    s_add_u32 s19, s29, 0
    buffer_store_dwordx4 v[64:67], v80, s[8:11], s19 offen offset:1024 sc1
    v_cvt_pk_bf16_f32 v68, v232, v233
    v_cvt_pk_bf16_f32 v69, v234, v235
    v_cvt_pk_bf16_f32 v70, v236, v237
    v_cvt_pk_bf16_f32 v71, v238, v239
    s_add_u32 s19, s29, 4096
    buffer_store_dwordx4 v[68:71], v80, s[8:11], s19 offen offset:1024 sc1
    v_cvt_pk_bf16_f32 v72, v240, v241
    v_cvt_pk_bf16_f32 v73, v242, v243
    v_cvt_pk_bf16_f32 v74, v244, v245
    v_cvt_pk_bf16_f32 v75, v246, v247
    s_add_u32 s19, s29, 0
    buffer_store_dwordx4 v[72:75], v80, s[8:11], s19 offen offset:1536 sc1
    v_cvt_pk_bf16_f32 v76, v248, v249
    v_cvt_pk_bf16_f32 v77, v250, v251
    v_cvt_pk_bf16_f32 v78, v252, v253
    v_cvt_pk_bf16_f32 v79, v254, v255
    s_add_u32 s19, s29, 4096
    buffer_store_dwordx4 v[76:79], v80, s[8:11], s19 offen offset:1536 sc1
    s_branch L_gm_sig
L_gm_sig:
    s_waitcnt vmcnt(0)
    s_barrier
    s_cmp_eq_u32 s17, 0
    s_cbranch_scc0 L_sig_12
    v_mov_b32 v2, s61
    s_mov_b64 exec, 1
    buffer_atomic_add v2, off, s[8:11], s63
    s_mov_b64 exec, -1
L_sig_12:
    s_branch L_gm_next
L_end_drain:
    s_waitcnt vmcnt(0)
    s_branch L_end
L_w5:
    s_lshl_b32 s47, s46, 2
    s_add_u32 s47, s47, s17
    s_and_b32 s78, s47, 31
    s_lshr_b32 s77, s46, 3
    v_lshlrev_b32 v1, 4, v0
    v_and_b32 v5, 31, v0
    v_lshrrev_b32 v6, 5, v0
    v_lshlrev_b32 v2, 7, v6
    v_lshl_add_u32 v2, v5, 4, v2
    v_mov_b32 v7, 0x40000000
    v_cmp_gt_u32 vcc, 8, v5
    s_nop 1
    v_cndmask_b32 v2, v7, v2, vcc
    v_lshlrev_b32 v3, 11, v6
    v_lshl_add_u32 v3, v5, 4, v3
    v_lshlrev_b32 v4, 3, v6
    v_lshl_add_u32 v4, v5, 4, v4
    v_lshlrev_b32 v7, 2, v6
    v_sub_u32 v7, v5, v7
    v_cmp_le_i32 s[44:45], 0, v7
    v_cmp_le_i32 s[46:47], 1, v7
    v_cmp_le_i32 s[48:49], 2, v7
    v_cmp_le_i32 s[50:51], 3, v7
    v_cmp_le_i32 s[52:53], 8, v7
    v_cmp_le_i32 s[54:55], 9, v7
    v_cmp_le_i32 s[56:57], 10, v7
    v_cmp_le_i32 s[58:59], 11, v7
    v_cmp_le_i32 s[60:61], 16, v7
    v_cmp_le_i32 s[62:63], 17, v7
    v_cmp_le_i32 s[64:65], 18, v7
    v_cmp_le_i32 s[66:67], 19, v7
    v_cmp_le_i32 s[68:69], 24, v7
    v_cmp_le_i32 s[70:71], 25, v7
    v_cmp_le_i32 s[72:73], 26, v7
    v_cmp_le_i32 s[74:75], 27, v7
    s_mov_b32 s40, 0x3e0293ee
    s_lshl_b32 s80, s78, 7
    s_add_u32 s80, s80, 0x201480
L_w5_loop:
    s_and_b32 s81, s77, 6
    s_cmp_eq_u32 s81, 0
    s_cbranch_scc0 L_w5_go
    s_lshr_b32 s81, s77, 3
    s_lshl_b32 s81, s81, 7
    s_add_u32 s82, s81, 0x200480
    s_mov_b32 s20, s3
L_pg_13:
    s_mov_b64 exec, 1
    buffer_load_dword v8, off, s[8:11], s82 sc1
    s_waitcnt vmcnt(0)
    s_nop 0
    v_readfirstlane_b32 s19, v8
    s_mov_b64 exec, -1
    s_cmp_ge_u32 s19, 128
    s_cbranch_scc1 L_pg_13_d
    s_sleep 32
    s_sub_u32 s20, s20, 1
    s_cmp_lg_u32 s20, 0
    s_cbranch_scc1 L_pg_13
    s_mov_b32 s3, 1
L_pg_13_d:
    s_add_u32 s82, s81, 0x200880
    s_mov_b32 s20, s3
L_pg_14:
    s_mov_b64 exec, 1
    buffer_load_dword v8, off, s[8:11], s82 sc1
    s_waitcnt vmcnt(0)
    s_nop 0
    v_readfirstlane_b32 s19, v8
    s_mov_b64 exec, -1
    s_cmp_ge_u32 s19, 32
    s_cbranch_scc1 L_pg_14_d
    s_sleep 32
    s_sub_u32 s20, s20, 1
    s_cmp_lg_u32 s20, 0
    s_cbranch_scc1 L_pg_14
    s_mov_b32 s3, 1
L_pg_14_d:
L_w5_go:
    s_lshl_b32 s76, s77, 5
    s_add_u32 s76, s76, s78
    s_lshl_b32 s79, s76, 13
    s_add_u32 s19, s79, 0x3000000
    s_add_u32 s20, s19, 4096
    buffer_load_dwordx4 v[16:19], v1, s[8:11], s19 offen offset:0
    buffer_load_dwordx4 v[20:23], v1, s[8:11], s19 offen offset:1024
    buffer_load_dwordx4 v[24:27], v1, s[8:11], s19 offen offset:2048
    buffer_load_dwordx4 v[28:31], v1, s[8:11], s19 offen offset:3072
    buffer_load_dwordx4 v[32:35], v1, s[8:11], s20 offen offset:0
    buffer_load_dwordx4 v[36:39], v1, s[8:11], s20 offen offset:1024
    buffer_load_dwordx4 v[40:43], v1, s[8:11], s20 offen offset:2048
    buffer_load_dwordx4 v[44:47], v1, s[8:11], s20 offen offset:3072
    s_add_u32 s19, s79, 0x1000000
    s_add_u32 s20, s19, 4096
    buffer_load_dwordx4 v[48:51], v1, s[8:11], s19 offen offset:0
    buffer_load_dwordx4 v[52:55], v1, s[8:11], s19 offen offset:1024
    buffer_load_dwordx4 v[56:59], v1, s[8:11], s19 offen offset:2048
    buffer_load_dwordx4 v[60:63], v1, s[8:11], s19 offen offset:3072
    buffer_load_dwordx4 v[64:67], v1, s[8:11], s20 offen offset:0
    buffer_load_dwordx4 v[68:71], v1, s[8:11], s20 offen offset:1024
    buffer_load_dwordx4 v[72:75], v1, s[8:11], s20 offen offset:2048
    buffer_load_dwordx4 v[76:79], v1, s[8:11], s20 offen offset:3072
    s_waitcnt vmcnt(7)
    v_mfma_f32_32x32x16_bf16 v[112:127], v[48:51], v[16:19], 0
    s_waitcnt vmcnt(6)
    v_mfma_f32_32x32x16_bf16 v[112:127], v[52:55], v[20:23], v[112:127]
    s_waitcnt vmcnt(5)
    v_mfma_f32_32x32x16_bf16 v[112:127], v[56:59], v[24:27], v[112:127]
    s_waitcnt vmcnt(4)
    v_mfma_f32_32x32x16_bf16 v[112:127], v[60:63], v[28:31], v[112:127]
    s_waitcnt vmcnt(3)
    v_mfma_f32_32x32x16_bf16 v[112:127], v[64:67], v[32:35], v[112:127]
    s_waitcnt vmcnt(2)
    v_mfma_f32_32x32x16_bf16 v[112:127], v[68:71], v[36:39], v[112:127]
    s_waitcnt vmcnt(1)
    v_mfma_f32_32x32x16_bf16 v[112:127], v[72:75], v[40:43], v[112:127]
    s_waitcnt vmcnt(0)
    v_mfma_f32_32x32x16_bf16 v[112:127], v[76:79], v[44:47], v[112:127]
    s_add_u32 s19, s79, 0x2000000
    s_add_u32 s20, s19, 4096
    buffer_load_dwordx4 v[48:51], v3, s[8:11], s19 offen offset:0
    buffer_load_dwordx4 v[52:55], v3, s[8:11], s20 offen offset:0
    buffer_load_dwordx4 v[56:59], v3, s[8:11], s19 offen offset:512
    buffer_load_dwordx4 v[60:63], v3, s[8:11], s20 offen offset:512
    buffer_load_dwordx4 v[64:67], v3, s[8:11], s19 offen offset:1024
    buffer_load_dwordx4 v[68:71], v3, s[8:11], s20 offen offset:1024
    buffer_load_dwordx4 v[72:75], v3, s[8:11], s19 offen offset:1536
    buffer_load_dwordx4 v[76:79], v3, s[8:11], s20 offen offset:1536
    s_add_u32 s83, s77, 1
    s_mov_b32 s20, s3
L_pg_15:
    s_mov_b64 exec, 1
    buffer_load_dword v8, off, s[8:11], s80 sc1
    s_waitcnt vmcnt(0)
    s_nop 0
    v_readfirstlane_b32 s19, v8
    s_mov_b64 exec, -1
    s_cmp_ge_u32 s19, s83
    s_cbranch_scc1 L_pg_15_d
    s_sleep 4
    s_sub_u32 s20, s20, 1
    s_cmp_lg_u32 s20, 0
    s_cbranch_scc1 L_pg_15
    s_mov_b32 s3, 1
L_pg_15_d:
    s_lshl_b32 s21, s76, 11
    s_add_u32 s19, s21, 0x6c00000
    buffer_load_dwordx4 v[80:83], v2, s[8:11], s19 offen offset:0
    buffer_load_dwordx4 v[84:87], v2, s[8:11], s19 offen offset:256
    buffer_load_dwordx4 v[88:91], v2, s[8:11], s19 offen offset:512
    buffer_load_dwordx4 v[92:95], v2, s[8:11], s19 offen offset:768
    buffer_load_dwordx4 v[96:99], v2, s[8:11], s19 offen offset:1024
    buffer_load_dwordx4 v[100:103], v2, s[8:11], s19 offen offset:1280
    buffer_load_dwordx4 v[104:107], v2, s[8:11], s19 offen offset:1536
    buffer_load_dwordx4 v[108:111], v2, s[8:11], s19 offen offset:1792
    s_add_u32 s19, s21, 0x7000000
    buffer_load_dwordx2 v[208:209], v4, s[8:11], s19 offen offset:0
    v_mov_b64 v[210:211], 0
    buffer_load_dwordx2 v[212:213], v4, s[8:11], s19 offen offset:512
    v_mov_b64 v[214:215], 0
    buffer_load_dwordx2 v[216:217], v4, s[8:11], s19 offen offset:1024
    v_mov_b64 v[218:219], 0
    buffer_load_dwordx2 v[220:221], v4, s[8:11], s19 offen offset:1536
    v_mov_b64 v[222:223], 0
    s_waitcnt vmcnt(11)
    v_mfma_f32_32x32x16_bf16 v[128:143], v[80:83], v[16:19], 0
    s_waitcnt vmcnt(10)
    v_mfma_f32_32x32x16_bf16 v[128:143], v[84:87], v[20:23], v[128:143]
    s_waitcnt vmcnt(9)
    v_mfma_f32_32x32x16_bf16 v[128:143], v[88:91], v[24:27], v[128:143]
    s_waitcnt vmcnt(8)
    v_mfma_f32_32x32x16_bf16 v[128:143], v[92:95], v[28:31], v[128:143]
    s_waitcnt vmcnt(7)
    v_mfma_f32_32x32x16_bf16 v[128:143], v[96:99], v[32:35], v[128:143]
    s_waitcnt vmcnt(6)
    v_mfma_f32_32x32x16_bf16 v[128:143], v[100:103], v[36:39], v[128:143]
    s_waitcnt vmcnt(5)
    v_mfma_f32_32x32x16_bf16 v[128:143], v[104:107], v[40:43], v[128:143]
    s_waitcnt vmcnt(4)
    v_mfma_f32_32x32x16_bf16 v[128:143], v[108:111], v[44:47], v[128:143]
    v_mov_b32 v8, 0xff800000
    v_cndmask_b32 v112, v8, v112, s[44:45]
    v_cndmask_b32 v113, v8, v113, s[46:47]
    v_cndmask_b32 v114, v8, v114, s[48:49]
    v_cndmask_b32 v115, v8, v115, s[50:51]
    v_cndmask_b32 v116, v8, v116, s[52:53]
    v_cndmask_b32 v117, v8, v117, s[54:55]
    v_cndmask_b32 v118, v8, v118, s[56:57]
    v_cndmask_b32 v119, v8, v119, s[58:59]
    v_cndmask_b32 v120, v8, v120, s[60:61]
    v_cndmask_b32 v121, v8, v121, s[62:63]
    v_cndmask_b32 v122, v8, v122, s[64:65]
    v_cndmask_b32 v123, v8, v123, s[66:67]
    v_cndmask_b32 v124, v8, v124, s[68:69]
    v_cndmask_b32 v125, v8, v125, s[70:71]
    v_cndmask_b32 v126, v8, v126, s[72:73]
    v_cndmask_b32 v127, v8, v127, s[74:75]
    v_max3_f32 v9, v112, v113, v114
    v_max3_f32 v9, v9, v115, v116
    v_max3_f32 v9, v9, v117, v118
    v_max3_f32 v9, v9, v119, v120
    v_max3_f32 v9, v9, v121, v122
    v_max3_f32 v9, v9, v123, v124
    v_max3_f32 v9, v9, v125, v126
    v_max3_f32 v9, v9, v127, v128
    v_max3_f32 v9, v9, v129, v130
    v_max_f32 v9, v9, v131
    v_mov_b32 v10, v9
    s_nop 1
    v_permlane32_swap_b32 v9, v10
    v_max_f32 v9, v9, v10
    v_mul_f32 v9, s40, v9
    v_fma_f32 v112, v112, s40, -v9
    v_fma_f32 v113, v113, s40, -v9
    v_fma_f32 v114, v114, s40, -v9
    v_fma_f32 v115, v115, s40, -v9
    v_fma_f32 v116, v116, s40, -v9
    v_fma_f32 v117, v117, s40, -v9
    v_fma_f32 v118, v118, s40, -v9
    v_fma_f32 v119, v119, s40, -v9
    v_fma_f32 v120, v120, s40, -v9
    v_fma_f32 v121, v121, s40, -v9
    v_fma_f32 v122, v122, s40, -v9
    v_fma_f32 v123, v123, s40, -v9
    v_fma_f32 v124, v124, s40, -v9
    v_fma_f32 v125, v125, s40, -v9
    v_fma_f32 v126, v126, s40, -v9
    v_fma_f32 v127, v127, s40, -v9
    v_fma_f32 v128, v128, s40, -v9
    v_fma_f32 v129, v129, s40, -v9
    v_fma_f32 v130, v130, s40, -v9
    v_fma_f32 v131, v131, s40, -v9
    v_exp_f32 v112, v112
    v_exp_f32 v113, v113
    v_exp_f32 v114, v114
    v_exp_f32 v115, v115
    v_exp_f32 v116, v116
    v_exp_f32 v117, v117
    v_exp_f32 v118, v118
    v_exp_f32 v119, v119
    v_exp_f32 v120, v120
    v_exp_f32 v121, v121
    v_exp_f32 v122, v122
    v_exp_f32 v123, v123
    v_exp_f32 v124, v124
    v_exp_f32 v125, v125
    v_exp_f32 v126, v126
    v_exp_f32 v127, v127
    v_exp_f32 v128, v128
    v_exp_f32 v129, v129
    v_exp_f32 v130, v130
    v_exp_f32 v131, v131
    v_add_f32 v10, v112, v113
    v_add_f32 v10, v10, v114
    v_add_f32 v10, v10, v115
    v_add_f32 v10, v10, v116
    v_add_f32 v10, v10, v117
    v_add_f32 v10, v10, v118
    v_add_f32 v10, v10, v119
    v_add_f32 v10, v10, v120
    v_add_f32 v10, v10, v121
    v_add_f32 v10, v10, v122
    v_add_f32 v10, v10, v123
    v_add_f32 v10, v10, v124
    v_add_f32 v10, v10, v125
    v_add_f32 v10, v10, v126
    v_add_f32 v10, v10, v127
    v_add_f32 v10, v10, v128
    v_add_f32 v10, v10, v129
    v_add_f32 v10, v10, v130
    v_add_f32 v10, v10, v131
    v_mov_b32 v11, v10
    s_nop 1
    v_permlane32_swap_b32 v10, v11
    v_add_f32 v10, v10, v11
    v_rcp_f32 v10, v10
    v_cvt_pk_bf16_f32 v16, v112, v113
    v_cvt_pk_bf16_f32 v17, v114, v115
    v_cvt_pk_bf16_f32 v18, v116, v117
    v_cvt_pk_bf16_f32 v19, v118, v119
    v_cvt_pk_bf16_f32 v20, v120, v121
    v_cvt_pk_bf16_f32 v21, v122, v123
    v_cvt_pk_bf16_f32 v22, v124, v125
    v_cvt_pk_bf16_f32 v23, v126, v127
    v_cvt_pk_bf16_f32 v24, v128, v129
    v_cvt_pk_bf16_f32 v25, v130, v131
    v_mov_b64 v[26:27], 0
    v_mfma_f32_32x32x16_bf16 v[144:159], v[48:51], v[16:19], 0
    v_mfma_f32_32x32x16_bf16 v[144:159], v[52:55], v[20:23], v[144:159]
    s_waitcnt vmcnt(3)
    v_mfma_f32_32x32x16_bf16 v[144:159], v[208:211], v[24:27], v[144:159]
    v_mfma_f32_32x32x16_bf16 v[160:175], v[56:59], v[16:19], 0
    v_mfma_f32_32x32x16_bf16 v[160:175], v[60:63], v[20:23], v[160:175]
    s_waitcnt vmcnt(2)
    v_mfma_f32_32x32x16_bf16 v[160:175], v[212:215], v[24:27], v[160:175]
    v_mfma_f32_32x32x16_bf16 v[176:191], v[64:67], v[16:19], 0
    v_mfma_f32_32x32x16_bf16 v[176:191], v[68:71], v[20:23], v[176:191]
    s_waitcnt vmcnt(1)
    v_mfma_f32_32x32x16_bf16 v[176:191], v[216:219], v[24:27], v[176:191]
    v_mfma_f32_32x32x16_bf16 v[192:207], v[72:75], v[16:19], 0
    v_mfma_f32_32x32x16_bf16 v[192:207], v[76:79], v[20:23], v[192:207]
    s_waitcnt vmcnt(0)
    v_mfma_f32_32x32x16_bf16 v[192:207], v[220:223], v[24:27], v[192:207]
    s_lshl_b32 s19, s77, 18
    s_lshl_b32 s20, s78, 13
    s_add_u32 s19, s19, s20
    s_add_u32 s19, s19, 0x4000000
    s_add_u32 s20, s19, 4096
    v_pk_mul_f32 v[144:145], v[144:145], v[10:11] op_sel_hi:[1,0]
    v_pk_mul_f32 v[146:147], v[146:147], v[10:11] op_sel_hi:[1,0]
    v_pk_mul_f32 v[148:149], v[148:149], v[10:11] op_sel_hi:[1,0]
    v_pk_mul_f32 v[150:151], v[150:151], v[10:11] op_sel_hi:[1,0]
    v_pk_mul_f32 v[152:153], v[152:153], v[10:11] op_sel_hi:[1,0]
    v_pk_mul_f32 v[154:155], v[154:155], v[10:11] op_sel_hi:[1,0]
    v_pk_mul_f32 v[156:157], v[156:157], v[10:11] op_sel_hi:[1,0]
    v_pk_mul_f32 v[158:159], v[158:159], v[10:11] op_sel_hi:[1,0]
    v_cvt_pk_bf16_f32 v32, v144, v145
    v_cvt_pk_bf16_f32 v33, v146, v147
    v_cvt_pk_bf16_f32 v34, v148, v149
    v_cvt_pk_bf16_f32 v35, v150, v151
    buffer_store_dwordx4 v[32:35], v1, s[8:11], s19 offen offset:0 sc1
    v_cvt_pk_bf16_f32 v36, v152, v153
    v_cvt_pk_bf16_f32 v37, v154, v155
    v_cvt_pk_bf16_f32 v38, v156, v157
    v_cvt_pk_bf16_f32 v39, v158, v159
    buffer_store_dwordx4 v[36:39], v1, s[8:11], s19 offen offset:1024 sc1
    v_pk_mul_f32 v[160:161], v[160:161], v[10:11] op_sel_hi:[1,0]
    v_pk_mul_f32 v[162:163], v[162:163], v[10:11] op_sel_hi:[1,0]
    v_pk_mul_f32 v[164:165], v[164:165], v[10:11] op_sel_hi:[1,0]
    v_pk_mul_f32 v[166:167], v[166:167], v[10:11] op_sel_hi:[1,0]
    v_pk_mul_f32 v[168:169], v[168:169], v[10:11] op_sel_hi:[1,0]
    v_pk_mul_f32 v[170:171], v[170:171], v[10:11] op_sel_hi:[1,0]
    v_pk_mul_f32 v[172:173], v[172:173], v[10:11] op_sel_hi:[1,0]
    v_pk_mul_f32 v[174:175], v[174:175], v[10:11] op_sel_hi:[1,0]
    v_cvt_pk_bf16_f32 v40, v160, v161
    v_cvt_pk_bf16_f32 v41, v162, v163
    v_cvt_pk_bf16_f32 v42, v164, v165
    v_cvt_pk_bf16_f32 v43, v166, v167
    buffer_store_dwordx4 v[40:43], v1, s[8:11], s19 offen offset:2048 sc1
    v_cvt_pk_bf16_f32 v44, v168, v169
    v_cvt_pk_bf16_f32 v45, v170, v171
    v_cvt_pk_bf16_f32 v46, v172, v173
    v_cvt_pk_bf16_f32 v47, v174, v175
    buffer_store_dwordx4 v[44:47], v1, s[8:11], s19 offen offset:3072 sc1
    v_pk_mul_f32 v[176:177], v[176:177], v[10:11] op_sel_hi:[1,0]
    v_pk_mul_f32 v[178:179], v[178:179], v[10:11] op_sel_hi:[1,0]
    v_pk_mul_f32 v[180:181], v[180:181], v[10:11] op_sel_hi:[1,0]
    v_pk_mul_f32 v[182:183], v[182:183], v[10:11] op_sel_hi:[1,0]
    v_pk_mul_f32 v[184:185], v[184:185], v[10:11] op_sel_hi:[1,0]
    v_pk_mul_f32 v[186:187], v[186:187], v[10:11] op_sel_hi:[1,0]
    v_pk_mul_f32 v[188:189], v[188:189], v[10:11] op_sel_hi:[1,0]
    v_pk_mul_f32 v[190:191], v[190:191], v[10:11] op_sel_hi:[1,0]
    v_cvt_pk_bf16_f32 v32, v176, v177
    v_cvt_pk_bf16_f32 v33, v178, v179
    v_cvt_pk_bf16_f32 v34, v180, v181
    v_cvt_pk_bf16_f32 v35, v182, v183
    buffer_store_dwordx4 v[32:35], v1, s[8:11], s20 offen offset:0 sc1
    v_cvt_pk_bf16_f32 v36, v184, v185
    v_cvt_pk_bf16_f32 v37, v186, v187
    v_cvt_pk_bf16_f32 v38, v188, v189
    v_cvt_pk_bf16_f32 v39, v190, v191
    buffer_store_dwordx4 v[36:39], v1, s[8:11], s20 offen offset:1024 sc1
    v_pk_mul_f32 v[192:193], v[192:193], v[10:11] op_sel_hi:[1,0]
    v_pk_mul_f32 v[194:195], v[194:195], v[10:11] op_sel_hi:[1,0]
    v_pk_mul_f32 v[196:197], v[196:197], v[10:11] op_sel_hi:[1,0]
    v_pk_mul_f32 v[198:199], v[198:199], v[10:11] op_sel_hi:[1,0]
    v_pk_mul_f32 v[200:201], v[200:201], v[10:11] op_sel_hi:[1,0]
    v_pk_mul_f32 v[202:203], v[202:203], v[10:11] op_sel_hi:[1,0]
    v_pk_mul_f32 v[204:205], v[204:205], v[10:11] op_sel_hi:[1,0]
    v_pk_mul_f32 v[206:207], v[206:207], v[10:11] op_sel_hi:[1,0]
    v_cvt_pk_bf16_f32 v40, v192, v193
    v_cvt_pk_bf16_f32 v41, v194, v195
    v_cvt_pk_bf16_f32 v42, v196, v197
    v_cvt_pk_bf16_f32 v43, v198, v199
    buffer_store_dwordx4 v[40:43], v1, s[8:11], s20 offen offset:2048 sc1
    v_cvt_pk_bf16_f32 v44, v200, v201
    v_cvt_pk_bf16_f32 v45, v202, v203
    v_cvt_pk_bf16_f32 v46, v204, v205
    v_cvt_pk_bf16_f32 v47, v206, v207
    buffer_store_dwordx4 v[44:47], v1, s[8:11], s20 offen offset:3072 sc1
    s_waitcnt vmcnt(0)
    s_lshl_b32 s81, s77, 7
    s_add_u32 s81, s81, 0x202480
    v_mov_b32 v8, 1
    s_mov_b64 exec, 1
    buffer_atomic_add v8, off, s[8:11], s81
    s_mov_b64 exec, -1
    s_add_u32 s77, s77, 2
    s_cmp_lt_u32 s77, 64
    s_cbranch_scc1 L_w5_loop
    s_waitcnt vmcnt(0)
    s_branch L_end
L_w6a:
    s_mov_b32 s44, s7
    s_mov_b32 s45, 0
    s_branch L_w6
L_w6b:
    s_mov_b32 s44, s46
    s_mov_b32 s45, 1
    s_branch L_w6
L_w6c:
    s_mov_b32 s44, s46
    s_mov_b32 s45, 2
L_w6:
    s_mov_b32 s47, 0x204580
    s_cmp_eq_u32 s17, 0
    s_cbranch_scc0 L_wgw_16
    s_mov_b32 s20, s3
L_pg_17:
    s_mov_b64 exec, 1
    buffer_load_dword v2, off, s[8:11], s47 sc1
    s_waitcnt vmcnt(0)
    s_nop 0
    v_readfirstlane_b32 s19, v2
    s_mov_b64 exec, -1
    s_cmp_ge_u32 s19, 16
    s_cbranch_scc1 L_pg_17_d
    s_sleep 48
    s_sub_u32 s20, s20, 1
    s_cmp_lg_u32 s20, 0
    s_cbranch_scc1 L_pg_17
    s_mov_b32 s3, 1
L_pg_17_d:
L_wgw_16:
    s_barrier
    s_mov_b32 s12, s70
    s_mov_b32 s13, s71
    s_mov_b32 s14, 0x480000
    s_mov_b32 s15, 0x20000
    s_mov_b32 s32, s64
    s_mov_b32 s33, s65
    s_mov_b32 s34, 0x240000
    s_mov_b32 s35, 0x20000
    s_mov_b32 s36, s68
    s_mov_b32 s37, s69
    s_mov_b32 s38, 0x240000
    s_mov_b32 s39, 0x20000
    s_mov_b32 s76, s66
    s_mov_b32 s77, s67
    s_mov_b32 s78, 0x480
    s_mov_b32 s79, 0x20000
    v_lshlrev_b32 v1, 4, v0
    v_lshrrev_b32 v4, 2, v0
    s_movk_i32 s19, 1152
    v_mul_lo_u32 v4, v4, s19
    v_and_b32 v5, 3, v0
    v_lshl_add_u32 v3, v5, 4, v4
    v_lshrrev_b32 v4, 5, v0
    v_bfe_u32 v5, v0, 2, 2
    v_lshl_add_u32 v4, v4, 2, v5
    v_lshlrev_b32 v4, 6, v4
    v_bfe_u32 v5, v0, 4, 1
    v_lshl_add_u32 v4, v5, 5, v4
    v_and_b32 v5, 3, v0
    v_lshl_add_u32 v4, v5, 3, v4
    s_lshl_b32 s47, s17, 15
    v_add_u32 v2, s47, v4
    s_mul_i32 s48, s17, 1179648
    s_lshl_b32 s49, s44, 6
    s_add_u32 s48, s48, s49
    s_mov_b32 m0, s47
    s_nop 0
    buffer_load_dwordx4 v3, s[12:15], s48 offen lds
    s_add_u32 m0, m0, 1024
    s_add_u32 s48, s48, 18432
    buffer_load_dwordx4 v3, s[12:15], s48 offen lds
    s_add_u32 m0, m0, 1024
    s_add_u32 s48, s48, 18432
    buffer_load_dwordx4 v3, s[12:15], s48 offen lds
    s_add_u32 m0, m0, 1024
    s_add_u32 s48, s48, 18432
    buffer_load_dwordx4 v3, s[12:15], s48 offen lds
    s_add_u32 m0, m0, 1024
    s_add_u32 s48, s48, 18432
    buffer_load_dwordx4 v3, s[12:15], s48 offen lds
    s_add_u32 m0, m0, 1024
    s_add_u32 s48, s48, 18432
    buffer_load_dwordx4 v3, s[12:15], s48 offen lds
    s_add_u32 m0, m0, 1024
    s_add_u32 s48, s48, 18432
    buffer_load_dwordx4 v3, s[12:15], s48 offen lds
    s_add_u32 m0, m0, 1024
    s_add_u32 s48, s48, 18432
    buffer_load_dwordx4 v3, s[12:15], s48 offen lds
    s_add_u32 m0, m0, 1024
    s_add_u32 s48, s48, 18432
    buffer_load_dwordx4 v3, s[12:15], s48 offen lds
    s_add_u32 m0, m0, 1024
    s_add_u32 s48, s48, 18432
    buffer_load_dwordx4 v3, s[12:15], s48 offen lds
    s_add_u32 m0, m0, 1024
    s_add_u32 s48, s48, 18432
    buffer_load_dwordx4 v3, s[12:15], s48 offen lds
    s_add_u32 m0, m0, 1024
    s_add_u32 s48, s48, 18432
    buffer_load_dwordx4 v3, s[12:15], s48 offen lds
    s_add_u32 m0, m0, 1024
    s_add_u32 s48, s48, 18432
    buffer_load_dwordx4 v3, s[12:15], s48 offen lds
    s_add_u32 m0, m0, 1024
    s_add_u32 s48, s48, 18432
    buffer_load_dwordx4 v3, s[12:15], s48 offen lds
    s_add_u32 m0, m0, 1024
    s_add_u32 s48, s48, 18432
    buffer_load_dwordx4 v3, s[12:15], s48 offen lds
    s_add_u32 m0, m0, 1024
    s_add_u32 s48, s48, 18432
    buffer_load_dwordx4 v3, s[12:15], s48 offen lds
    s_add_u32 m0, m0, 1024
    s_add_u32 s48, s48, 18432
    buffer_load_dwordx4 v3, s[12:15], s48 offen lds
    s_add_u32 m0, m0, 1024
    s_add_u32 s48, s48, 18432
    buffer_load_dwordx4 v3, s[12:15], s48 offen lds
    s_add_u32 m0, m0, 1024
    s_add_u32 s48, s48, 18432
    buffer_load_dwordx4 v3, s[12:15], s48 offen lds
    s_add_u32 m0, m0, 1024
    s_add_u32 s48, s48, 18432
    buffer_load_dwordx4 v3, s[12:15], s48 offen lds
    s_add_u32 m0, m0, 1024
    s_add_u32 s48, s48, 18432
    buffer_load_dwordx4 v3, s[12:15], s48 offen lds
    s_add_u32 m0, m0, 1024
    s_add_u32 s48, s48, 18432
    buffer_load_dwordx4 v3, s[12:15], s48 offen lds
    s_add_u32 m0, m0, 1024
    s_add_u32 s48, s48, 18432
    buffer_load_dwordx4 v3, s[12:15], s48 offen lds
    s_add_u32 m0, m0, 1024
    s_add_u32 s48, s48, 18432
    buffer_load_dwordx4 v3, s[12:15], s48 offen lds
    s_add_u32 m0, m0, 1024
    s_add_u32 s48, s48, 18432
    buffer_load_dwordx4 v3, s[12:15], s48 offen lds
    s_add_u32 m0, m0, 1024
    s_add_u32 s48, s48, 18432
    buffer_load_dwordx4 v3, s[12:15], s48 offen lds
    s_add_u32 m0, m0, 1024
    s_add_u32 s48, s48, 18432
    buffer_load_dwordx4 v3, s[12:15], s48 offen lds
    s_add_u32 m0, m0, 1024
    s_add_u32 s48, s48, 18432
    buffer_load_dwordx4 v3, s[12:15], s48 offen lds
    s_add_u32 m0, m0, 1024
    s_add_u32 s48, s48, 18432
    buffer_load_dwordx4 v3, s[12:15], s48 offen lds
    s_add_u32 m0, m0, 1024
    s_add_u32 s48, s48, 18432
    buffer_load_dwordx4 v3, s[12:15], s48 offen lds
    s_add_u32 m0, m0, 1024
    s_add_u32 s48, s48, 18432
    buffer_load_dwordx4 v3, s[12:15], s48 offen lds
    s_add_u32 m0, m0, 1024
    s_add_u32 s48, s48, 18432
    buffer_load_dwordx4 v3, s[12:15], s48 offen lds
    s_add_u32 m0, m0, 1024
    s_add_u32 s48, s48, 18432
    s_waitcnt vmcnt(0)
    ds_read_b64_tr_b16 a[0:1], v2 offset:0
    ds_read_b64_tr_b16 a[2:3], v2 offset:512
    ds_read_b64_tr_b16 a[4:5], v2 offset:1024
    ds_read_b64_tr_b16 a[6:7], v2 offset:1536
    ds_read_b64_tr_b16 a[8:9], v2 offset:2048
    ds_read_b64_tr_b16 a[10:11], v2 offset:2560
    ds_read_b64_tr_b16 a[12:13], v2 offset:3072
    ds_read_b64_tr_b16 a[14:15], v2 offset:3584
    ds_read_b64_tr_b16 a[16:17], v2 offset:4096
    ds_read_b64_tr_b16 a[18:19], v2 offset:4608
    ds_read_b64_tr_b16 a[20:21], v2 offset:5120
    ds_read_b64_tr_b16 a[22:23], v2 offset:5632
    ds_read_b64_tr_b16 a[24:25], v2 offset:6144
    ds_read_b64_tr_b16 a[26:27], v2 offset:6656
    ds_read_b64_tr_b16 a[28:29], v2 offset:7168
    ds_read_b64_tr_b16 a[30:31], v2 offset:7680
    ds_read_b64_tr_b16 a[32:33], v2 offset:8192
    ds_read_b64_tr_b16 a[34:35], v2 offset:8704
    ds_read_b64_tr_b16 a[36:37], v2 offset:9216
    ds_read_b64_tr_b16 a[38:39], v2 offset:9728
    ds_read_b64_tr_b16 a[40:41], v2 offset:10240
    ds_read_b64_tr_b16 a[42:43], v2 offset:10752
    ds_read_b64_tr_b16 a[44:45], v2 offset:11264
    ds_read_b64_tr_b16 a[46:47], v2 offset:11776
    ds_read_b64_tr_b16 a[48:49], v2 offset:12288
    ds_read_b64_tr_b16 a[50:51], v2 offset:12800
    ds_read_b64_tr_b16 a[52:53], v2 offset:13312
    ds_read_b64_tr_b16 a[54:55], v2 offset:13824
    ds_read_b64_tr_b16 a[56:57], v2 offset:14336
    ds_read_b64_tr_b16 a[58:59], v2 offset:14848
    ds_read_b64_tr_b16 a[60:61], v2 offset:15360
    ds_read_b64_tr_b16 a[62:63], v2 offset:15872
    ds_read_b64_tr_b16 a[64:65], v2 offset:16384
    ds_read_b64_tr_b16 a[66:67], v2 offset:16896
    ds_read_b64_tr_b16 a[68:69], v2 offset:17408
    ds_read_b64_tr_b16 a[70:71], v2 offset:17920
    ds_read_b64_tr_b16 a[72:73], v2 offset:18432
    ds_read_b64_tr_b16 a[74:75], v2 offset:18944
    ds_read_b64_tr_b16 a[76:77], v2 offset:19456
    ds_read_b64_tr_b16 a[78:79], v2 offset:19968
    ds_read_b64_tr_b16 a[80:81], v2 offset:20480
    ds_read_b64_tr_b16 a[82:83], v2 offset:20992
    ds_read_b64_tr_b16 a[84:85], v2 offset:21504
    ds_read_b64_tr_b16 a[86:87], v2 offset:22016
    ds_read_b64_tr_b16 a[88:89], v2 offset:22528
    ds_read_b64_tr_b16 a[90:91], v2 offset:23040
    ds_read_b64_tr_b16 a[92:93], v2 offset:23552
    ds_read_b64_tr_b16 a[94:95], v2 offset:24064
    ds_read_b64_tr_b16 a[96:97], v2 offset:24576
    ds_read_b64_tr_b16 a[98:99], v2 offset:25088
    ds_read_b64_tr_b16 a[100:101], v2 offset:25600
    ds_read_b64_tr_b16 a[102:103], v2 offset:26112
    ds_read_b64_tr_b16 a[104:105], v2 offset:26624
    ds_read_b64_tr_b16 a[106:107], v2 offset:27136
    ds_read_b64_tr_b16 a[108:109], v2 offset:27648
    ds_read_b64_tr_b16 a[110:111], v2 offset:28160
    ds_read_b64_tr_b16 a[112:113], v2 offset:28672
    ds_read_b64_tr_b16 a[114:115], v2 offset:29184
    ds_read_b64_tr_b16 a[116:117], v2 offset:29696
    ds_read_b64_tr_b16 a[118:119], v2 offset:30208
    ds_read_b64_tr_b16 a[120:121], v2 offset:30720
    ds_read_b64_tr_b16 a[122:123], v2 offset:31232
    ds_read_b64_tr_b16 a[124:125], v2 offset:31744
    ds_read_b64_tr_b16 a[126:127], v2 offset:32256
    s_waitcnt lgkmcnt(0)
    s_mov_b32 m0, s47
    s_nop 0
    buffer_load_dwordx4 v3, s[12:15], s48 offen lds
    s_add_u32 m0, m0, 1024
    s_add_u32 s48, s48, 18432
    buffer_load_dwordx4 v3, s[12:15], s48 offen lds
    s_add_u32 m0, m0, 1024
    s_add_u32 s48, s48, 18432
    buffer_load_dwordx4 v3, s[12:15], s48 offen lds
    s_add_u32 m0, m0, 1024
    s_add_u32 s48, s48, 18432
    buffer_load_dwordx4 v3, s[12:15], s48 offen lds
    s_add_u32 m0, m0, 1024
    s_add_u32 s48, s48, 18432
    buffer_load_dwordx4 v3, s[12:15], s48 offen lds
    s_add_u32 m0, m0, 1024
    s_add_u32 s48, s48, 18432
    buffer_load_dwordx4 v3, s[12:15], s48 offen lds
    s_add_u32 m0, m0, 1024
    s_add_u32 s48, s48, 18432
    buffer_load_dwordx4 v3, s[12:15], s48 offen lds
    s_add_u32 m0, m0, 1024
    s_add_u32 s48, s48, 18432
    buffer_load_dwordx4 v3, s[12:15], s48 offen lds
    s_add_u32 m0, m0, 1024
    s_add_u32 s48, s48, 18432
    buffer_load_dwordx4 v3, s[12:15], s48 offen lds
    s_add_u32 m0, m0, 1024
    s_add_u32 s48, s48, 18432
    buffer_load_dwordx4 v3, s[12:15], s48 offen lds
    s_add_u32 m0, m0, 1024
    s_add_u32 s48, s48, 18432
    buffer_load_dwordx4 v3, s[12:15], s48 offen lds
    s_add_u32 m0, m0, 1024
    s_add_u32 s48, s48, 18432
    buffer_load_dwordx4 v3, s[12:15], s48 offen lds
    s_add_u32 m0, m0, 1024
    s_add_u32 s48, s48, 18432
    buffer_load_dwordx4 v3, s[12:15], s48 offen lds
    s_add_u32 m0, m0, 1024
    s_add_u32 s48, s48, 18432
    buffer_load_dwordx4 v3, s[12:15], s48 offen lds
    s_add_u32 m0, m0, 1024
    s_add_u32 s48, s48, 18432
    buffer_load_dwordx4 v3, s[12:15], s48 offen lds
    s_add_u32 m0, m0, 1024
    s_add_u32 s48, s48, 18432
    buffer_load_dwordx4 v3, s[12:15], s48 offen lds
    s_add_u32 m0, m0, 1024
    s_add_u32 s48, s48, 18432
    buffer_load_dwordx4 v3, s[12:15], s48 offen lds
    s_add_u32 m0, m0, 1024
    s_add_u32 s48, s48, 18432
    buffer_load_dwordx4 v3, s[12:15], s48 offen lds
    s_add_u32 m0, m0, 1024
    s_add_u32 s48, s48, 18432
    buffer_load_dwordx4 v3, s[12:15], s48 offen lds
    s_add_u32 m0, m0, 1024
    s_add_u32 s48, s48, 18432
    buffer_load_dwordx4 v3, s[12:15], s48 offen lds
    s_add_u32 m0, m0, 1024
    s_add_u32 s48, s48, 18432
    buffer_load_dwordx4 v3, s[12:15], s48 offen lds
    s_add_u32 m0, m0, 1024
    s_add_u32 s48, s48, 18432
    buffer_load_dwordx4 v3, s[12:15], s48 offen lds
    s_add_u32 m0, m0, 1024
    s_add_u32 s48, s48, 18432
    buffer_load_dwordx4 v3, s[12:15], s48 offen lds
    s_add_u32 m0, m0, 1024
    s_add_u32 s48, s48, 18432
    buffer_load_dwordx4 v3, s[12:15], s48 offen lds
    s_add_u32 m0, m0, 1024
    s_add_u32 s48, s48, 18432
    buffer_load_dwordx4 v3, s[12:15], s48 offen lds
    s_add_u32 m0, m0, 1024
    s_add_u32 s48, s48, 18432
    buffer_load_dwordx4 v3, s[12:15], s48 offen lds
    s_add_u32 m0, m0, 1024
    s_add_u32 s48, s48, 18432
    buffer_load_dwordx4 v3, s[12:15], s48 offen lds
    s_add_u32 m0, m0, 1024
    s_add_u32 s48, s48, 18432
    buffer_load_dwordx4 v3, s[12:15], s48 offen lds
    s_add_u32 m0, m0, 1024
    s_add_u32 s48, s48, 18432
    buffer_load_dwordx4 v3, s[12:15], s48 offen lds
    s_add_u32 m0, m0, 1024
    s_add_u32 s48, s48, 18432
    buffer_load_dwordx4 v3, s[12:15], s48 offen lds
    s_add_u32 m0, m0, 1024
    s_add_u32 s48, s48, 18432
    buffer_load_dwordx4 v3, s[12:15], s48 offen lds
    s_add_u32 m0, m0, 1024
    s_add_u32 s48, s48, 18432
    buffer_load_dwordx4 v3, s[12:15], s48 offen lds
    s_add_u32 m0, m0, 1024
    s_add_u32 s48, s48, 18432
    s_waitcnt vmcnt(0)
    ds_read_b64_tr_b16 a[128:129], v2 offset:0
    ds_read_b64_tr_b16 a[130:131], v2 offset:512
    ds_read_b64_tr_b16 a[132:133], v2 offset:1024
    ds_read_b64_tr_b16 a[134:135], v2 offset:1536
    ds_read_b64_tr_b16 a[136:137], v2 offset:2048
    ds_read_b64_tr_b16 a[138:139], v2 offset:2560
    ds_read_b64_tr_b16 a[140:141], v2 offset:3072
    ds_read_b64_tr_b16 a[142:143], v2 offset:3584
    ds_read_b64_tr_b16 a[144:145], v2 offset:4096
    ds_read_b64_tr_b16 a[146:147], v2 offset:4608
    ds_read_b64_tr_b16 a[148:149], v2 offset:5120
    ds_read_b64_tr_b16 a[150:151], v2 offset:5632
    ds_read_b64_tr_b16 a[152:153], v2 offset:6144
    ds_read_b64_tr_b16 a[154:155], v2 offset:6656
    ds_read_b64_tr_b16 a[156:157], v2 offset:7168
    ds_read_b64_tr_b16 a[158:159], v2 offset:7680
    ds_read_b64_tr_b16 a[160:161], v2 offset:8192
    ds_read_b64_tr_b16 a[162:163], v2 offset:8704
    ds_read_b64_tr_b16 a[164:165], v2 offset:9216
    ds_read_b64_tr_b16 a[166:167], v2 offset:9728
    ds_read_b64_tr_b16 a[168:169], v2 offset:10240
    ds_read_b64_tr_b16 a[170:171], v2 offset:10752
    ds_read_b64_tr_b16 a[172:173], v2 offset:11264
    ds_read_b64_tr_b16 a[174:175], v2 offset:11776
    ds_read_b64_tr_b16 a[176:177], v2 offset:12288
    ds_read_b64_tr_b16 a[178:179], v2 offset:12800
    ds_read_b64_tr_b16 a[180:181], v2 offset:13312
    ds_read_b64_tr_b16 a[182:183], v2 offset:13824
    ds_read_b64_tr_b16 a[184:185], v2 offset:14336
    ds_read_b64_tr_b16 a[186:187], v2 offset:14848
    ds_read_b64_tr_b16 a[188:189], v2 offset:15360
    ds_read_b64_tr_b16 a[190:191], v2 offset:15872
    ds_read_b64_tr_b16 a[192:193], v2 offset:16384
    ds_read_b64_tr_b16 a[194:195], v2 offset:16896
    ds_read_b64_tr_b16 a[196:197], v2 offset:17408
    ds_read_b64_tr_b16 a[198:199], v2 offset:17920
    ds_read_b64_tr_b16 a[200:201], v2 offset:18432
    ds_read_b64_tr_b16 a[202:203], v2 offset:18944
    ds_read_b64_tr_b16 a[204:205], v2 offset:19456
    ds_read_b64_tr_b16 a[206:207], v2 offset:19968
    ds_read_b64_tr_b16 a[208:209], v2 offset:20480
    ds_read_b64_tr_b16 a[210:211], v2 offset:20992
    ds_read_b64_tr_b16 a[212:213], v2 offset:21504
    ds_read_b64_tr_b16 a[214:215], v2 offset:22016
    ds_read_b64_tr_b16 a[216:217], v2 offset:22528
    ds_read_b64_tr_b16 a[218:219], v2 offset:23040
    ds_read_b64_tr_b16 a[220:221], v2 offset:23552
    ds_read_b64_tr_b16 a[222:223], v2 offset:24064
    ds_read_b64_tr_b16 a[224:225], v2 offset:24576
    ds_read_b64_tr_b16 a[226:227], v2 offset:25088
    ds_read_b64_tr_b16 a[228:229], v2 offset:25600
    ds_read_b64_tr_b16 a[230:231], v2 offset:26112
    ds_read_b64_tr_b16 a[232:233], v2 offset:26624
    ds_read_b64_tr_b16 a[234:235], v2 offset:27136
    ds_read_b64_tr_b16 a[236:237], v2 offset:27648
    ds_read_b64_tr_b16 a[238:239], v2 offset:28160
    ds_read_b64_tr_b16 a[240:241], v2 offset:28672
    ds_read_b64_tr_b16 a[242:243], v2 offset:29184
    ds_read_b64_tr_b16 a[244:245], v2 offset:29696
    ds_read_b64_tr_b16 a[246:247], v2 offset:30208
    ds_read_b64_tr_b16 a[248:249], v2 offset:30720
    ds_read_b64_tr_b16 a[250:251], v2 offset:31232
    ds_read_b64_tr_b16 a[252:253], v2 offset:31744
    ds_read_b64_tr_b16 a[254:255], v2 offset:32256
    s_waitcnt lgkmcnt(0)
    v_and_b32 v4, 31, v0
    s_movk_i32 s19, 1152
    v_mul_lo_u32 v4, v4, s19
    v_lshrrev_b32 v5, 5, v0
    v_lshlrev_b32 v5, 4, v5
    v_add_u32 v4, v4, v5
    s_barrier
L_w6_loop:
    s_lshr_b32 s50, s45, 3
    s_lshl_b32 s50, s50, 7
    s_add_u32 s50, s50, 0x201080
    s_cmp_eq_u32 s17, 0
    s_cbranch_scc0 L_wgw_18
    s_mov_b32 s20, s3
L_pg_19:
    s_mov_b64 exec, 1
    buffer_load_dword v8, off, s[8:11], s50 sc1
    s_waitcnt vmcnt(0)
    s_nop 0
    v_readfirstlane_b32 s19, v8
    s_mov_b64 exec, -1
    s_cmp_ge_u32 s19, 24
    s_cbranch_scc1 L_pg_19_d
    s_sleep 32
    s_sub_u32 s20, s20, 1
    s_cmp_lg_u32 s20, 0
    s_cbranch_scc1 L_pg_19
    s_mov_b32 s3, 1
L_pg_19_d:
L_wgw_18:
    s_barrier
    s_lshl_b32 s51, s17, 6
    s_add_u32 s51, s51, s45
    s_mul_i32 s51, s51, 18
    s_add_u32 s51, s51, s44
    s_lshl_b32 s51, s51, 12
    s_add_u32 s51, s51, 0x7400000
    buffer_load_dwordx4 v[208:211], v1, s[8:11], s51 offen offset:0
    buffer_load_dwordx4 v[212:215], v1, s[8:11], s51 offen offset:1024
    buffer_load_dwordx4 v[216:219], v1, s[8:11], s51 offen offset:2048
    buffer_load_dwordx4 v[220:223], v1, s[8:11], s51 offen offset:3072
    s_lshl_b32 s50, s45, 7
    s_add_u32 s50, s50, 0x202480
    s_cmp_eq_u32 s17, 0
    s_cbranch_scc0 L_wgw_20
    s_mov_b32 s20, s3
L_pg_21:
    s_mov_b64 exec, 1
    buffer_load_dword v8, off, s[8:11], s50 sc1
    s_waitcnt vmcnt(0)
    s_nop 0
    v_readfirstlane_b32 s19, v8
    s_mov_b64 exec, -1
    s_cmp_ge_u32 s19, 32
    s_cbranch_scc1 L_pg_21_d
    s_sleep 4
    s_sub_u32 s20, s20, 1
    s_cmp_lg_u32 s20, 0
    s_cbranch_scc1 L_pg_21
    s_mov_b32 s3, 1
L_pg_21_d:
L_wgw_20:
    s_barrier
    s_lshl_b32 s52, s45, 18
    s_lshl_b32 s53, s17, 16
    s_add_u32 s52, s52, s53
    s_add_u32 s52, s52, 0x4000000
    s_add_u32 s53, s52, 0
    buffer_load_dwordx4 v[16:19], v1, s[8:11], s53 offen offset:0
    buffer_load_dwordx4 v[20:23], v1, s[8:11], s53 offen offset:1024
    buffer_load_dwordx4 v[24:27], v1, s[8:11], s53 offen offset:2048
    buffer_load_dwordx4 v[28:31], v1, s[8:11], s53 offen offset:3072
    s_add_u32 s53, s52, 4096
    buffer_load_dwordx4 v[32:35], v1, s[8:11], s53 offen offset:0
    buffer_load_dwordx4 v[36:39], v1, s[8:11], s53 offen offset:1024
    buffer_load_dwordx4 v[40:43], v1, s[8:11], s53 offen offset:2048
    buffer_load_dwordx4 v[44:47], v1, s[8:11], s53 offen offset:3072
    s_add_u32 s53, s52, 8192
    buffer_load_dwordx4 v[48:51], v1, s[8:11], s53 offen offset:0
    buffer_load_dwordx4 v[52:55], v1, s[8:11], s53 offen offset:1024
    buffer_load_dwordx4 v[56:59], v1, s[8:11], s53 offen offset:2048
    buffer_load_dwordx4 v[60:63], v1, s[8:11], s53 offen offset:3072
    s_add_u32 s53, s52, 12288
    buffer_load_dwordx4 v[64:67], v1, s[8:11], s53 offen offset:0
    buffer_load_dwordx4 v[68:71], v1, s[8:11], s53 offen offset:1024
    buffer_load_dwordx4 v[72:75], v1, s[8:11], s53 offen offset:2048
    buffer_load_dwordx4 v[76:79], v1, s[8:11], s53 offen offset:3072
    s_add_u32 s53, s52, 16384
    buffer_load_dwordx4 v[80:83], v1, s[8:11], s53 offen offset:0
    buffer_load_dwordx4 v[84:87], v1, s[8:11], s53 offen offset:1024
    buffer_load_dwordx4 v[88:91], v1, s[8:11], s53 offen offset:2048
    buffer_load_dwordx4 v[92:95], v1, s[8:11], s53 offen offset:3072
    s_add_u32 s53, s52, 20480
    buffer_load_dwordx4 v[96:99], v1, s[8:11], s53 offen offset:0
    buffer_load_dwordx4 v[100:103], v1, s[8:11], s53 offen offset:1024
    buffer_load_dwordx4 v[104:107], v1, s[8:11], s53 offen offset:2048
    buffer_load_dwordx4 v[108:111], v1, s[8:11], s53 offen offset:3072
    s_add_u32 s53, s52, 24576
    buffer_load_dwordx4 v[112:115], v1, s[8:11], s53 offen offset:0
    buffer_load_dwordx4 v[116:119], v1, s[8:11], s53 offen offset:1024
    buffer_load_dwordx4 v[120:123], v1, s[8:11], s53 offen offset:2048
    buffer_load_dwordx4 v[124:127], v1, s[8:11], s53 offen offset:3072
    s_add_u32 s53, s52, 28672
    buffer_load_dwordx4 v[128:131], v1, s[8:11], s53 offen offset:0
    buffer_load_dwordx4 v[132:135], v1, s[8:11], s53 offen offset:1024
    buffer_load_dwordx4 v[136:139], v1, s[8:11], s53 offen offset:2048
    buffer_load_dwordx4 v[140:143], v1, s[8:11], s53 offen offset:3072
    s_add_u32 s53, s52, 32768
    buffer_load_dwordx4 v[144:147], v1, s[8:11], s53 offen offset:0
    buffer_load_dwordx4 v[148:151], v1, s[8:11], s53 offen offset:1024
    buffer_load_dwordx4 v[152:155], v1, s[8:11], s53 offen offset:2048
    buffer_load_dwordx4 v[156:159], v1, s[8:11], s53 offen offset:3072
    s_add_u32 s53, s52, 36864
    buffer_load_dwordx4 v[160:163], v1, s[8:11], s53 offen offset:0
    buffer_load_dwordx4 v[164:167], v1, s[8:11], s53 offen offset:1024
    buffer_load_dwordx4 v[168:171], v1, s[8:11], s53 offen offset:2048
    buffer_load_dwordx4 v[172:175], v1, s[8:11], s53 offen offset:3072
    s_add_u32 s53, s52, 40960
    buffer_load_dwordx4 v[176:179], v1, s[8:11], s53 offen offset:0
    buffer_load_dwordx4 v[180:183], v1, s[8:11], s53 offen offset:1024
    buffer_load_dwordx4 v[184:187], v1, s[8:11], s53 offen offset:2048
    buffer_load_dwordx4 v[188:191], v1, s[8:11], s53 offen offset:3072
    s_add_u32 s53, s52, 45056
    buffer_load_dwordx4 v[192:195], v1, s[8:11], s53 offen offset:0
    buffer_load_dwordx4 v[196:199], v1, s[8:11], s53 offen offset:1024
    buffer_load_dwordx4 v[200:203], v1, s[8:11], s53 offen offset:2048
    buffer_load_dwordx4 v[204:207], v1, s[8:11], s53 offen offset:3072
    s_waitcnt vmcnt(47)
    v_mfma_f32_32x32x16_bf16 v[208:223], a[0:3], v[16:19], v[208:223]
    s_waitcnt vmcnt(46)
    v_mfma_f32_32x32x16_bf16 v[208:223], a[4:7], v[20:23], v[208:223]
    s_waitcnt vmcnt(45)
    v_mfma_f32_32x32x16_bf16 v[208:223], a[8:11], v[24:27], v[208:223]
    s_waitcnt vmcnt(44)
    v_mfma_f32_32x32x16_bf16 v[208:223], a[12:15], v[28:31], v[208:223]
    s_waitcnt vmcnt(43)
    v_mfma_f32_32x32x16_bf16 v[208:223], a[16:19], v[32:35], v[208:223]
    s_waitcnt vmcnt(42)
    v_mfma_f32_32x32x16_bf16 v[208:223], a[20:23], v[36:39], v[208:223]
    s_waitcnt vmcnt(41)
    v_mfma_f32_32x32x16_bf16 v[208:223], a[24:27], v[40:43], v[208:223]
    s_waitcnt vmcnt(40)
    v_mfma_f32_32x32x16_bf16 v[208:223], a[28:31], v[44:47], v[208:223]
    s_waitcnt vmcnt(39)
    v_mfma_f32_32x32x16_bf16 v[208:223], a[32:35], v[48:51], v[208:223]
    s_waitcnt vmcnt(38)
    v_mfma_f32_32x32x16_bf16 v[208:223], a[36:39], v[52:55], v[208:223]
    s_waitcnt vmcnt(37)
    v_mfma_f32_32x32x16_bf16 v[208:223], a[40:43], v[56:59], v[208:223]
    s_waitcnt vmcnt(36)
    v_mfma_f32_32x32x16_bf16 v[208:223], a[44:47], v[60:63], v[208:223]
    s_waitcnt vmcnt(35)
    v_mfma_f32_32x32x16_bf16 v[208:223], a[48:51], v[64:67], v[208:223]
    s_waitcnt vmcnt(34)
    v_mfma_f32_32x32x16_bf16 v[208:223], a[52:55], v[68:71], v[208:223]
    s_waitcnt vmcnt(33)
    v_mfma_f32_32x32x16_bf16 v[208:223], a[56:59], v[72:75], v[208:223]
    s_waitcnt vmcnt(32)
    v_mfma_f32_32x32x16_bf16 v[208:223], a[60:63], v[76:79], v[208:223]
    s_add_u32 s53, s52, 49152
    buffer_load_dwordx4 v[16:19], v1, s[8:11], s53 offen offset:0
    buffer_load_dwordx4 v[20:23], v1, s[8:11], s53 offen offset:1024
    buffer_load_dwordx4 v[24:27], v1, s[8:11], s53 offen offset:2048
    buffer_load_dwordx4 v[28:31], v1, s[8:11], s53 offen offset:3072
    s_add_u32 s53, s52, 53248
    buffer_load_dwordx4 v[32:35], v1, s[8:11], s53 offen offset:0
    buffer_load_dwordx4 v[36:39], v1, s[8:11], s53 offen offset:1024
    buffer_load_dwordx4 v[40:43], v1, s[8:11], s53 offen offset:2048
    buffer_load_dwordx4 v[44:47], v1, s[8:11], s53 offen offset:3072
    s_add_u32 s53, s52, 57344
    buffer_load_dwordx4 v[48:51], v1, s[8:11], s53 offen offset:0
    buffer_load_dwordx4 v[52:55], v1, s[8:11], s53 offen offset:1024
    buffer_load_dwordx4 v[56:59], v1, s[8:11], s53 offen offset:2048
    buffer_load_dwordx4 v[60:63], v1, s[8:11], s53 offen offset:3072
    s_add_u32 s53, s52, 61440
    buffer_load_dwordx4 v[64:67], v1, s[8:11], s53 offen offset:0
    buffer_load_dwordx4 v[68:71], v1, s[8:11], s53 offen offset:1024
    buffer_load_dwordx4 v[72:75], v1, s[8:11], s53 offen offset:2048
    buffer_load_dwordx4 v[76:79], v1, s[8:11], s53 offen offset:3072
    s_waitcnt vmcnt(47)
    v_mfma_f32_32x32x16_bf16 v[208:223], a[64:67], v[80:83], v[208:223]
    s_waitcnt vmcnt(46)
    v_mfma_f32_32x32x16_bf16 v[208:223], a[68:71], v[84:87], v[208:223]
    s_waitcnt vmcnt(45)
    v_mfma_f32_32x32x16_bf16 v[208:223], a[72:75], v[88:91], v[208:223]
    s_waitcnt vmcnt(44)
    v_mfma_f32_32x32x16_bf16 v[208:223], a[76:79], v[92:95], v[208:223]
    s_waitcnt vmcnt(43)
    v_mfma_f32_32x32x16_bf16 v[208:223], a[80:83], v[96:99], v[208:223]
    s_waitcnt vmcnt(42)
    v_mfma_f32_32x32x16_bf16 v[208:223], a[84:87], v[100:103], v[208:223]
    s_waitcnt vmcnt(41)
    v_mfma_f32_32x32x16_bf16 v[208:223], a[88:91], v[104:107], v[208:223]
    s_waitcnt vmcnt(40)
    v_mfma_f32_32x32x16_bf16 v[208:223], a[92:95], v[108:111], v[208:223]
    s_waitcnt vmcnt(39)
    v_mfma_f32_32x32x16_bf16 v[208:223], a[96:99], v[112:115], v[208:223]
    s_waitcnt vmcnt(38)
    v_mfma_f32_32x32x16_bf16 v[208:223], a[100:103], v[116:119], v[208:223]
    s_waitcnt vmcnt(37)
    v_mfma_f32_32x32x16_bf16 v[208:223], a[104:107], v[120:123], v[208:223]
    s_waitcnt vmcnt(36)
    v_mfma_f32_32x32x16_bf16 v[208:223], a[108:111], v[124:127], v[208:223]
    s_waitcnt vmcnt(35)
    v_mfma_f32_32x32x16_bf16 v[208:223], a[112:115], v[128:131], v[208:223]
    s_waitcnt vmcnt(34)
    v_mfma_f32_32x32x16_bf16 v[208:223], a[116:119], v[132:135], v[208:223]
    s_waitcnt vmcnt(33)
    v_mfma_f32_32x32x16_bf16 v[208:223], a[120:123], v[136:139], v[208:223]
    s_waitcnt vmcnt(32)
    v_mfma_f32_32x32x16_bf16 v[208:223], a[124:127], v[140:143], v[208:223]
    s_waitcnt vmcnt(31)
    v_mfma_f32_32x32x16_bf16 v[208:223], a[128:131], v[144:147], v[208:223]
    s_waitcnt vmcnt(30)
    v_mfma_f32_32x32x16_bf16 v[208:223], a[132:135], v[148:151], v[208:223]
    s_waitcnt vmcnt(29)
    v_mfma_f32_32x32x16_bf16 v[208:223], a[136:139], v[152:155], v[208:223]
    s_waitcnt vmcnt(28)
    v_mfma_f32_32x32x16_bf16 v[208:223], a[140:143], v[156:159], v[208:223]
    s_waitcnt vmcnt(27)
    v_mfma_f32_32x32x16_bf16 v[208:223], a[144:147], v[160:163], v[208:223]
    s_waitcnt vmcnt(26)
    v_mfma_f32_32x32x16_bf16 v[208:223], a[148:151], v[164:167], v[208:223]
    s_waitcnt vmcnt(25)
    v_mfma_f32_32x32x16_bf16 v[208:223], a[152:155], v[168:171], v[208:223]
    s_waitcnt vmcnt(24)
    v_mfma_f32_32x32x16_bf16 v[208:223], a[156:159], v[172:175], v[208:223]
    s_waitcnt vmcnt(23)
    v_mfma_f32_32x32x16_bf16 v[208:223], a[160:163], v[176:179], v[208:223]
    s_waitcnt vmcnt(22)
    v_mfma_f32_32x32x16_bf16 v[208:223], a[164:167], v[180:183], v[208:223]
    s_waitcnt vmcnt(21)
    v_mfma_f32_32x32x16_bf16 v[208:223], a[168:171], v[184:187], v[208:223]
    s_waitcnt vmcnt(20)
    v_mfma_f32_32x32x16_bf16 v[208:223], a[172:175], v[188:191], v[208:223]
    s_waitcnt vmcnt(19)
    v_mfma_f32_32x32x16_bf16 v[208:223], a[176:179], v[192:195], v[208:223]
    s_waitcnt vmcnt(18)
    v_mfma_f32_32x32x16_bf16 v[208:223], a[180:183], v[196:199], v[208:223]
    s_waitcnt vmcnt(17)
    v_mfma_f32_32x32x16_bf16 v[208:223], a[184:187], v[200:203], v[208:223]
    s_waitcnt vmcnt(16)
    v_mfma_f32_32x32x16_bf16 v[208:223], a[188:191], v[204:207], v[208:223]
    s_waitcnt vmcnt(15)
    v_mfma_f32_32x32x16_bf16 v[208:223], a[192:195], v[16:19], v[208:223]
    s_waitcnt vmcnt(14)
    v_mfma_f32_32x32x16_bf16 v[208:223], a[196:199], v[20:23], v[208:223]
    s_waitcnt vmcnt(13)
    v_mfma_f32_32x32x16_bf16 v[208:223], a[200:203], v[24:27], v[208:223]
    s_waitcnt vmcnt(12)
    v_mfma_f32_32x32x16_bf16 v[208:223], a[204:207], v[28:31], v[208:223]
    s_waitcnt vmcnt(11)
    v_mfma_f32_32x32x16_bf16 v[208:223], a[208:211], v[32:35], v[208:223]
    s_waitcnt vmcnt(10)
    v_mfma_f32_32x32x16_bf16 v[208:223], a[212:215], v[36:39], v[208:223]
    s_waitcnt vmcnt(9)
    v_mfma_f32_32x32x16_bf16 v[208:223], a[216:219], v[40:43], v[208:223]
    s_waitcnt vmcnt(8)
    v_mfma_f32_32x32x16_bf16 v[208:223], a[220:223], v[44:47], v[208:223]
    s_waitcnt vmcnt(7)
    v_mfma_f32_32x32x16_bf16 v[208:223], a[224:227], v[48:51], v[208:223]
    s_waitcnt vmcnt(6)
    v_mfma_f32_32x32x16_bf16 v[208:223], a[228:231], v[52:55], v[208:223]
    s_waitcnt vmcnt(5)
    v_mfma_f32_32x32x16_bf16 v[208:223], a[232:235], v[56:59], v[208:223]
    s_waitcnt vmcnt(4)
    v_mfma_f32_32x32x16_bf16 v[208:223], a[236:239], v[60:63], v[208:223]
    s_waitcnt vmcnt(3)
    v_mfma_f32_32x32x16_bf16 v[208:223], a[240:243], v[64:67], v[208:223]
    s_waitcnt vmcnt(2)
    v_mfma_f32_32x32x16_bf16 v[208:223], a[244:247], v[68:71], v[208:223]
    s_waitcnt vmcnt(1)
    v_mfma_f32_32x32x16_bf16 v[208:223], a[248:251], v[72:75], v[208:223]
    s_waitcnt vmcnt(0)
    v_mfma_f32_32x32x16_bf16 v[208:223], a[252:255], v[76:79], v[208:223]
    s_cmp_eq_u32 s17, 0
    s_cbranch_scc1 L_w6_r0
    s_lshl_b32 s53, s17, 12
    v_add_u32 v8, s53, v1
    s_nop 7
    ds_write_b128 v8, v[208:211] offset:0
    ds_write_b128 v8, v[212:215] offset:1024
    ds_write_b128 v8, v[216:219] offset:2048
    ds_write_b128 v8, v[220:223] offset:3072
    s_waitcnt lgkmcnt(0)
    s_barrier
    s_barrier
    s_branch L_w6_next
L_w6_r0:
    s_mul_i32 s53, s45, 36864
    s_lshl_b32 s54, s44, 6
    s_add_u32 s53, s53, s54
    buffer_load_dwordx4 v[16:19], v4, s[32:35], s53 offen offset:0
    buffer_load_dwordx4 v[20:23], v5, s[76:79], s54 offen offset:0
    buffer_load_dwordx4 v[24:27], v4, s[32:35], s53 offen offset:32
    buffer_load_dwordx4 v[28:31], v5, s[76:79], s54 offen offset:32
    s_barrier
    ds_read_b128 v[32:35], v1 offset:4096
    ds_read_b128 v[36:39], v1 offset:5120
    ds_read_b128 v[40:43], v1 offset:6144
    ds_read_b128 v[44:47], v1 offset:7168
    s_waitcnt lgkmcnt(3)
    v_pk_add_f32 v[208:209], v[208:209], v[32:33]
    v_pk_add_f32 v[210:211], v[210:211], v[34:35]
    s_waitcnt lgkmcnt(2)
    v_pk_add_f32 v[212:213], v[212:213], v[36:37]
    v_pk_add_f32 v[214:215], v[214:215], v[38:39]
    s_waitcnt lgkmcnt(1)
    v_pk_add_f32 v[216:217], v[216:217], v[40:41]
    v_pk_add_f32 v[218:219], v[218:219], v[42:43]
    s_waitcnt lgkmcnt(0)
    v_pk_add_f32 v[220:221], v[220:221], v[44:45]
    v_pk_add_f32 v[222:223], v[222:223], v[46:47]
    ds_read_b128 v[32:35], v1 offset:8192
    ds_read_b128 v[36:39], v1 offset:9216
    ds_read_b128 v[40:43], v1 offset:10240
    ds_read_b128 v[44:47], v1 offset:11264
    s_waitcnt lgkmcnt(3)
    v_pk_add_f32 v[208:209], v[208:209], v[32:33]
    v_pk_add_f32 v[210:211], v[210:211], v[34:35]
    s_waitcnt lgkmcnt(2)
    v_pk_add_f32 v[212:213], v[212:213], v[36:37]
    v_pk_add_f32 v[214:215], v[214:215], v[38:39]
    s_waitcnt lgkmcnt(1)
    v_pk_add_f32 v[216:217], v[216:217], v[40:41]
    v_pk_add_f32 v[218:219], v[218:219], v[42:43]
    s_waitcnt lgkmcnt(0)
    v_pk_add_f32 v[220:221], v[220:221], v[44:45]
    v_pk_add_f32 v[222:223], v[222:223], v[46:47]
    ds_read_b128 v[32:35], v1 offset:12288
    ds_read_b128 v[36:39], v1 offset:13312
    ds_read_b128 v[40:43], v1 offset:14336
    ds_read_b128 v[44:47], v1 offset:15360
    s_waitcnt lgkmcnt(3)
    v_pk_add_f32 v[208:209], v[208:209], v[32:33]
    v_pk_add_f32 v[210:211], v[210:211], v[34:35]
    s_waitcnt lgkmcnt(2)
    v_pk_add_f32 v[212:213], v[212:213], v[36:37]
    v_pk_add_f32 v[214:215], v[214:215], v[38:39]
    s_waitcnt lgkmcnt(1)
    v_pk_add_f32 v[216:217], v[216:217], v[40:41]
    v_pk_add_f32 v[218:219], v[218:219], v[42:43]
    s_waitcnt lgkmcnt(0)
    v_pk_add_f32 v[220:221], v[220:221], v[44:45]
    v_pk_add_f32 v[222:223], v[222:223], v[46:47]
    s_waitcnt lgkmcnt(0)
    s_barrier
    v_permlane32_swap_b32 v208, v212
    v_permlane32_swap_b32 v209, v213
    v_permlane32_swap_b32 v210, v214
    v_permlane32_swap_b32 v211, v215
    s_waitcnt vmcnt(3)
    v_lshlrev_b32 v8, 16, v16
    v_add_f32 v208, v208, v8
    v_and_b32 v9, 0xffff0000, v16
    v_add_f32 v209, v209, v9
    s_waitcnt vmcnt(2)
    v_lshlrev_b32 v8, 16, v20
    v_add_f32 v208, v208, v8
    v_and_b32 v9, 0xffff0000, v20
    v_add_f32 v209, v209, v9
    v_lshlrev_b32 v8, 16, v17
    v_add_f32 v210, v210, v8
    v_and_b32 v9, 0xffff0000, v17
    v_add_f32 v211, v211, v9
    v_lshlrev_b32 v8, 16, v21
    v_add_f32 v210, v210, v8
    v_and_b32 v9, 0xffff0000, v21
    v_add_f32 v211, v211, v9
    v_lshlrev_b32 v8, 16, v18
    v_add_f32 v212, v212, v8
    v_and_b32 v9, 0xffff0000, v18
    v_add_f32 v213, v213, v9
    v_lshlrev_b32 v8, 16, v22
    v_add_f32 v212, v212, v8
    v_and_b32 v9, 0xffff0000, v22
    v_add_f32 v213, v213, v9
    v_lshlrev_b32 v8, 16, v19
    v_add_f32 v214, v214, v8
    v_and_b32 v9, 0xffff0000, v19
    v_add_f32 v215, v215, v9
    v_lshlrev_b32 v8, 16, v23
    v_add_f32 v214, v214, v8
    v_and_b32 v9, 0xffff0000, v23
    v_add_f32 v215, v215, v9
    v_cvt_pk_bf16_f32 v48, v208, v209
    v_cvt_pk_bf16_f32 v49, v210, v211
    v_cvt_pk_bf16_f32 v50, v212, v213
    v_cvt_pk_bf16_f32 v51, v214, v215
    buffer_store_dwordx4 v[48:51], v4, s[36:39], s53 offen offset:0
    v_permlane32_swap_b32 v216, v220
    v_permlane32_swap_b32 v217, v221
    v_permlane32_swap_b32 v218, v222
    v_permlane32_swap_b32 v219, v223
    s_waitcnt vmcnt(2)
    v_lshlrev_b32 v8, 16, v24
    v_add_f32 v216, v216, v8
    v_and_b32 v9, 0xffff0000, v24
    v_add_f32 v217, v217, v9
    s_waitcnt vmcnt(1)
    v_lshlrev_b32 v8, 16, v28
    v_add_f32 v216, v216, v8
    v_and_b32 v9, 0xffff0000, v28
    v_add_f32 v217, v217, v9
    v_lshlrev_b32 v8, 16, v25
    v_add_f32 v218, v218, v8
    v_and_b32 v9, 0xffff0000, v25
    v_add_f32 v219, v219, v9
    v_lshlrev_b32 v8, 16, v29
    v_add_f32 v218, v218, v8
    v_and_b32 v9, 0xffff0000, v29
    v_add_f32 v219, v219, v9
    v_lshlrev_b32 v8, 16, v26
    v_add_f32 v220, v220, v8
    v_and_b32 v9, 0xffff0000, v26
    v_add_f32 v221, v221, v9
    v_lshlrev_b32 v8, 16, v30
    v_add_f32 v220, v220, v8
    v_and_b32 v9, 0xffff0000, v30
    v_add_f32 v221, v221, v9
    v_lshlrev_b32 v8, 16, v27
    v_add_f32 v222, v222, v8
    v_and_b32 v9, 0xffff0000, v27
    v_add_f32 v223, v223, v9
    v_lshlrev_b32 v8, 16, v31
    v_add_f32 v222, v222, v8
    v_and_b32 v9, 0xffff0000, v31
    v_add_f32 v223, v223, v9
    v_cvt_pk_bf16_f32 v48, v216, v217
    v_cvt_pk_bf16_f32 v49, v218, v219
    v_cvt_pk_bf16_f32 v50, v220, v221
    v_cvt_pk_bf16_f32 v51, v222, v223
    buffer_store_dwordx4 v[48:51], v4, s[36:39], s53 offen offset:32
L_w6_next:
    s_add_u32 s45, s45, 3
    s_cmp_lt_u32 s45, 64
    s_cbranch_scc1 L_w6_loop
    s_waitcnt vmcnt(0)
    s_branch L_end
L_chain:
    s_load_dwordx2 s[46:47], s[0:1], 16
    s_load_dwordx2 s[48:49], s[0:1], 24
    s_load_dwordx2 s[50:51], s[0:1], 32
    s_load_dwordx2 s[52:53], s[0:1], 40
    s_load_dwordx2 s[54:55], s[0:1], 8
    s_waitcnt lgkmcnt(0)
    v_and_b32 v2, 15, v0
    v_lshrrev_b32 v3, 4, v0
    v_and_b32 v14, 1, v3
    v_lshrrev_b32 v15, 1, v3
    v_lshl_add_u32 v14, v15, 2, v14
    v_xor_b32 v15, v2, v14
    v_lshlrev_b32 v15, 4, v15
    v_lshl_add_u32 v4, v3, 13, v15
    v_xor_b32 v15, v2, v14
    v_xor_b32 v15, 8, v15
    v_lshlrev_b32 v15, 4, v15
    v_lshl_add_u32 v5, v3, 13, v15
    v_bfe_u32 v14, v0, 3, 1
    v_bfe_u32 v15, v0, 2, 1
    v_and_b32 v16, 1, v3
    v_lshlrev_b32 v17, 3, v14
    v_lshl_add_u32 v17, v15, 1, v17
    v_add_u32 v17, v17, v16
    v_lshlrev_b32 v17, 8, v17
    v_lshlrev_b32 v14, 3, v14
    v_lshl_add_u32 v14, v15, 2, v14
    v_add_u32 v14, v14, v16
    v_bfe_u32 v15, v0, 1, 1
    v_lshlrev_b32 v15, 1, v15
    s_lshl_b32 s19, s17, 2
    v_add_u32 v15, s19, v15
    v_lshrrev_b32 v16, 1, v3
    s_mov_b32 s19, 36864
    v_mul_lo_u32 v16, v16, s19
    v_add_u32 v17, v17, v16
    v_and_b32 v16, 1, v0
    v_lshl_add_u32 v17, v16, 3, v17
    v_add_u32 v17, 16384, v17
    v_xor_b32 v16, v15, v14
    v_lshl_add_u32 v6, v16, 4, v17
    v_add_u32 v7, 73728, v6
    v_xor_b32 v16, v15, v14
    v_xor_b32 v16, 1, v16
    v_lshl_add_u32 v8, v16, 4, v17
    v_add_u32 v9, 73728, v8
    v_lshrrev_b32 v14, 1, v3
    v_lshlrev_b32 v14, 2, v14
    v_bfe_u32 v15, v0, 2, 1
    v_add_u32 v14, v14, v15
    v_and_b32 v15, 1, v3
    v_lshl_add_u32 v14, v15, 3, v14
    s_movk_i32 s19, 1152
    v_mul_lo_u32 v14, v14, s19
    v_and_b32 v15, 3, v0
    v_lshl_add_u32 v14, v15, 3, v14
    s_lshl_b32 s19, s17, 5
    s_add_u32 s19, s19, 16384
    v_add_u32 v14, s19, v14
    v_bfe_u32 v15, v0, 3, 1
    v_lshl_add_u32 v10, v15, 7, v14
    s_mov_b32 s19, 36864
    v_mul_lo_u32 v15, v15, s19
    v_add_u32 v11, v15, v14
    v_lshlrev_b32 v12, 4, v0
    s_mul_i32 s87, s17, 36864
    s_add_u32 s87, s87, 16384
    v_add_u32 v13, s87, v12
    s_mov_b32 s12, s52
    s_mov_b32 s13, s53
    s_mov_b32 s14, 0x480000
    s_mov_b32 s15, 0x20000
    s_mul_i32 s19, s16, 147456
    s_mul_i32 s20, s17, 36864
    s_add_u32 s19, s19, s20
    s_mov_b32 m0, s87
    s_nop 0
    buffer_load_dwordx4 v12, s[12:15], s19 offen lds
    s_add_u32 m0, m0, 1024
    s_add_u32 s19, s19, 1024
    buffer_load_dwordx4 v12, s[12:15], s19 offen lds
    s_add_u32 m0, m0, 1024
    s_add_u32 s19, s19, 1024
    buffer_load_dwordx4 v12, s[12:15], s19 offen lds
    s_add_u32 m0, m0, 1024
    s_add_u32 s19, s19, 1024
    buffer_load_dwordx4 v12, s[12:15], s19 offen lds
    s_add_u32 m0, m0, 1024
    s_add_u32 s19, s19, 1024
    buffer_load_dwordx4 v12, s[12:15], s19 offen lds
    s_add_u32 m0, m0, 1024
    s_add_u32 s19, s19, 1024
    buffer_load_dwordx4 v12, s[12:15], s19 offen lds
    s_add_u32 m0, m0, 1024
    s_add_u32 s19, s19, 1024
    buffer_load_dwordx4 v12, s[12:15], s19 offen lds
    s_add_u32 m0, m0, 1024
    s_add_u32 s19, s19, 1024
    buffer_load_dwordx4 v12, s[12:15], s19 offen lds
    s_add_u32 m0, m0, 1024
    s_add_u32 s19, s19, 1024
    buffer_load_dwordx4 v12, s[12:15], s19 offen lds
    s_add_u32 m0, m0, 1024
    s_add_u32 s19, s19, 1024
    buffer_load_dwordx4 v12, s[12:15], s19 offen lds
    s_add_u32 m0, m0, 1024
    s_add_u32 s19, s19, 1024
    buffer_load_dwordx4 v12, s[12:15], s19 offen lds
    s_add_u32 m0, m0, 1024
    s_add_u32 s19, s19, 1024
    buffer_load_dwordx4 v12, s[12:15], s19 offen lds
    s_add_u32 m0, m0, 1024
    s_add_u32 s19, s19, 1024
    buffer_load_dwordx4 v12, s[12:15], s19 offen lds
    s_add_u32 m0, m0, 1024
    s_add_u32 s19, s19, 1024
    buffer_load_dwordx4 v12, s[12:15], s19 offen lds
    s_add_u32 m0, m0, 1024
    s_add_u32 s19, s19, 1024
    buffer_load_dwordx4 v12, s[12:15], s19 offen lds
    s_add_u32 m0, m0, 1024
    s_add_u32 s19, s19, 1024
    buffer_load_dwordx4 v12, s[12:15], s19 offen lds
    s_add_u32 m0, m0, 1024
    s_add_u32 s19, s19, 1024
    buffer_load_dwordx4 v12, s[12:15], s19 offen lds
    s_add_u32 m0, m0, 1024
    s_add_u32 s19, s19, 1024
    buffer_load_dwordx4 v12, s[12:15], s19 offen lds
    s_add_u32 m0, m0, 1024
    s_add_u32 s19, s19, 1024
    buffer_load_dwordx4 v12, s[12:15], s19 offen lds
    s_add_u32 m0, m0, 1024
    s_add_u32 s19, s19, 1024
    buffer_load_dwordx4 v12, s[12:15], s19 offen lds
    s_add_u32 m0, m0, 1024
    s_add_u32 s19, s19, 1024
    buffer_load_dwordx4 v12, s[12:15], s19 offen lds
    s_add_u32 m0, m0, 1024
    s_add_u32 s19, s19, 1024
    buffer_load_dwordx4 v12, s[12:15], s19 offen lds
    s_add_u32 m0, m0, 1024
    s_add_u32 s19, s19, 1024
    buffer_load_dwordx4 v12, s[12:15], s19 offen lds
    s_add_u32 m0, m0, 1024
    s_add_u32 s19, s19, 1024
    buffer_load_dwordx4 v12, s[12:15], s19 offen lds
    s_add_u32 m0, m0, 1024
    s_add_u32 s19, s19, 1024
    buffer_load_dwordx4 v12, s[12:15], s19 offen lds
    s_add_u32 m0, m0, 1024
    s_add_u32 s19, s19, 1024
    buffer_load_dwordx4 v12, s[12:15], s19 offen lds
    s_add_u32 m0, m0, 1024
    s_add_u32 s19, s19, 1024
    buffer_load_dwordx4 v12, s[12:15], s19 offen lds
    s_add_u32 m0, m0, 1024
    s_add_u32 s19, s19, 1024
    buffer_load_dwordx4 v12, s[12:15], s19 offen lds
    s_add_u32 m0, m0, 1024
    s_add_u32 s19, s19, 1024
    buffer_load_dwordx4 v12, s[12:15], s19 offen lds
    s_add_u32 m0, m0, 1024
    s_add_u32 s19, s19, 1024
    buffer_load_dwordx4 v12, s[12:15], s19 offen lds
    s_add_u32 m0, m0, 1024
    s_add_u32 s19, s19, 1024
    buffer_load_dwordx4 v12, s[12:15], s19 offen lds
    s_add_u32 m0, m0, 1024
    s_add_u32 s19, s19, 1024
    buffer_load_dwordx4 v12, s[12:15], s19 offen lds
    s_add_u32 m0, m0, 1024
    s_add_u32 s19, s19, 1024
    buffer_load_dwordx4 v12, s[12:15], s19 offen lds
    s_add_u32 m0, m0, 1024
    s_add_u32 s19, s19, 1024
    buffer_load_dwordx4 v12, s[12:15], s19 offen lds
    s_add_u32 m0, m0, 1024
    s_add_u32 s19, s19, 1024
    buffer_load_dwordx4 v12, s[12:15], s19 offen lds
    s_add_u32 m0, m0, 1024
    s_add_u32 s19, s19, 1024
    buffer_load_dwordx4 v12, s[12:15], s19 offen lds
    v_mov_b32 v59, 192
    global_load_dword v58, v59, s[42:43] sc1
    v_mov_b32 v57, 0
    global_load_dword v56, v57, s[42:43] sc1
    s_mov_b32 s64, s54
    s_mov_b32 s65, s55
    s_mov_b32 s66, 9216
    s_mov_b32 s67, 0x20000
    s_lshl_b32 s19, s17, 6
    v_add_u32 v60, s19, v0
    v_add_u32 v61, 0, v60
    v_and_b32 v62, 7, v61
    v_lshrrev_b32 v63, 3, v61
    s_movk_i32 s20, 1152
    v_mul_lo_u32 v62, v62, s20
    v_lshl_add_u32 v62, v63, 4, v62
    v_cmp_gt_u32 vcc, 576, v61
    v_mov_b32 v63, 0x40000000
    s_nop 0
    v_cndmask_b32 v62, v63, v62, vcc
    buffer_load_dwordx4 v[64:67], v62, s[64:67], 0 offen
    v_add_u32 v61, 256, v60
    v_and_b32 v62, 7, v61
    v_lshrrev_b32 v63, 3, v61
    s_movk_i32 s20, 1152
    v_mul_lo_u32 v62, v62, s20
    v_lshl_add_u32 v62, v63, 4, v62
    v_cmp_gt_u32 vcc, 576, v61
    v_mov_b32 v63, 0x40000000
    s_nop 0
    v_cndmask_b32 v62, v63, v62, vcc
    buffer_load_dwordx4 v[68:71], v62, s[64:67], 0 offen
    v_add_u32 v61, 512, v60
    v_and_b32 v62, 7, v61
    v_lshrrev_b32 v63, 3, v61
    s_movk_i32 s20, 1152
    v_mul_lo_u32 v62, v62, s20
    v_lshl_add_u32 v62, v63, 4, v62
    v_cmp_gt_u32 vcc, 576, v61
    v_mov_b32 v63, 0x40000000
    s_nop 0
    v_cndmask_b32 v62, v63, v62, vcc
    buffer_load_dwordx4 v[72:75], v62, s[64:67], 0 offen
    v_mov_b32 v76, -1
    v_mov_b32 v77, -1
    v_mov_b32 v78, -1
    v_mov_b32 v79, -1
    s_mul_i32 s19, s16, 9216
    s_add_u32 s19, s19, 0x0
    v_lshlrev_b32 v61, 4, v60
    s_add_u32 s20, s19, 0
    buffer_store_dwordx4 v[76:79], v61, s[8:11], s20 offen sc1
    s_add_u32 s20, s19, 4096
    buffer_store_dwordx4 v[76:79], v61, s[8:11], s20 offen sc1
    v_mov_b32 v63, 0x40000000
    v_cmp_gt_u32 vcc, 64, v60
    s_nop 1
    v_cndmask_b32 v61, v63, v61, vcc
    s_add_u32 s20, s19, 8192
    buffer_store_dwordx4 v[76:79], v61, s[8:11], s20 offen sc1
    s_sub_u32 s19, s17, 1
    s_lshl_b32 s19, s19, 5
    s_add_u32 s19, s19, s16
    s_cmp_lt_u32 s19, 72
    s_cselect_b32 s20, 1, 0
    s_cmp_eq_u32 s17, 0
    s_cselect_b32 s20, 0, s20
    s_lshl_b32 s19, s19, 7
    v_lshlrev_b32 v61, 2, v0
    v_mov_b32 v63, 0x40000000
    v_cmp_gt_u32 vcc, 32, v0
    s_nop 1
    v_cndmask_b32 v61, v63, v61, vcc
    s_cmp_eq_u32 s20, 0
    s_cselect_b64 vcc, -1, 0
    v_cndmask_b32 v61, v61, v63, vcc
    s_add_u32 s20, s19, 0x100000
    buffer_store_dword v76, v61, s[8:11], s20 offen sc1
    s_add_u32 s20, s19, 0x102400
    buffer_store_dword v76, v61, s[8:11], s20 offen sc1
    s_add_u32 s20, s19, 0x104800
    buffer_store_dword v76, v61, s[8:11], s20 offen sc1
    s_add_u32 s20, s19, 0x106c00
    buffer_store_dword v76, v61, s[8:11], s20 offen sc1
    s_waitcnt vmcnt(0) lgkmcnt(0)
    s_barrier
    v_readfirstlane_b32 s75, v56
    s_mov_b32 s62, 0x05040100
    s_mov_b32 s63, 0x07060302
    v_perm_b32 v76, v65, v64, s62
    v_perm_b32 v77, v67, v66, s62
    v_perm_b32 v78, v65, v64, s63
    v_perm_b32 v79, v67, v66, s63
    v_add_u32 v61, 0, v60
    v_cmp_gt_u32 vcc, 576, v61
    v_lshlrev_b32 v61, 4, v61
    s_and_saveexec_b64 s[40:41], vcc
    ds_write_b128 v61, v[76:79] offset:0
    s_mov_b64 exec, s[40:41]
    v_perm_b32 v76, v69, v68, s62
    v_perm_b32 v77, v71, v70, s62
    v_perm_b32 v78, v69, v68, s63
    v_perm_b32 v79, v71, v70, s63
    v_add_u32 v61, 256, v60
    v_cmp_gt_u32 vcc, 576, v61
    v_lshlrev_b32 v61, 4, v61
    s_and_saveexec_b64 s[40:41], vcc
    ds_write_b128 v61, v[76:79] offset:0
    s_mov_b64 exec, s[40:41]
    v_perm_b32 v76, v73, v72, s62
    v_perm_b32 v77, v75, v74, s62
    v_perm_b32 v78, v73, v72, s63
    v_perm_b32 v79, v75, v74, s63
    v_add_u32 v61, 512, v60
    v_cmp_gt_u32 vcc, 576, v61
    v_lshlrev_b32 v61, 4, v61
    s_and_saveexec_b64 s[40:41], vcc
    ds_write_b128 v61, v[76:79] offset:0
    s_mov_b64 exec, s[40:41]
    s_cmp_eq_u32 s17, 0
    s_cbranch_scc0 L_ei_s
    s_mov_b32 s35, 30000
L_ei_z:
    v_readfirstlane_b32 s20, v58
    s_nop 0
    s_cmp_lg_u32 s20, 0
    s_cbranch_scc1 L_ei_zd
    global_load_dword v58, v59, s[42:43] sc1
    s_waitcnt vmcnt(0)
    s_sub_u32 s35, s35, 1
    s_cmp_lg_u32 s35, 0
    s_cbranch_scc1 L_ei_z
L_ei_zd:
    s_mov_b32 s20, 0x204480
    v_mov_b32 v61, 1
    s_mov_b64 exec, 1
    buffer_atomic_add v61, off, s[8:11], s20
    s_mov_b64 exec, -1
L_ei_s:
    ds_read_b64_tr_b16 v[160:161], v10 offset:128
    ds_read_b64_tr_b16 v[162:163], v10 offset:2432
    ds_read_b64_tr_b16 v[164:165], v10 offset:18560
    ds_read_b64_tr_b16 v[166:167], v10 offset:20864
    v_add_u32 v14, 36864, v10
    ds_read_b64_tr_b16 v[168:169], v14 offset:128
    ds_read_b64_tr_b16 v[170:171], v14 offset:2432
    ds_read_b64_tr_b16 v[172:173], v14 offset:18560
    ds_read_b64_tr_b16 v[174:175], v14 offset:20864
    v_add_u32 v14, 73728, v10
    ds_read_b64_tr_b16 v[176:177], v14 offset:128
    ds_read_b64_tr_b16 v[178:179], v14 offset:2432
    ds_read_b64_tr_b16 v[180:181], v14 offset:18560
    ds_read_b64_tr_b16 v[182:183], v14 offset:20864
    v_add_u32 v14, 110592, v10
    ds_read_b64_tr_b16 v[20:21], v14 offset:128
    ds_read_b64_tr_b16 v[22:23], v14 offset:2432
    ds_read_b64_tr_b16 v[24:25], v14 offset:18560
    ds_read_b64_tr_b16 v[26:27], v14 offset:20864
    ds_read_b64_tr_b16 v[184:185], v10 offset:384
    ds_read_b64_tr_b16 v[186:187], v10 offset:2688
    ds_read_b64_tr_b16 v[188:189], v10 offset:18816
    ds_read_b64_tr_b16 v[190:191], v10 offset:21120
    v_add_u32 v14, 36864, v10
    ds_read_b64_tr_b16 v[192:193], v14 offset:384
    ds_read_b64_tr_b16 v[194:195], v14 offset:2688
    ds_read_b64_tr_b16 v[196:197], v14 offset:18816
    ds_read_b64_tr_b16 v[198:199], v14 offset:21120
    v_add_u32 v14, 73728, v10
    ds_read_b64_tr_b16 v[200:201], v14 offset:384
    ds_read_b64_tr_b16 v[202:203], v14 offset:2688
    ds_read_b64_tr_b16 v[204:205], v14 offset:18816
    ds_read_b64_tr_b16 v[206:207], v14 offset:21120
    v_add_u32 v14, 110592, v10
    ds_read_b64_tr_b16 v[28:29], v14 offset:384
    ds_read_b64_tr_b16 v[30:31], v14 offset:2688
    ds_read_b64_tr_b16 v[32:33], v14 offset:18816
    ds_read_b64_tr_b16 v[34:35], v14 offset:21120
    ds_read_b64_tr_b16 v[208:209], v10 offset:640
    ds_read_b64_tr_b16 v[210:211], v10 offset:2944
    ds_read_b64_tr_b16 v[212:213], v10 offset:19072
    ds_read_b64_tr_b16 v[214:215], v10 offset:21376
    v_add_u32 v14, 36864, v10
    ds_read_b64_tr_b16 v[216:217], v14 offset:640
    ds_read_b64_tr_b16 v[218:219], v14 offset:2944
    ds_read_b64_tr_b16 v[220:221], v14 offset:19072
    ds_read_b64_tr_b16 v[222:223], v14 offset:21376
    v_add_u32 v14, 73728, v10
    ds_read_b64_tr_b16 v[224:225], v14 offset:640
    ds_read_b64_tr_b16 v[226:227], v14 offset:2944
    ds_read_b64_tr_b16 v[228:229], v14 offset:19072
    ds_read_b64_tr_b16 v[230:231], v14 offset:21376
    v_add_u32 v14, 110592, v10
    ds_read_b64_tr_b16 v[36:37], v14 offset:640
    ds_read_b64_tr_b16 v[38:39], v14 offset:2944
    ds_read_b64_tr_b16 v[40:41], v14 offset:19072
    ds_read_b64_tr_b16 v[42:43], v14 offset:21376
    ds_read_b64_tr_b16 v[232:233], v10 offset:896
    ds_read_b64_tr_b16 v[234:235], v10 offset:3200
    ds_read_b64_tr_b16 v[236:237], v10 offset:19328
    ds_read_b64_tr_b16 v[238:239], v10 offset:21632
    v_add_u32 v14, 36864, v10
    ds_read_b64_tr_b16 v[240:241], v14 offset:896
    ds_read_b64_tr_b16 v[242:243], v14 offset:3200
    ds_read_b64_tr_b16 v[244:245], v14 offset:19328
    ds_read_b64_tr_b16 v[246:247], v14 offset:21632
    v_add_u32 v14, 73728, v10
    ds_read_b64_tr_b16 v[248:249], v14 offset:896
    ds_read_b64_tr_b16 v[250:251], v14 offset:3200
    ds_read_b64_tr_b16 v[252:253], v14 offset:19328
    ds_read_b64_tr_b16 v[254:255], v14 offset:21632
    v_add_u32 v14, 110592, v10
    ds_read_b64_tr_b16 v[44:45], v14 offset:896
    ds_read_b64_tr_b16 v[46:47], v14 offset:3200
    ds_read_b64_tr_b16 v[48:49], v14 offset:19328
    ds_read_b64_tr_b16 v[50:51], v14 offset:21632
    v_add_u32 v14, 0, v11
    ds_read_b64_tr_b16 v[144:145], v14 offset:0
    ds_read_b64_tr_b16 v[146:147], v14 offset:2304
    ds_read_b64_tr_b16 v[148:149], v14 offset:18432
    ds_read_b64_tr_b16 v[150:151], v14 offset:20736
    v_add_u32 v14, 73728, v11
    ds_read_b64_tr_b16 v[152:153], v14 offset:0
    ds_read_b64_tr_b16 v[154:155], v14 offset:2304
    ds_read_b64_tr_b16 v[156:157], v14 offset:18432
    ds_read_b64_tr_b16 v[158:159], v14 offset:20736
    s_waitcnt lgkmcnt(0)
    s_barrier
    ds_write_b128 v13, v[20:23] offset:28672
    ds_write_b128 v13, v[24:27] offset:29696
    ds_write_b128 v13, v[28:31] offset:30720
    ds_write_b128 v13, v[32:35] offset:31744
    ds_write_b128 v13, v[36:39] offset:32768
    ds_write_b128 v13, v[40:43] offset:33792
    ds_write_b128 v13, v[44:47] offset:34816
    ds_write_b128 v13, v[48:51] offset:35840
    s_lshl_b32 s88, s16, 8
    s_mul_i32 s19, s17, 131072
    s_add_u32 s88, s88, s19
    s_mov_b32 s12, s46
    s_mov_b32 s13, s47
    s_mov_b32 s14, 0x480000
    s_mov_b32 s15, 0x20000
    s_add_u32 m0, s87, 0
    s_add_u32 s19, s88, 0
    buffer_load_dwordx4 v4, s[12:15], s19 offen lds
    s_add_u32 m0, s87, 1024
    s_add_u32 s19, s88, 32768
    buffer_load_dwordx4 v4, s[12:15], s19 offen lds
    s_add_u32 m0, s87, 2048
    s_add_u32 s19, s88, 65536
    buffer_load_dwordx4 v5, s[12:15], s19 offen lds
    s_add_u32 m0, s87, 3072
    s_add_u32 s19, s88, 98304
    buffer_load_dwordx4 v5, s[12:15], s19 offen lds
    s_add_u32 m0, s87, 4096
    s_add_u32 s19, s88, 524288
    buffer_load_dwordx4 v4, s[12:15], s19 offen lds
    s_add_u32 m0, s87, 5120
    s_add_u32 s19, s88, 557056
    buffer_load_dwordx4 v4, s[12:15], s19 offen lds
    s_add_u32 m0, s87, 6144
    s_add_u32 s19, s88, 589824
    buffer_load_dwordx4 v5, s[12:15], s19 offen lds
    s_add_u32 m0, s87, 7168
    s_add_u32 s19, s88, 622592
    buffer_load_dwordx4 v5, s[12:15], s19 offen lds
    s_add_u32 m0, s87, 8192
    s_add_u32 s19, s88, 1048576
    buffer_load_dwordx4 v4, s[12:15], s19 offen lds
    s_add_u32 m0, s87, 9216
    s_add_u32 s19, s88, 1081344
    buffer_load_dwordx4 v4, s[12:15], s19 offen lds
    s_add_u32 m0, s87, 10240
    s_add_u32 s19, s88, 1114112
    buffer_load_dwordx4 v5, s[12:15], s19 offen lds
    s_add_u32 m0, s87, 11264
    s_add_u32 s19, s88, 1146880
    buffer_load_dwordx4 v5, s[12:15], s19 offen lds
    s_add_u32 m0, s87, 12288
    s_add_u32 s19, s88, 1572864
    buffer_load_dwordx4 v4, s[12:15], s19 offen lds
    s_add_u32 m0, s87, 13312
    s_add_u32 s19, s88, 1605632
    buffer_load_dwordx4 v4, s[12:15], s19 offen lds
    s_add_u32 m0, s87, 14336
    s_add_u32 s19, s88, 1638400
    buffer_load_dwordx4 v5, s[12:15], s19 offen lds
    s_add_u32 m0, s87, 15360
    s_add_u32 s19, s88, 1671168
    buffer_load_dwordx4 v5, s[12:15], s19 offen lds
    s_add_u32 m0, s87, 16384
    s_add_u32 s19, s88, 2097152
    buffer_load_dwordx4 v4, s[12:15], s19 offen lds
    s_add_u32 m0, s87, 17408
    s_add_u32 s19, s88, 2129920
    buffer_load_dwordx4 v4, s[12:15], s19 offen lds
    s_add_u32 m0, s87, 18432
    s_add_u32 s19, s88, 2162688
    buffer_load_dwordx4 v5, s[12:15], s19 offen lds
    s_add_u32 m0, s87, 19456
    s_add_u32 s19, s88, 2195456
    buffer_load_dwordx4 v5, s[12:15], s19 offen lds
    s_add_u32 m0, s87, 20480
    s_add_u32 s19, s88, 2621440
    buffer_load_dwordx4 v4, s[12:15], s19 offen lds
    s_add_u32 m0, s87, 21504
    s_add_u32 s19, s88, 2654208
    buffer_load_dwordx4 v4, s[12:15], s19 offen lds
    s_add_u32 m0, s87, 22528
    s_add_u32 s19, s88, 2686976
    buffer_load_dwordx4 v5, s[12:15], s19 offen lds
    s_add_u32 m0, s87, 23552
    s_add_u32 s19, s88, 2719744
    buffer_load_dwordx4 v5, s[12:15], s19 offen lds
    s_add_u32 m0, s87, 24576
    s_add_u32 s19, s88, 3145728
    buffer_load_dwordx4 v4, s[12:15], s19 offen lds
    s_add_u32 m0, s87, 25600
    s_add_u32 s19, s88, 3178496
    buffer_load_dwordx4 v4, s[12:15], s19 offen lds
    s_add_u32 m0, s87, 26624
    s_add_u32 s19, s88, 3211264
    buffer_load_dwordx4 v5, s[12:15], s19 offen lds
    s_add_u32 m0, s87, 27648
    s_add_u32 s19, s88, 3244032
    buffer_load_dwordx4 v5, s[12:15], s19 offen lds
    s_waitcnt vmcnt(24) lgkmcnt(0)
    s_barrier
    ds_read_b64_tr_b16 a[0:1], v6 offset:0
    ds_read_b64_tr_b16 a[2:3], v6 offset:1024
    ds_read_b64_tr_b16 a[4:5], v7 offset:0
    ds_read_b64_tr_b16 a[6:7], v7 offset:1024
    ds_read_b64_tr_b16 a[8:9], v8 offset:0
    ds_read_b64_tr_b16 a[10:11], v8 offset:1024
    ds_read_b64_tr_b16 a[12:13], v9 offset:0
    ds_read_b64_tr_b16 a[14:15], v9 offset:1024
    s_waitcnt vmcnt(20) lgkmcnt(0)
    s_barrier
    s_add_u32 m0, s87, 0
    s_add_u32 s19, s88, 3670016
    buffer_load_dwordx4 v4, s[12:15], s19 offen lds
    s_add_u32 m0, s87, 1024
    s_add_u32 s19, s88, 3702784
    buffer_load_dwordx4 v4, s[12:15], s19 offen lds
    s_add_u32 m0, s87, 2048
    s_add_u32 s19, s88, 3735552
    buffer_load_dwordx4 v5, s[12:15], s19 offen lds
    s_add_u32 m0, s87, 3072
    s_add_u32 s19, s88, 3768320
    buffer_load_dwordx4 v5, s[12:15], s19 offen lds
    ds_read_b64_tr_b16 a[16:17], v6 offset:4096
    ds_read_b64_tr_b16 a[18:19], v6 offset:5120
    ds_read_b64_tr_b16 a[20:21], v7 offset:4096
    ds_read_b64_tr_b16 a[22:23], v7 offset:5120
    ds_read_b64_tr_b16 a[24:25], v8 offset:4096
    ds_read_b64_tr_b16 a[26:27], v8 offset:5120
    ds_read_b64_tr_b16 a[28:29], v9 offset:4096
    ds_read_b64_tr_b16 a[30:31], v9 offset:5120
    s_waitcnt vmcnt(20) lgkmcnt(0)
    s_barrier
    s_add_u32 m0, s87, 4096
    s_add_u32 s19, s88, 4194304
    buffer_load_dwordx4 v4, s[12:15], s19 offen lds
    s_add_u32 m0, s87, 5120
    s_add_u32 s19, s88, 4227072
    buffer_load_dwordx4 v4, s[12:15], s19 offen lds
    s_add_u32 m0, s87, 6144
    s_add_u32 s19, s88, 4259840
    buffer_load_dwordx4 v5, s[12:15], s19 offen lds
    s_add_u32 m0, s87, 7168
    s_add_u32 s19, s88, 4292608
    buffer_load_dwordx4 v5, s[12:15], s19 offen lds
    ds_read_b64_tr_b16 a[32:33], v6 offset:8192
    ds_read_b64_tr_b16 a[34:35], v6 offset:9216
    ds_read_b64_tr_b16 a[36:37], v7 offset:8192
    ds_read_b64_tr_b16 a[38:39], v7 offset:9216
    ds_read_b64_tr_b16 a[40:41], v8 offset:8192
    ds_read_b64_tr_b16 a[42:43], v8 offset:9216
    ds_read_b64_tr_b16 a[44:45], v9 offset:8192
    ds_read_b64_tr_b16 a[46:47], v9 offset:9216
    s_waitcnt vmcnt(20) lgkmcnt(0)
    s_barrier
    s_mov_b32 s12, s48
    s_mov_b32 s13, s49
    s_mov_b32 s14, 0x480000
    s_mov_b32 s15, 0x20000
    s_add_u32 m0, s87, 8192
    s_add_u32 s19, s88, 524288
    buffer_load_dwordx4 v4, s[12:15], s19 offen lds
    s_add_u32 m0, s87, 9216
    s_add_u32 s19, s88, 557056
    buffer_load_dwordx4 v4, s[12:15], s19 offen lds
    s_add_u32 m0, s87, 10240
    s_add_u32 s19, s88, 589824
    buffer_load_dwordx4 v5, s[12:15], s19 offen lds
    s_add_u32 m0, s87, 11264
    s_add_u32 s19, s88, 622592
    buffer_load_dwordx4 v5, s[12:15], s19 offen lds
    ds_read_b64_tr_b16 a[48:49], v6 offset:12288
    ds_read_b64_tr_b16 a[50:51], v6 offset:13312
    ds_read_b64_tr_b16 a[52:53], v7 offset:12288
    ds_read_b64_tr_b16 a[54:55], v7 offset:13312
    ds_read_b64_tr_b16 a[56:57], v8 offset:12288
    ds_read_b64_tr_b16 a[58:59], v8 offset:13312
    ds_read_b64_tr_b16 a[60:61], v9 offset:12288
    ds_read_b64_tr_b16 a[62:63], v9 offset:13312
    s_waitcnt vmcnt(20) lgkmcnt(0)
    s_barrier
    s_add_u32 m0, s87, 12288
    s_add_u32 s19, s88, 1572864
    buffer_load_dwordx4 v4, s[12:15], s19 offen lds
    s_add_u32 m0, s87, 13312
    s_add_u32 s19, s88, 1605632
    buffer_load_dwordx4 v4, s[12:15], s19 offen lds
    s_add_u32 m0, s87, 14336
    s_add_u32 s19, s88, 1638400
    buffer_load_dwordx4 v5, s[12:15], s19 offen lds
    s_add_u32 m0, s87, 15360
    s_add_u32 s19, s88, 1671168
    buffer_load_dwordx4 v5, s[12:15], s19 offen lds
    ds_read_b64_tr_b16 a[64:65], v6 offset:16384
    ds_read_b64_tr_b16 a[66:67], v6 offset:17408
    ds_read_b64_tr_b16 a[68:69], v7 offset:16384
    ds_read_b64_tr_b16 a[70:71], v7 offset:17408
    ds_read_b64_tr_b16 a[72:73], v8 offset:16384
    ds_read_b64_tr_b16 a[74:75], v8 offset:17408
    ds_read_b64_tr_b16 a[76:77], v9 offset:16384
    ds_read_b64_tr_b16 a[78:79], v9 offset:17408
    s_waitcnt vmcnt(20) lgkmcnt(0)
    s_barrier
    s_add_u32 m0, s87, 16384
    s_add_u32 s19, s88, 2621440
    buffer_load_dwordx4 v4, s[12:15], s19 offen lds
    s_add_u32 m0, s87, 17408
    s_add_u32 s19, s88, 2654208
    buffer_load_dwordx4 v4, s[12:15], s19 offen lds
    s_add_u32 m0, s87, 18432
    s_add_u32 s19, s88, 2686976
    buffer_load_dwordx4 v5, s[12:15], s19 offen lds
    s_add_u32 m0, s87, 19456
    s_add_u32 s19, s88, 2719744
    buffer_load_dwordx4 v5, s[12:15], s19 offen lds
    ds_read_b64_tr_b16 a[80:81], v6 offset:20480
    ds_read_b64_tr_b16 a[82:83], v6 offset:21504
    ds_read_b64_tr_b16 a[84:85], v7 offset:20480
    ds_read_b64_tr_b16 a[86:87], v7 offset:21504
    ds_read_b64_tr_b16 a[88:89], v8 offset:20480
    ds_read_b64_tr_b16 a[90:91], v8 offset:21504
    ds_read_b64_tr_b16 a[92:93], v9 offset:20480
    ds_read_b64_tr_b16 a[94:95], v9 offset:21504
    s_waitcnt vmcnt(20) lgkmcnt(0)
    s_barrier
    s_add_u32 m0, s87, 20480
    s_add_u32 s19, s88, 3670016
    buffer_load_dwordx4 v4, s[12:15], s19 offen lds
    s_add_u32 m0, s87, 21504
    s_add_u32 s19, s88, 3702784
    buffer_load_dwordx4 v4, s[12:15], s19 offen lds
    s_add_u32 m0, s87, 22528
    s_add_u32 s19, s88, 3735552
    buffer_load_dwordx4 v5, s[12:15], s19 offen lds
    s_add_u32 m0, s87, 23552
    s_add_u32 s19, s88, 3768320
    buffer_load_dwordx4 v5, s[12:15], s19 offen lds
    ds_read_b64_tr_b16 a[96:97], v6 offset:24576
    ds_read_b64_tr_b16 a[98:99], v6 offset:25600
    ds_read_b64_tr_b16 a[100:101], v7 offset:24576
    ds_read_b64_tr_b16 a[102:103], v7 offset:25600
    ds_read_b64_tr_b16 a[104:105], v8 offset:24576
    ds_read_b64_tr_b16 a[106:107], v8 offset:25600
    ds_read_b64_tr_b16 a[108:109], v9 offset:24576
    ds_read_b64_tr_b16 a[110:111], v9 offset:25600
    s_waitcnt vmcnt(20) lgkmcnt(0)
    s_barrier
    s_mov_b32 s12, s50
    s_mov_b32 s13, s51
    s_mov_b32 s14, 0x480000
    s_mov_b32 s15, 0x20000
    s_add_u32 m0, s87, 24576
    s_add_u32 s19, s88, 0
    buffer_load_dwordx4 v4, s[12:15], s19 offen lds
    s_add_u32 m0, s87, 25600
    s_add_u32 s19, s88, 32768
    buffer_load_dwordx4 v4, s[12:15], s19 offen lds
    s_add_u32 m0, s87, 26624
    s_add_u32 s19, s88, 65536
    buffer_load_dwordx4 v5, s[12:15], s19 offen lds
    s_add_u32 m0, s87, 27648
    s_add_u32 s19, s88, 98304
    buffer_load_dwordx4 v5, s[12:15], s19 offen lds
    ds_read_b64_tr_b16 a[112:113], v6 offset:0
    ds_read_b64_tr_b16 a[114:115], v6 offset:1024
    ds_read_b64_tr_b16 a[116:117], v7 offset:0
    ds_read_b64_tr_b16 a[118:119], v7 offset:1024
    ds_read_b64_tr_b16 a[120:121], v8 offset:0
    ds_read_b64_tr_b16 a[122:123], v8 offset:1024
    ds_read_b64_tr_b16 a[124:125], v9 offset:0
    ds_read_b64_tr_b16 a[126:127], v9 offset:1024
    s_waitcnt vmcnt(20) lgkmcnt(0)
    s_barrier
    s_add_u32 m0, s87, 0
    s_add_u32 s19, s88, 524288
    buffer_load_dwordx4 v4, s[12:15], s19 offen lds
    s_add_u32 m0, s87, 1024
    s_add_u32 s19, s88, 557056
    buffer_load_dwordx4 v4, s[12:15], s19 offen lds
    s_add_u32 m0, s87, 2048
    s_add_u32 s19, s88, 589824
    buffer_load_dwordx4 v5, s[12:15], s19 offen lds
    s_add_u32 m0, s87, 3072
    s_add_u32 s19, s88, 622592
    buffer_load_dwordx4 v5, s[12:15], s19 offen lds
    ds_read_b64_tr_b16 a[128:129], v6 offset:4096
    ds_read_b64_tr_b16 a[130:131], v6 offset:5120
    ds_read_b64_tr_b16 a[132:133], v7 offset:4096
    ds_read_b64_tr_b16 a[134:135], v7 offset:5120
    ds_read_b64_tr_b16 a[136:137], v8 offset:4096
    ds_read_b64_tr_b16 a[138:139], v8 offset:5120
    ds_read_b64_tr_b16 a[140:141], v9 offset:4096
    ds_read_b64_tr_b16 a[142:143], v9 offset:5120
    s_waitcnt vmcnt(20) lgkmcnt(0)
    s_barrier
    s_add_u32 m0, s87, 4096
    s_add_u32 s19, s88, 1572864
    buffer_load_dwordx4 v4, s[12:15], s19 offen lds
    s_add_u32 m0, s87, 5120
    s_add_u32 s19, s88, 1605632
    buffer_load_dwordx4 v4, s[12:15], s19 offen lds
    s_add_u32 m0, s87, 6144
    s_add_u32 s19, s88, 1638400
    buffer_load_dwordx4 v5, s[12:15], s19 offen lds
    s_add_u32 m0, s87, 7168
    s_add_u32 s19, s88, 1671168
    buffer_load_dwordx4 v5, s[12:15], s19 offen lds
    ds_read_b64_tr_b16 a[144:145], v6 offset:8192
    ds_read_b64_tr_b16 a[146:147], v6 offset:9216
    ds_read_b64_tr_b16 a[148:149], v7 offset:8192
    ds_read_b64_tr_b16 a[150:151], v7 offset:9216
    ds_read_b64_tr_b16 a[152:153], v8 offset:8192
    ds_read_b64_tr_b16 a[154:155], v8 offset:9216
    ds_read_b64_tr_b16 a[156:157], v9 offset:8192
    ds_read_b64_tr_b16 a[158:159], v9 offset:9216
    s_waitcnt vmcnt(20) lgkmcnt(0)
    s_barrier
    s_add_u32 m0, s87, 8192
    s_add_u32 s19, s88, 2097152
    buffer_load_dwordx4 v4, s[12:15], s19 offen lds
    s_add_u32 m0, s87, 9216
    s_add_u32 s19, s88, 2129920
    buffer_load_dwordx4 v4, s[12:15], s19 offen lds
    s_add_u32 m0, s87, 10240
    s_add_u32 s19, s88, 2162688
    buffer_load_dwordx4 v5, s[12:15], s19 offen lds
    s_add_u32 m0, s87, 11264
    s_add_u32 s19, s88, 2195456
    buffer_load_dwordx4 v5, s[12:15], s19 offen lds
    ds_read_b64_tr_b16 a[160:161], v6 offset:12288
    ds_read_b64_tr_b16 a[162:163], v6 offset:13312
    ds_read_b64_tr_b16 a[164:165], v7 offset:12288
    ds_read_b64_tr_b16 a[166:167], v7 offset:13312
    ds_read_b64_tr_b16 a[168:169], v8 offset:12288
    ds_read_b64_tr_b16 a[170:171], v8 offset:13312
    ds_read_b64_tr_b16 a[172:173], v9 offset:12288
    ds_read_b64_tr_b16 a[174:175], v9 offset:13312
    s_waitcnt vmcnt(20) lgkmcnt(0)
    s_barrier
    s_add_u32 m0, s87, 12288
    s_add_u32 s19, s88, 2621440
    buffer_load_dwordx4 v4, s[12:15], s19 offen lds
    s_add_u32 m0, s87, 13312
    s_add_u32 s19, s88, 2654208
    buffer_load_dwordx4 v4, s[12:15], s19 offen lds
    s_add_u32 m0, s87, 14336
    s_add_u32 s19, s88, 2686976
    buffer_load_dwordx4 v5, s[12:15], s19 offen lds
    s_add_u32 m0, s87, 15360
    s_add_u32 s19, s88, 2719744
    buffer_load_dwordx4 v5, s[12:15], s19 offen lds
    ds_read_b64_tr_b16 a[176:177], v6 offset:16384
    ds_read_b64_tr_b16 a[178:179], v6 offset:17408
    ds_read_b64_tr_b16 a[180:181], v7 offset:16384
    ds_read_b64_tr_b16 a[182:183], v7 offset:17408
    ds_read_b64_tr_b16 a[184:185], v8 offset:16384
    ds_read_b64_tr_b16 a[186:187], v8 offset:17408
    ds_read_b64_tr_b16 a[188:189], v9 offset:16384
    ds_read_b64_tr_b16 a[190:191], v9 offset:17408
    s_waitcnt vmcnt(20) lgkmcnt(0)
    s_barrier
    s_add_u32 m0, s87, 16384
    s_add_u32 s19, s88, 3670016
    buffer_load_dwordx4 v4, s[12:15], s19 offen lds
    s_add_u32 m0, s87, 17408
    s_add_u32 s19, s88, 3702784
    buffer_load_dwordx4 v4, s[12:15], s19 offen lds
    s_add_u32 m0, s87, 18432
    s_add_u32 s19, s88, 3735552
    buffer_load_dwordx4 v5, s[12:15], s19 offen lds
    s_add_u32 m0, s87, 19456
    s_add_u32 s19, s88, 3768320
    buffer_load_dwordx4 v5, s[12:15], s19 offen lds
    ds_read_b64_tr_b16 a[192:193], v6 offset:20480
    ds_read_b64_tr_b16 a[194:195], v6 offset:21504
    ds_read_b64_tr_b16 a[196:197], v7 offset:20480
    ds_read_b64_tr_b16 a[198:199], v7 offset:21504
    ds_read_b64_tr_b16 a[200:201], v8 offset:20480
    ds_read_b64_tr_b16 a[202:203], v8 offset:21504
    ds_read_b64_tr_b16 a[204:205], v9 offset:20480
    ds_read_b64_tr_b16 a[206:207], v9 offset:21504
    s_waitcnt vmcnt(20) lgkmcnt(0)
    s_barrier
    s_add_u32 m0, s87, 20480
    s_add_u32 s19, s88, 4194304
    buffer_load_dwordx4 v4, s[12:15], s19 offen lds
    s_add_u32 m0, s87, 21504
    s_add_u32 s19, s88, 4227072
    buffer_load_dwordx4 v4, s[12:15], s19 offen lds
    s_add_u32 m0, s87, 22528
    s_add_u32 s19, s88, 4259840
    buffer_load_dwordx4 v5, s[12:15], s19 offen lds
    s_add_u32 m0, s87, 23552
    s_add_u32 s19, s88, 4292608
    buffer_load_dwordx4 v5, s[12:15], s19 offen lds
    ds_read_b64_tr_b16 a[208:209], v6 offset:24576
    ds_read_b64_tr_b16 a[210:211], v6 offset:25600
    ds_read_b64_tr_b16 a[212:213], v7 offset:24576
    ds_read_b64_tr_b16 a[214:215], v7 offset:25600
    ds_read_b64_tr_b16 a[216:217], v8 offset:24576
    ds_read_b64_tr_b16 a[218:219], v8 offset:25600
    ds_read_b64_tr_b16 a[220:221], v9 offset:24576
    ds_read_b64_tr_b16 a[222:223], v9 offset:25600
    s_waitcnt vmcnt(20) lgkmcnt(0)
    s_barrier
    s_add_u32 m0, s87, 24576
    s_add_u32 s19, s88, 3145728
    buffer_load_dwordx4 v4, s[12:15], s19 offen lds
    s_add_u32 m0, s87, 25600
    s_add_u32 s19, s88, 3178496
    buffer_load_dwordx4 v4, s[12:15], s19 offen lds
    s_add_u32 m0, s87, 26624
    s_add_u32 s19, s88, 3211264
    buffer_load_dwordx4 v5, s[12:15], s19 offen lds
    s_add_u32 m0, s87, 27648
    s_add_u32 s19, s88, 3244032
    buffer_load_dwordx4 v5, s[12:15], s19 offen lds
    ds_read_b64_tr_b16 a[224:225], v6 offset:0
    ds_read_b64_tr_b16 a[226:227], v6 offset:1024
    ds_read_b64_tr_b16 a[228:229], v7 offset:0
    ds_read_b64_tr_b16 a[230:231], v7 offset:1024
    ds_read_b64_tr_b16 a[232:233], v8 offset:0
    ds_read_b64_tr_b16 a[234:235], v8 offset:1024
    ds_read_b64_tr_b16 a[236:237], v9 offset:0
    ds_read_b64_tr_b16 a[238:239], v9 offset:1024
    s_waitcnt vmcnt(20) lgkmcnt(0)
    s_barrier
    s_mov_b32 s12, s48
    s_mov_b32 s13, s49
    s_mov_b32 s14, 0x480000
    s_mov_b32 s15, 0x20000
    s_add_u32 m0, s87, 0
    s_add_u32 s19, s88, 0
    buffer_load_dwordx4 v4, s[12:15], s19 offen lds
    s_add_u32 m0, s87, 1024
    s_add_u32 s19, s88, 32768
    buffer_load_dwordx4 v4, s[12:15], s19 offen lds
    s_add_u32 m0, s87, 2048
    s_add_u32 s19, s88, 65536
    buffer_load_dwordx4 v5, s[12:15], s19 offen lds
    s_add_u32 m0, s87, 3072
    s_add_u32 s19, s88, 98304
    buffer_load_dwordx4 v5, s[12:15], s19 offen lds
    ds_read_b64_tr_b16 a[240:241], v6 offset:4096
    ds_read_b64_tr_b16 a[242:243], v6 offset:5120
    ds_read_b64_tr_b16 a[244:245], v7 offset:4096
    ds_read_b64_tr_b16 a[246:247], v7 offset:5120
    ds_read_b64_tr_b16 a[248:249], v8 offset:4096
    ds_read_b64_tr_b16 a[250:251], v8 offset:5120
    ds_read_b64_tr_b16 a[252:253], v9 offset:4096
    ds_read_b64_tr_b16 a[254:255], v9 offset:5120
    s_waitcnt vmcnt(20) lgkmcnt(0)
    s_barrier
    s_add_u32 m0, s87, 4096
    s_add_u32 s19, s88, 1048576
    buffer_load_dwordx4 v4, s[12:15], s19 offen lds
    s_add_u32 m0, s87, 5120
    s_add_u32 s19, s88, 1081344
    buffer_load_dwordx4 v4, s[12:15], s19 offen lds
    s_add_u32 m0, s87, 6144
    s_add_u32 s19, s88, 1114112
    buffer_load_dwordx4 v5, s[12:15], s19 offen lds
    s_add_u32 m0, s87, 7168
    s_add_u32 s19, s88, 1146880
    buffer_load_dwordx4 v5, s[12:15], s19 offen lds
    ds_read_b64_tr_b16 v[80:81], v6 offset:8192
    ds_read_b64_tr_b16 v[82:83], v6 offset:9216
    ds_read_b64_tr_b16 v[84:85], v7 offset:8192
    ds_read_b64_tr_b16 v[86:87], v7 offset:9216
    ds_read_b64_tr_b16 v[88:89], v8 offset:8192
    ds_read_b64_tr_b16 v[90:91], v8 offset:9216
    ds_read_b64_tr_b16 v[92:93], v9 offset:8192
    ds_read_b64_tr_b16 v[94:95], v9 offset:9216
    s_waitcnt vmcnt(20) lgkmcnt(0)
    s_barrier
    s_add_u32 m0, s87, 8192
    s_add_u32 s19, s88, 2097152
    buffer_load_dwordx4 v4, s[12:15], s19 offen lds
    s_add_u32 m0, s87, 9216
    s_add_u32 s19, s88, 2129920
    buffer_load_dwordx4 v4, s[12:15], s19 offen lds
    s_add_u32 m0, s87, 10240
    s_add_u32 s19, s88, 2162688
    buffer_load_dwordx4 v5, s[12:15], s19 offen lds
    s_add_u32 m0, s87, 11264
    s_add_u32 s19, s88, 2195456
    buffer_load_dwordx4 v5, s[12:15], s19 offen lds
    ds_read_b64_tr_b16 v[96:97], v6 offset:12288
    ds_read_b64_tr_b16 v[98:99], v6 offset:13312
    ds_read_b64_tr_b16 v[100:101], v7 offset:12288
    ds_read_b64_tr_b16 v[102:103], v7 offset:13312
    ds_read_b64_tr_b16 v[104:105], v8 offset:12288
    ds_read_b64_tr_b16 v[106:107], v8 offset:13312
    ds_read_b64_tr_b16 v[108:109], v9 offset:12288
    ds_read_b64_tr_b16 v[110:111], v9 offset:13312
    s_waitcnt vmcnt(20) lgkmcnt(0)
    s_barrier
    s_add_u32 m0, s87, 12288
    s_add_u32 s19, s88, 3145728
    buffer_load_dwordx4 v4, s[12:15], s19 offen lds
    s_add_u32 m0, s87, 13312
    s_add_u32 s19, s88, 3178496
    buffer_load_dwordx4 v4, s[12:15], s19 offen lds
    s_add_u32 m0, s87, 14336
    s_add_u32 s19, s88, 3211264
    buffer_load_dwordx4 v5, s[12:15], s19 offen lds
    s_add_u32 m0, s87, 15360
    s_add_u32 s19, s88, 3244032
    buffer_load_dwordx4 v5, s[12:15], s19 offen lds
    ds_read_b64_tr_b16 v[112:113], v6 offset:16384
    ds_read_b64_tr_b16 v[114:115], v6 offset:17408
    ds_read_b64_tr_b16 v[116:117], v7 offset:16384
    ds_read_b64_tr_b16 v[118:119], v7 offset:17408
    ds_read_b64_tr_b16 v[120:121], v8 offset:16384
    ds_read_b64_tr_b16 v[122:123], v8 offset:17408
    ds_read_b64_tr_b16 v[124:125], v9 offset:16384
    ds_read_b64_tr_b16 v[126:127], v9 offset:17408
    s_waitcnt vmcnt(20) lgkmcnt(0)
    s_barrier
    s_add_u32 m0, s87, 16384
    s_add_u32 s19, s88, 4194304
    buffer_load_dwordx4 v4, s[12:15], s19 offen lds
    s_add_u32 m0, s87, 17408
    s_add_u32 s19, s88, 4227072
    buffer_load_dwordx4 v4, s[12:15], s19 offen lds
    s_add_u32 m0, s87, 18432
    s_add_u32 s19, s88, 4259840
    buffer_load_dwordx4 v5, s[12:15], s19 offen lds
    s_add_u32 m0, s87, 19456
    s_add_u32 s19, s88, 4292608
    buffer_load_dwordx4 v5, s[12:15], s19 offen lds
    ds_read_b64_tr_b16 v[128:129], v6 offset:20480
    ds_read_b64_tr_b16 v[130:131], v6 offset:21504
    ds_read_b64_tr_b16 v[132:133], v7 offset:20480
    ds_read_b64_tr_b16 v[134:135], v7 offset:21504
    ds_read_b64_tr_b16 v[136:137], v8 offset:20480
    ds_read_b64_tr_b16 v[138:139], v8 offset:21504
    ds_read_b64_tr_b16 v[140:141], v9 offset:20480
    ds_read_b64_tr_b16 v[142:143], v9 offset:21504
    s_waitcnt vmcnt(20) lgkmcnt(0)
    s_barrier
    s_mov_b32 s12, s50
    s_mov_b32 s13, s51
    s_mov_b32 s14, 0x480000
    s_mov_b32 s15, 0x20000
    s_add_u32 m0, s87, 20480
    s_add_u32 s19, s88, 1048576
    buffer_load_dwordx4 v4, s[12:15], s19 offen lds
    s_add_u32 m0, s87, 21504
    s_add_u32 s19, s88, 1081344
    buffer_load_dwordx4 v4, s[12:15], s19 offen lds
    s_add_u32 m0, s87, 22528
    s_add_u32 s19, s88, 1114112
    buffer_load_dwordx4 v5, s[12:15], s19 offen lds
    s_add_u32 m0, s87, 23552
    s_add_u32 s19, s88, 1146880
    buffer_load_dwordx4 v5, s[12:15], s19 offen lds
    ds_read_b64_tr_b16 v[20:21], v6 offset:24576
    ds_read_b64_tr_b16 v[22:23], v6 offset:25600
    ds_read_b64_tr_b16 v[24:25], v7 offset:24576
    ds_read_b64_tr_b16 v[26:27], v7 offset:25600
    ds_read_b64_tr_b16 v[28:29], v8 offset:24576
    ds_read_b64_tr_b16 v[30:31], v8 offset:25600
    ds_read_b64_tr_b16 v[32:33], v9 offset:24576
    ds_read_b64_tr_b16 v[34:35], v9 offset:25600
    s_waitcnt lgkmcnt(0)
    s_barrier
    ds_write_b128 v13, v[20:23] offset:24576
    ds_write_b128 v13, v[24:27] offset:25600
    ds_write_b128 v13, v[28:31] offset:26624
    ds_write_b128 v13, v[32:35] offset:27648
    s_waitcnt vmcnt(20) lgkmcnt(0)
    s_barrier
    ds_read_b64_tr_b16 v[20:21], v6 offset:0
    ds_read_b64_tr_b16 v[22:23], v6 offset:1024
    ds_read_b64_tr_b16 v[24:25], v7 offset:0
    ds_read_b64_tr_b16 v[26:27], v7 offset:1024
    ds_read_b64_tr_b16 v[28:29], v8 offset:0
    ds_read_b64_tr_b16 v[30:31], v8 offset:1024
    ds_read_b64_tr_b16 v[32:33], v9 offset:0
    ds_read_b64_tr_b16 v[34:35], v9 offset:1024
    s_waitcnt lgkmcnt(0)
    s_barrier
    ds_write_b128 v13, v[20:23] offset:0
    ds_write_b128 v13, v[24:27] offset:1024
    ds_write_b128 v13, v[28:31] offset:2048
    ds_write_b128 v13, v[32:35] offset:3072
    s_waitcnt vmcnt(16) lgkmcnt(0)
    s_barrier
    ds_read_b64_tr_b16 v[20:21], v6 offset:4096
    ds_read_b64_tr_b16 v[22:23], v6 offset:5120
    ds_read_b64_tr_b16 v[24:25], v7 offset:4096
    ds_read_b64_tr_b16 v[26:27], v7 offset:5120
    ds_read_b64_tr_b16 v[28:29], v8 offset:4096
    ds_read_b64_tr_b16 v[30:31], v8 offset:5120
    ds_read_b64_tr_b16 v[32:33], v9 offset:4096
    ds_read_b64_tr_b16 v[34:35], v9 offset:5120
    s_waitcnt lgkmcnt(0)
    s_barrier
    ds_write_b128 v13, v[20:23] offset:4096
    ds_write_b128 v13, v[24:27] offset:5120
    ds_write_b128 v13, v[28:31] offset:6144
    ds_write_b128 v13, v[32:35] offset:7168
    s_waitcnt vmcnt(12) lgkmcnt(0)
    s_barrier
    ds_read_b64_tr_b16 v[20:21], v6 offset:8192
    ds_read_b64_tr_b16 v[22:23], v6 offset:9216
    ds_read_b64_tr_b16 v[24:25], v7 offset:8192
    ds_read_b64_tr_b16 v[26:27], v7 offset:9216
    ds_read_b64_tr_b16 v[28:29], v8 offset:8192
    ds_read_b64_tr_b16 v[30:31], v8 offset:9216
    ds_read_b64_tr_b16 v[32:33], v9 offset:8192
    ds_read_b64_tr_b16 v[34:35], v9 offset:9216
    s_waitcnt lgkmcnt(0)
    s_barrier
    ds_write_b128 v13, v[20:23] offset:8192
    ds_write_b128 v13, v[24:27] offset:9216
    ds_write_b128 v13, v[28:31] offset:10240
    ds_write_b128 v13, v[32:35] offset:11264
    s_waitcnt vmcnt(8) lgkmcnt(0)
    s_barrier
    ds_read_b64_tr_b16 v[20:21], v6 offset:12288
    ds_read_b64_tr_b16 v[22:23], v6 offset:13312
    ds_read_b64_tr_b16 v[24:25], v7 offset:12288
    ds_read_b64_tr_b16 v[26:27], v7 offset:13312
    ds_read_b64_tr_b16 v[28:29], v8 offset:12288
    ds_read_b64_tr_b16 v[30:31], v8 offset:13312
    ds_read_b64_tr_b16 v[32:33], v9 offset:12288
    ds_read_b64_tr_b16 v[34:35], v9 offset:13312
    s_waitcnt lgkmcnt(0)
    s_barrier
    ds_write_b128 v13, v[20:23] offset:12288
    ds_write_b128 v13, v[24:27] offset:13312
    ds_write_b128 v13, v[28:31] offset:14336
    ds_write_b128 v13, v[32:35] offset:15360
    s_waitcnt vmcnt(4) lgkmcnt(0)
    s_barrier
    ds_read_b64_tr_b16 v[20:21], v6 offset:16384
    ds_read_b64_tr_b16 v[22:23], v6 offset:17408
    ds_read_b64_tr_b16 v[24:25], v7 offset:16384
    ds_read_b64_tr_b16 v[26:27], v7 offset:17408
    ds_read_b64_tr_b16 v[28:29], v8 offset:16384
    ds_read_b64_tr_b16 v[30:31], v8 offset:17408
    ds_read_b64_tr_b16 v[32:33], v9 offset:16384
    ds_read_b64_tr_b16 v[34:35], v9 offset:17408
    s_waitcnt lgkmcnt(0)
    s_barrier
    ds_write_b128 v13, v[20:23] offset:16384
    ds_write_b128 v13, v[24:27] offset:17408
    ds_write_b128 v13, v[28:31] offset:18432
    ds_write_b128 v13, v[32:35] offset:19456
    s_waitcnt vmcnt(0) lgkmcnt(0)
    s_barrier
    ds_read_b64_tr_b16 v[20:21], v6 offset:20480
    ds_read_b64_tr_b16 v[22:23], v6 offset:21504
    ds_read_b64_tr_b16 v[24:25], v7 offset:20480
    ds_read_b64_tr_b16 v[26:27], v7 offset:21504
    ds_read_b64_tr_b16 v[28:29], v8 offset:20480
    ds_read_b64_tr_b16 v[30:31], v8 offset:21504
    ds_read_b64_tr_b16 v[32:33], v9 offset:20480
    ds_read_b64_tr_b16 v[34:35], v9 offset:21504
    s_waitcnt lgkmcnt(0)
    s_barrier
    ds_write_b128 v13, v[20:23] offset:20480
    ds_write_b128 v13, v[24:27] offset:21504
    ds_write_b128 v13, v[28:31] offset:22528
    ds_write_b128 v13, v[32:35] offset:23552
    s_waitcnt lgkmcnt(0)
    s_barrier
    s_cmp_ge_u32 s75, 32
    s_cselect_b32 s13, 1, 0
    s_cmp_eq_u32 s13, 1
    s_cbranch_scc0 L_chain_slow
L_chain_fast:
    s_cmp_eq_u32 s17, 0
    s_cbranch_scc0 L_ld_22
    s_mov_b32 s20, 0x204580
    v_mov_b32 v61, 1
    s_mov_b64 exec, 1
    buffer_atomic_add v61, off, s[8:11], s20
    s_mov_b64 exec, -1
    s_mov_b32 s20, 0x204480
    buffer_load_dword v78, off, s[8:11], s20 sc1
    s_mov_b32 s20, 0x200480
    buffer_load_dword v79, off, s[8:11], s20 sc1
L_ld_22:
    v_and_b32 v20, 15, v0
    v_lshrrev_b32 v21, 4, v0
    v_lshlrev_b32 v1, 4, v0
    v_mov_b32 v2, 0x44444444
    v_mov_b32 v22, 0xeeeeeeee
    v_cmp_lt_u32 vcc, 7, v20
    s_nop 1
    v_cndmask_b32 v2, v2, v22, vcc
    v_lshrrev_b32 v25, 3, v20
    v_and_b32 v26, 7, v20
    v_lshl_add_u32 v22, v21, 3, v26
    v_lshlrev_b32 v6, 4, v22
    v_lshrrev_b32 v22, 1, v21
    v_lshl_add_u32 v22, v22, 6, v20
    s_lshl_b32 s19, s17, 4
    v_add_u32 v22, s19, v22
    v_lshlrev_b32 v22, 4, v22
    v_and_b32 v23, 1, v21
    v_lshl_add_u32 v3, v23, 3, v22
    v_lshlrev_b32 v22, 4, v20
    v_lshl_add_u32 v22, v21, 2, v22
    s_lshl_b32 s19, s17, 8
    v_add_u32 v17, s19, v22
    s_sub_u32 s19, s17, 1
    s_lshl_b32 s19, s19, 5
    s_add_u32 s19, s19, s16
    s_cmp_lt_u32 s19, 72
    s_cselect_b32 s34, 1, 0
    s_cmp_eq_u32 s17, 0
    s_cselect_b32 s34, 0, s34
    s_cmp_eq_u32 s34, 0
    s_cselect_b32 s19, 0, s19
    s_lshr_b32 s20, s19, 3
    s_mul_i32 s45, s20, 1
    s_add_u32 s45, s45, 1
    s_lshl_b32 s21, s19, 7
    v_lshl_add_u32 v22, v21, 1, v25
    s_movk_i32 s20, 9216
    v_mul_lo_u32 v22, v22, s20
    v_lshl_add_u32 v22, v26, 4, v22
    v_add_u32 v4, s21, v22
    v_lshlrev_b32 v22, 1, v20
    v_and_b32 v22, 7, v22
    v_bfe_u32 v23, v20, 2, 1
    v_add_u32 v22, v22, v23
    s_cmp_lt_u32 s19, 8
    s_cselect_b64 vcc, -1, 0
    v_cndmask_b32 v22, v20, v22, vcc
    v_lshlrev_b32 v22, 4, v22
    v_lshl_add_u32 v22, v21, 2, v22
    v_add_u32 v22, s21, v22
    v_mov_b32 v23, 0x40000000
    v_cmp_lt_u32 vcc, 7, v20
    s_nop 1
    v_cndmask_b32 v22, v22, v23, vcc
    s_cmp_eq_u32 s34, 0
    s_cselect_b64 vcc, -1, 0
    v_cndmask_b32 v5, v22, v23, vcc
    s_mul_i32 s19, s17, 1280
    s_add_u32 s19, s19, 9216
    v_add_u32 v7, s19, v6
    v_lshl_add_u32 v22, v25, 9, v6
    v_add_u32 v8, 9216, v22
    v_and_b32 v22, 1, v21
    v_lshl_add_u32 v22, v22, 3, v26
    v_lshlrev_b32 v22, 4, v22
    s_movk_i32 s20, 2560
    v_mul_lo_u32 v23, v25, s20
    v_add_u32 v22, v22, v23
    v_add_u32 v9, 10240, v22
    v_lshl_add_u32 v27, v25, 4, v26
    s_lshl_b32 s19, s17, 2
    v_add_u32 v22, s19, v21
    v_lshl_add_u32 v22, v22, 5, v27
    v_lshlrev_b32 v10, 4, v22
    s_lshl_b32 s19, s17, 5
    v_lshl_add_u32 v22, v21, 7, v27
    v_add_u32 v22, s19, v22
    v_lshlrev_b32 v11, 4, v22
    v_lshrrev_b32 v22, 1, v21
    v_lshl_add_u32 v22, v22, 3, v27
    v_add_u32 v22, s19, v22
    v_lshlrev_b32 v22, 4, v22
    v_and_b32 v23, 1, v21
    v_lshl_add_u32 v13, v23, 3, v22
    s_mul_i32 s19, s17, 36864
    s_add_u32 s19, s19, 16384
    v_add_u32 v12, s19, v1
    v_and_b32 v22, 3, v20
    v_lshrrev_b32 v23, 2, v26
    v_and_b32 v24, 1, v21
    v_cmp_eq_u32 s[40:41], v23, v24
    v_and_b32 v23, 1, v22
    v_lshlrev_b32 v23, 4, v23
    v_mov_b32 v28, 0x3f80
    v_lshlrev_b32 v16, v23, v28
    v_cndmask_b32 v29, 0, v16, s[40:41]
    v_cmp_gt_u32 vcc, 2, v22
    s_nop 1
    v_cndmask_b32 v14, 0, v29, vcc
    v_cmp_lt_u32 vcc, 1, v22
    s_nop 1
    v_cndmask_b32 v15, 0, v29, vcc
    v_lshrrev_b32 v23, 1, v20
    v_cmp_eq_u32 s[64:65], 0, v23
    v_cmp_eq_u32 s[66:67], 1, v23
    v_cmp_eq_u32 s[68:69], 2, v23
    v_cmp_eq_u32 s[70:71], 3, v23
    s_mov_b32 s36, 0x00ff00ff
    s_mov_b32 s37, 0x00ff00ff
    s_mov_b32 s60, 0x00ff00ff
    s_mov_b32 s61, 0
    s_mov_b32 s38, 0x3e0293ee
    s_lshl_b32 s56, s17, 9
    s_add_u32 s56, s56, 14336
    s_lshl_b32 s57, s17, 10
    s_mov_b32 s39, 0
    s_mov_b32 s58, 20000
    s_mul_i32 s23, s16, 9216
    s_add_u32 s23, s23, 0x0
    s_add_u32 s24, s23, 4096
    s_mov_b32 s25, 0x0
    s_mov_b32 s26, 0x12000
    s_mov_b32 s27, 0x24000
    s_mov_b32 s28, 0x36000
    s_mov_b32 s30, 0x102400
    s_mov_b32 s31, 0x104800
    s_lshl_b32 s32, s16, 13
    s_add_u32 s72, s32, 0x2000000
    s_add_u32 s32, s32, 0x1000000
    s_lshl_b32 s33, s16, 11
    s_lshl_b32 s20, s17, 9
    s_add_u32 s73, s33, s20
    s_add_u32 s73, s73, 0x6c00000
    s_add_u32 s33, s33, 0x7000000
    s_mov_b32 s18, 0
    s_mov_b32 s44, 0
    s_mov_b32 s74, 0x40000000
    v_mov_b64 v[18:19], 0
    s_mov_b32 s84, 0
    s_mov_b32 s85, 0
    v_mov_b32 v0, -1
    s_lshl_b32 s86, s16, 7
    s_add_u32 s86, s86, 0x201480
    s_cmp_eq_u32 s17, 0
    s_cselect_b32 s59, s86, 0x40000000
    s_cmp_eq_u32 s17, 0
    s_cbranch_scc0 L_cb_f_wait
    s_waitcnt vmcnt(0)
    v_readfirstlane_b32 s19, v78
    v_readfirstlane_b32 s20, v79
    s_cmp_ge_u32 s19, 32
    s_cselect_b32 s19, 1, 0
    s_cmp_ge_u32 s20, 128
    s_cselect_b32 s19, s19, 0
    s_cmp_eq_u32 s19, 1
    s_cbranch_scc1 L_cb_f_wait
    s_mov_b32 s21, 0x204480
    s_mov_b32 s35, s3
L_pg_23:
    s_mov_b64 exec, 1
    buffer_load_dword v22, off, s[8:11], s21 sc1
    s_waitcnt vmcnt(0)
    s_nop 0
    v_readfirstlane_b32 s19, v22
    s_mov_b64 exec, -1
    s_cmp_ge_u32 s19, 32
    s_cbranch_scc1 L_pg_23_d
    s_sleep 2
    s_sub_u32 s35, s35, 1
    s_cmp_lg_u32 s35, 0
    s_cbranch_scc1 L_pg_23
    s_mov_b32 s3, 1
L_pg_23_d:
    s_mov_b32 s21, 0x200480
    s_mov_b32 s35, s3
L_pg_24:
    s_mov_b64 exec, 1
    buffer_load_dword v22, off, s[8:11], s21 sc1
    s_waitcnt vmcnt(0)
    s_nop 0
    v_readfirstlane_b32 s19, v22
    s_mov_b64 exec, -1
    s_cmp_ge_u32 s19, 128
    s_cbranch_scc1 L_pg_24_d
    s_sleep 2
    s_sub_u32 s35, s35, 1
    s_cmp_lg_u32 s35, 0
    s_cbranch_scc1 L_pg_24
    s_mov_b32 s3, 1
L_pg_24_d:
L_cb_f_wait:
    v_mov_b64 v[48:49], 0
    v_mov_b64 v[50:51], 0
    v_mov_b64 v[52:53], 0
    v_mov_b64 v[54:55], 0
    v_mov_b64 v[56:57], 0
    v_mov_b64 v[58:59], 0
    v_mov_b64 v[60:61], 0
    v_mov_b64 v[62:63], 0
    v_mov_b64 v[64:65], 0
    v_mov_b64 v[66:67], 0
    v_mov_b64 v[68:69], 0
    v_mov_b64 v[70:71], 0
    ds_read_b128 v[32:35], v12 offset:0
    ds_read_b128 v[36:39], v12 offset:1024
    ds_read_b128 v[40:43], v12 offset:2048
    ds_read_b128 v[44:47], v12 offset:3072
    s_waitcnt vmcnt(0) lgkmcnt(0)
    s_barrier
    .p2align 6
L_chain_loopf:
    ds_read_b128 v[20:23], v1 offset:0
    ds_read_b128 v[24:27], v1 offset:1024
    buffer_load_dwordx4 v[72:75], v10, s[8:11], s32 offen
    buffer_load_dwordx4 v[76:79], v10, s[8:11], s32 offen offset:128
    ds_read_b128 v[28:31], v1 offset:2048
    s_waitcnt lgkmcnt(2)
    v_smfmac_f32_16x16x64_bf16 v[48:51], v[20:23], a[0:7], v2
    v_smfmac_f32_16x16x64_bf16 v[52:55], v[20:23], a[8:15], v2
    v_smfmac_f32_16x16x64_bf16 v[56:59], v[20:23], v[32:39], v2
    v_smfmac_f32_16x16x64_bf16 v[60:63], v[20:23], v[40:47], v2
    ds_read_b128 v[20:23], v1 offset:3072
    s_waitcnt lgkmcnt(2)
    v_smfmac_f32_16x16x64_bf16 v[48:51], v[24:27], a[16:23], v2
    v_smfmac_f32_16x16x64_bf16 v[52:55], v[24:27], a[24:31], v2
    ds_read_b128 v[32:35], v12 offset:4096
    ds_read_b128 v[36:39], v12 offset:5120
    v_smfmac_f32_16x16x64_bf16 v[56:59], v[24:27], a[144:151], v2
    ds_read_b128 v[40:43], v12 offset:6144
    ds_read_b128 v[44:47], v12 offset:7168
    v_smfmac_f32_16x16x64_bf16 v[60:63], v[24:27], a[152:159], v2
    ds_read_b128 v[24:27], v1 offset:4096
    s_waitcnt lgkmcnt(6)
    v_smfmac_f32_16x16x64_bf16 v[48:51], v[28:31], a[32:39], v2
    v_smfmac_f32_16x16x64_bf16 v[52:55], v[28:31], a[40:47], v2
    s_waitcnt lgkmcnt(3)
    v_smfmac_f32_16x16x64_bf16 v[56:59], v[28:31], v[32:39], v2
    s_waitcnt lgkmcnt(1)
    v_smfmac_f32_16x16x64_bf16 v[60:63], v[28:31], v[40:47], v2
    ds_read_b128 v[28:31], v1 offset:5120
    v_smfmac_f32_16x16x64_bf16 v[48:51], v[20:23], a[48:55], v2
    v_smfmac_f32_16x16x64_bf16 v[52:55], v[20:23], a[56:63], v2
    ds_read_b128 v[32:35], v12 offset:8192
    ds_read_b128 v[36:39], v12 offset:9216
    v_smfmac_f32_16x16x64_bf16 v[56:59], v[20:23], a[160:167], v2
    ds_read_b128 v[40:43], v12 offset:10240
    ds_read_b128 v[44:47], v12 offset:11264
    v_smfmac_f32_16x16x64_bf16 v[60:63], v[20:23], a[168:175], v2
    ds_read_b128 v[20:23], v1 offset:6144
    s_waitcnt lgkmcnt(6)
    v_smfmac_f32_16x16x64_bf16 v[48:51], v[24:27], a[64:71], v2
    v_smfmac_f32_16x16x64_bf16 v[52:55], v[24:27], a[72:79], v2
    s_waitcnt lgkmcnt(3)
    v_smfmac_f32_16x16x64_bf16 v[56:59], v[24:27], v[32:39], v2
    s_waitcnt lgkmcnt(1)
    v_smfmac_f32_16x16x64_bf16 v[60:63], v[24:27], v[40:47], v2
    ds_read_b128 v[24:27], v1 offset:7168
    v_smfmac_f32_16x16x64_bf16 v[48:51], v[28:31], a[80:87], v2
    v_smfmac_f32_16x16x64_bf16 v[52:55], v[28:31], a[88:95], v2
    ds_read_b128 v[32:35], v12 offset:12288
    ds_read_b128 v[36:39], v12 offset:13312
    v_smfmac_f32_16x16x64_bf16 v[56:59], v[28:31], a[176:183], v2
    ds_read_b128 v[40:43], v12 offset:14336
    ds_read_b128 v[44:47], v12 offset:15360
    v_smfmac_f32_16x16x64_bf16 v[60:63], v[28:31], a[184:191], v2
    ds_read_b128 v[28:31], v1 offset:8192
    s_waitcnt lgkmcnt(6)
    v_smfmac_f32_16x16x64_bf16 v[48:51], v[20:23], a[96:103], v2
    v_mov_b64 v[68:69], 0
    v_smfmac_f32_16x16x64_bf16 v[52:55], v[20:23], a[104:111], v2
    v_mov_b64 v[70:71], 0
    s_waitcnt lgkmcnt(3)
    v_smfmac_f32_16x16x64_bf16 v[56:59], v[20:23], v[32:39], v2
    s_waitcnt lgkmcnt(1)
    v_smfmac_f32_16x16x64_bf16 v[60:63], v[20:23], v[40:47], v2
    v_smfmac_f32_16x16x64_bf16 v[48:51], v[24:27], a[112:119], v2
    v_smfmac_f32_16x16x64_bf16 v[52:55], v[24:27], a[120:127], v2
    ds_read_b128 v[32:35], v12 offset:16384
    ds_read_b128 v[36:39], v12 offset:17408
    v_smfmac_f32_16x16x64_bf16 v[56:59], v[24:27], a[192:199], v2
    ds_read_b128 v[40:43], v12 offset:18432
    ds_read_b128 v[44:47], v12 offset:19456
    v_smfmac_f32_16x16x64_bf16 v[60:63], v[24:27], a[200:207], v2
    s_waitcnt lgkmcnt(4)
    v_smfmac_f32_16x16x64_bf16 v[48:51], v[28:31], a[128:135], v2
    v_smfmac_f32_16x16x64_bf16 v[52:55], v[28:31], a[136:143], v2
    ds_read_b128 v[20:23], v1 offset:2048
    ds_read_b128 v[24:27], v1 offset:6144
    s_waitcnt lgkmcnt(4)
    v_smfmac_f32_16x16x64_bf16 v[56:59], v[28:31], v[32:39], v2
    ds_read_b128 v[32:35], v12 offset:20480
    ds_read_b128 v[36:39], v12 offset:21504
    s_waitcnt lgkmcnt(4)
    v_smfmac_f32_16x16x64_bf16 v[60:63], v[28:31], v[40:47], v2
    ds_read_b128 v[40:43], v12 offset:22528
    ds_read_b128 v[44:47], v12 offset:23552
    v_cvt_pk_bf16_f32 v48, v48, v49
    v_cvt_pk_bf16_f32 v49, v50, v51
    v_cvt_pk_bf16_f32 v52, v52, v53
    v_cvt_pk_bf16_f32 v53, v54, v55
    v_mfma_f32_16x16x16_bf16 v[48:51], v[48:49], v[14:15], 0
    s_nop 0
    v_mfma_f32_16x16x16_bf16 v[52:55], v[52:53], v[14:15], 0
    v_cvt_pk_bf16_f32 v56, v56, v57
    v_cvt_pk_bf16_f32 v57, v58, v59
    v_cvt_pk_bf16_f32 v60, v60, v61
    v_cvt_pk_bf16_f32 v61, v62, v63
    v_mfma_f32_16x16x16_bf16 v[56:59], v[56:57], v[14:15], 0
    s_nop 0
    v_mfma_f32_16x16x16_bf16 v[60:63], v[60:61], v[14:15], 0
    s_waitcnt lgkmcnt(2)
    v_smfmac_f32_16x16x64_bf16 v[64:67], v[20:23], v[32:39], v2
    ds_read_b128 v[32:35], v12 offset:24576
    ds_read_b128 v[36:39], v12 offset:25600
    v_cvt_pk_bf16_f32 v48, v48, v49
    v_cvt_pk_bf16_f32 v49, v50, v51
    v_cvt_pk_bf16_f32 v50, v52, v53
    v_cvt_pk_bf16_f32 v51, v54, v55
    s_waitcnt vmcnt(1)
    s_nop 0
    v_mfma_f32_16x16x32_bf16 v[52:55], v[72:75], v[48:51], 0
    s_waitcnt vmcnt(0)
    v_mfma_f32_16x16x32_bf16 v[76:79], v[76:79], v[48:51], 0
    v_cvt_pk_bf16_f32 v56, v56, v57
    v_cvt_pk_bf16_f32 v57, v58, v59
    v_cvt_pk_bf16_f32 v58, v60, v61
    v_cvt_pk_bf16_f32 v59, v62, v63
    s_waitcnt lgkmcnt(2)
    v_smfmac_f32_16x16x64_bf16 v[68:71], v[20:23], v[40:47], v2
    ds_read_b128 v[40:43], v12 offset:26624
    ds_read_b128 v[44:47], v12 offset:27648
    ds_read_b128 v[28:31], v1 offset:0
    v_mfma_f32_16x16x32_bf16 v[60:63], v[56:59], v[48:51], 0
    s_waitcnt lgkmcnt(3)
    v_smfmac_f32_16x16x64_bf16 v[64:67], v[24:27], v[32:39], v2
    ds_read_b128 v[20:23], v1 offset:1024
    s_mov_b64 exec, s[36:37]
    ds_write_b128 v7, v[52:55]
    ds_write_b128 v7, v[76:79] offset:512
    s_mov_b64 exec, -1
    buffer_load_dwordx4 v[72:75], v11, s[8:11], s72 offen
    s_mov_b64 exec, s[60:61]
    ds_write_b128 v7, v[60:63] offset:1024
    s_mov_b64 exec, -1
    buffer_load_dwordx4 v[76:79], v11, s[8:11], s72 offen offset:128
    s_waitcnt lgkmcnt(5)
    v_smfmac_f32_16x16x64_bf16 v[68:71], v[24:27], v[40:47], v2
    s_waitcnt lgkmcnt(4)
    v_smfmac_f32_16x16x64_bf16 v[64:67], v[28:31], a[208:215], v2
    ds_read_b128 v[24:27], v1 offset:3072
    v_smfmac_f32_16x16x64_bf16 v[68:71], v[28:31], a[216:223], v2
    s_waitcnt lgkmcnt(1)
    s_cmp_eq_u32 s18, 63
    s_cbranch_scc1 L_chain_lastf
    s_barrier
    ds_read_b128 v[48:51], v8 offset:0
    ds_read_b128 v[52:55], v8 offset:1280
    ds_read_b128 v[60:63], v8 offset:3840
    ds_read_b128 v[40:43], v9 offset:0
    ds_read_b128 v[44:47], v9 offset:1280
    s_mov_b64 exec, s[36:37]
    buffer_store_dwordx4 v[56:59], v6, s[8:11], s73 offen sc1
    s_mov_b64 exec, -1
    s_nop 3
    ds_read_b128 v[56:59], v8 offset:2560
    buffer_store_dwordx2 v[18:19], v13, s[8:11], s74 offen sc1
    v_smfmac_f32_16x16x64_bf16 v[64:67], v[20:23], a[224:231], v2
    ds_read_b128 v[28:31], v1 offset:4096
    v_smfmac_f32_16x16x64_bf16 v[68:71], v[20:23], a[232:239], v2
    s_sub_i32 s19, s18, 1
    s_max_i32 s19, s19, 0
    v_mov_b32 v18, s19
    s_mov_b64 exec, 1
    buffer_store_dword v18, off, s[8:11], s59 sc1
    s_mov_b64 exec, -1
    s_waitcnt lgkmcnt(7)
    v_smfmac_f32_16x16x64_bf16 v[64:67], v[24:27], a[240:247], v2
    ds_read_b128 v[20:23], v1 offset:5120
    v_smfmac_f32_16x16x64_bf16 v[68:71], v[24:27], a[248:255], v2
    s_waitcnt lgkmcnt(1)
    v_smfmac_f32_16x16x64_bf16 v[64:67], v[28:31], v[80:87], v2
    ds_read_b128 v[24:27], v1 offset:7168
    v_pk_add_f32 v[48:49], v[48:49], v[52:53]
    v_pk_add_f32 v[50:51], v[50:51], v[54:55]
    v_smfmac_f32_16x16x64_bf16 v[68:71], v[28:31], v[88:95], v2
    v_pk_add_f32 v[56:57], v[56:57], v[60:61]
    v_pk_add_f32 v[58:59], v[58:59], v[62:63]
    s_waitcnt lgkmcnt(1)
    v_smfmac_f32_16x16x64_bf16 v[64:67], v[20:23], v[96:103], v2
    ds_read_b128 v[28:31], v1 offset:8192
    v_pk_add_f32 v[40:41], v[40:41], v[44:45]
    v_pk_add_f32 v[42:43], v[42:43], v[46:47]
    v_smfmac_f32_16x16x64_bf16 v[68:71], v[20:23], v[104:111], v2
    v_pk_add_f32 v[48:49], v[48:49], v[56:57]
    v_pk_add_f32 v[50:51], v[50:51], v[58:59]
    v_add_f32_dpp v40, v40, v40 row_ror:8 row_mask:0xf bank_mask:0xf
    v_add_f32_dpp v41, v41, v41 row_ror:8 row_mask:0xf bank_mask:0xf
    v_add_f32_dpp v42, v42, v42 row_ror:8 row_mask:0xf bank_mask:0xf
    v_add_f32_dpp v43, v43, v43 row_ror:8 row_mask:0xf bank_mask:0xf
    v_max3_f32 v44, v48, v49, v50
    v_max3_f32 v44, v44, v51, v40
    v_max3_f32 v44, v44, v41, v42
    v_max_f32 v44, v44, v43
    s_waitcnt lgkmcnt(1)
    v_smfmac_f32_16x16x64_bf16 v[64:67], v[24:27], v[112:119], v2
    v_max_f32_dpp v44, v44, v44 row_ror:8 row_mask:0xf bank_mask:0xf
    v_mov_b32 v62, 0x3f803f80
    v_mov_b32 v45, v44
    v_smfmac_f32_16x16x64_bf16 v[68:71], v[24:27], v[120:127], v2
    s_waitcnt lgkmcnt(0)
    v_smfmac_f32_16x16x64_bf16 v[64:67], v[28:31], v[128:135], v2
    v_smfmac_f32_16x16x64_bf16 v[68:71], v[28:31], v[136:143], v2
    v_mov_b32 v63, 0x3f803f80
    v_permlane16_swap_b32 v44, v45
    v_max_f32 v44, v44, v45
    v_mov_b32 v45, v44
    v_mov_b32 v46, 0x3f003f00
    v_mov_b32 v47, 0x3f003f00
    v_permlane32_swap_b32 v44, v45
    v_max_f32 v44, v44, v45
    v_mul_f32 v44, s38, v44
    v_fma_f32 v48, v48, s38, -v44
    v_fma_f32 v49, v49, s38, -v44
    v_fma_f32 v50, v50, s38, -v44
    v_fma_f32 v51, v51, s38, -v44
    v_fma_f32 v40, v40, s38, -v44
    v_fma_f32 v41, v41, s38, -v44
    v_fma_f32 v42, v42, s38, -v44
    v_fma_f32 v43, v43, s38, -v44
    v_exp_f32 v48, v48
    v_exp_f32 v49, v49
    v_exp_f32 v50, v50
    v_exp_f32 v51, v51
    v_exp_f32 v40, v40
    v_exp_f32 v41, v41
    v_exp_f32 v42, v42
    v_exp_f32 v43, v43
    v_cvt_pk_bf16_f32 v56, v40, v41
    v_cvt_pk_bf16_f32 v57, v42, v43
    v_cvt_pk_bf16_f32 v52, v48, v49
    v_cvt_pk_bf16_f32 v53, v50, v51
    v_mfma_f32_16x16x16_bf16 v[28:31], v[46:47], v[56:57], 0
    v_mov_b32_dpp v54, v52 row_ror:8 row_mask:0xf bank_mask:0xf
    v_mov_b32_dpp v55, v53 row_ror:8 row_mask:0xf bank_mask:0xf
    v_mfma_f32_16x16x16_bf16 v[28:31], v[62:63], v[52:53], v[28:31]
    v_cvt_pk_bf16_f32 v58, v64, v65
    v_mfma_f32_16x16x16_bf16 v[28:31], v[62:63], v[54:55], v[28:31]
    v_cvt_pk_bf16_f32 v59, v66, v67
    s_waitcnt vmcnt(4)
    v_mfma_f32_16x16x32_bf16 v[20:23], v[72:75], v[52:55], 0
    v_cvt_pk_bf16_f32 v60, v68, v69
    s_waitcnt vmcnt(3)
    v_mfma_f32_16x16x32_bf16 v[24:27], v[76:79], v[52:55], 0
    v_cvt_pk_bf16_f32 v61, v70, v71
    v_mfma_f32_16x16x16_bf16 v[20:23], v[58:59], v[56:57], v[20:23]
    v_add_u32 v40, s56, v6
    v_mfma_f32_16x16x16_bf16 v[24:27], v[60:61], v[56:57], v[24:27]
    v_rcp_f32 v28, v28
    ds_read_b128 v[32:35], v12 offset:28672
    ds_read_b128 v[36:39], v12 offset:29696
    s_nop 2
    v_pk_mul_f32 v[20:21], v[20:21], v[28:29] op_sel_hi:[1,0]
    v_pk_mul_f32 v[22:23], v[22:23], v[28:29] op_sel_hi:[1,0]
    v_pk_mul_f32 v[24:25], v[24:25], v[28:29] op_sel_hi:[1,0]
    v_pk_mul_f32 v[26:27], v[26:27], v[28:29] op_sel_hi:[1,0]
    v_cvt_pk_bf16_f32 v60, v20, v21
    v_cvt_pk_bf16_f32 v61, v22, v23
    v_cvt_pk_bf16_f32 v62, v24, v25
    v_cvt_pk_bf16_f32 v63, v26, v27
    s_mov_b64 exec, s[36:37]
    ds_write_b128 v40, v[60:63]
    s_mov_b64 exec, -1
    v_mov_b64 v[72:73], 0
    v_mov_b64 v[74:75], 0
    v_mov_b64 v[76:77], 0
    v_mov_b64 v[78:79], 0
    v_mov_b64 v[28:29], 0
    v_mov_b64 v[30:31], 0
    ds_read_b128 v[40:43], v12 offset:30720
    ds_read_b128 v[44:47], v12 offset:31744
    s_waitcnt lgkmcnt(2)
    s_barrier
    ds_read_b128 v[20:23], v8 offset:5120
    ds_read_b128 v[24:27], v8 offset:6144
    ds_read_b128 v[48:51], v6 offset:14336
    ds_read_b128 v[52:55], v6 offset:14848
    ds_read_b128 v[56:59], v6 offset:15360
    ds_read_b128 v[60:63], v6 offset:15872
    s_waitcnt lgkmcnt(5)
    v_smfmac_f32_16x16x64_bf16 v[28:31], v[20:23], v[144:151], v2
    s_waitcnt lgkmcnt(4)
    v_smfmac_f32_16x16x64_bf16 v[28:31], v[24:27], v[152:159], v2
    s_waitcnt lgkmcnt(3)
    v_smfmac_f32_16x16x64_bf16 v[72:75], v[48:51], v[160:167], v2
    v_mov_b64 v[20:21], 0
    v_mov_b64 v[22:23], 0
    s_waitcnt lgkmcnt(2)
    v_smfmac_f32_16x16x64_bf16 v[72:75], v[52:55], v[168:175], v2
    v_mov_b64 v[24:25], 0
    v_mov_b64 v[26:27], 0
    s_waitcnt lgkmcnt(1)
    v_smfmac_f32_16x16x64_bf16 v[72:75], v[56:59], v[176:183], v2
    v_permlane32_swap_b32 v28, v29
    s_waitcnt lgkmcnt(0)
    v_smfmac_f32_16x16x64_bf16 v[72:75], v[60:63], v[32:39], v2
    ds_read_b128 v[32:35], v12 offset:32768
    ds_read_b128 v[36:39], v12 offset:33792
    v_permlane32_swap_b32 v30, v31
    v_smfmac_f32_16x16x64_bf16 v[76:79], v[48:51], v[184:191], v2
    v_add_f32 v28, v28, v29
    v_add_f32 v30, v30, v31
    v_smfmac_f32_16x16x64_bf16 v[76:79], v[52:55], v[192:199], v2
    v_cvt_pk_bf16_f32 v28, v28, v30
    v_bfi_b32 v28, 1, s44, v28
    buffer_store_dword v28, v17, s[8:11], s23 offen
    v_smfmac_f32_16x16x64_bf16 v[76:79], v[56:59], v[200:207], v2
    v_cvt_pk_bf16_f32 v72, v72, v73
    v_cvt_pk_bf16_f32 v73, v74, v75
    v_bfi_b32 v72, 1, s44, v72
    buffer_store_dwordx2 v[72:73], v3, s[8:11], s23 offen offset:1024
    v_smfmac_f32_16x16x64_bf16 v[76:79], v[60:63], v[40:47], v2
    ds_read_b128 v[40:43], v12 offset:34816
    ds_read_b128 v[44:47], v12 offset:35840
    v_smfmac_f32_16x16x64_bf16 v[20:23], v[48:51], v[208:215], v2
    v_smfmac_f32_16x16x64_bf16 v[20:23], v[52:55], v[216:223], v2
    v_smfmac_f32_16x16x64_bf16 v[20:23], v[56:59], v[224:231], v2
    s_nop 2
    v_cvt_pk_bf16_f32 v76, v76, v77
    v_cvt_pk_bf16_f32 v77, v78, v79
    v_bfi_b32 v76, 1, s44, v76
    buffer_store_dwordx2 v[76:77], v3, s[8:11], s23 offen offset:3072
    s_waitcnt lgkmcnt(2)
    v_smfmac_f32_16x16x64_bf16 v[20:23], v[60:63], v[32:39], v2
    v_smfmac_f32_16x16x64_bf16 v[24:27], v[48:51], v[232:239], v2
    v_smfmac_f32_16x16x64_bf16 v[24:27], v[52:55], v[240:247], v2
    v_smfmac_f32_16x16x64_bf16 v[24:27], v[56:59], v[248:255], v2
    s_nop 4
    v_cvt_pk_bf16_f32 v20, v20, v21
    v_cvt_pk_bf16_f32 v21, v22, v23
    v_bfi_b32 v20, 1, s44, v20
    buffer_store_dwordx2 v[20:21], v3, s[8:11], s24 offen offset:1024
    s_waitcnt lgkmcnt(0)
    v_smfmac_f32_16x16x64_bf16 v[24:27], v[60:63], v[40:47], v2
    s_nop 7
    v_cvt_pk_bf16_f32 v24, v24, v25
    v_cvt_pk_bf16_f32 v25, v26, v27
    v_bfi_b32 v24, 1, s44, v24
    buffer_store_dwordx2 v[24:25], v3, s[8:11], s24 offen offset:3072
    s_cmp_eq_u32 s34, 0
    s_cbranch_scc1 L_noredf
    buffer_store_dword v0, v5, s[8:11], s31 offen
    s_cmp_eq_u32 s45, 0
    s_cbranch_scc1 L_rdelf_x
    s_mov_b32 s22, s45
L_rdelf:
    s_sub_u32 s22, s22, 1
    s_cmp_gt_i32 s22, 0
    s_cbranch_scc1 L_rdelf
L_rdelf_x:
    buffer_load_dwordx4 v[20:23], v4, s[8:11], s25 offen sc1
    buffer_load_dwordx4 v[24:27], v4, s[8:11], s26 offen sc1
    buffer_load_dwordx4 v[28:31], v4, s[8:11], s27 offen sc1
    buffer_load_dwordx4 v[40:43], v4, s[8:11], s28 offen sc1
    v_cndmask_b32 v48, 0, v16, s[64:65]
    v_cndmask_b32 v49, 0, v16, s[66:67]
    v_cndmask_b32 v50, 0, v16, s[68:69]
    v_cndmask_b32 v51, 0, v16, s[70:71]
    v_permlane32_swap_b32 v64, v68
    v_permlane32_swap_b32 v65, v69
    v_permlane32_swap_b32 v66, v70
    v_permlane32_swap_b32 v67, v71
    v_pk_add_f32 v[64:65], v[64:65], v[68:69]
    v_pk_add_f32 v[66:67], v[66:67], v[70:71]
    v_cvt_pk_bf16_f32 v18, v64, v65
    v_cvt_pk_bf16_f32 v19, v66, v67
    s_mov_b32 s74, s33
    s_add_u32 s32, s32, 262144
    s_add_u32 s72, s72, 262144
    s_add_u32 s33, s33, 65536
    s_add_u32 s73, s73, 65536
    s_add_u32 s87, s30, s57
    s_add_u32 s88, s87, 4096
    s_add_u32 s89, s30, 8192
    s_add_u32 s20, s18, 3
    s_and_b32 s20, s20, 3
    s_mul_i32 s20, s20, 9216
    s_add_u32 s29, s20, 0x100000
    s_add_u32 s18, s18, 1
    buffer_load_dwordx4 v[20:23], v4, s[8:11], s25 offen sc1
    buffer_load_dwordx4 v[24:27], v4, s[8:11], s26 offen sc1
    buffer_load_dwordx4 v[28:31], v4, s[8:11], s27 offen sc1
    buffer_load_dwordx4 v[40:43], v4, s[8:11], s28 offen sc1
    s_mov_b32 s35, s58
    s_cmp_eq_u32 s44, 0
    s_cbranch_scc0 L_redf_poll1
L_redf_poll0:
    s_waitcnt vmcnt(4)
    v_or3_b32 v52, v20, v22, v24
    v_or3_b32 v53, v26, v28, v30
    v_or3_b32 v52, v52, v40, v42
    v_or_b32 v52, v52, v53
    v_and_b32 v52, 1, v52
    v_cmp_ne_u32 vcc, s44, v52
    s_cbranch_vccz L_redf_done
    buffer_load_dwordx4 v[20:23], v4, s[8:11], s25 offen sc1
    buffer_load_dwordx4 v[24:27], v4, s[8:11], s26 offen sc1
    buffer_load_dwordx4 v[28:31], v4, s[8:11], s27 offen sc1
    buffer_load_dwordx4 v[40:43], v4, s[8:11], s28 offen sc1
    s_sub_u32 s35, s35, 1
    s_cmp_lg_u32 s35, 0
    s_cbranch_scc1 L_redf_poll0
    s_or_b32 s39, s39, 1
    s_mov_b32 s58, 1
    s_branch L_redf_done
L_redf_poll1:
    s_waitcnt vmcnt(4)
    v_and_b32 v52, v20, v22
    v_and_b32 v53, v24, v26
    v_and_b32 v54, v28, v30
    v_and_b32 v55, v40, v42
    v_and_b32 v52, v52, v53
    v_and_b32 v54, v54, v55
    v_and_b32 v52, v52, v54
    v_and_b32 v52, 1, v52
    v_cmp_ne_u32 vcc, s44, v52
    s_cbranch_vccz L_redf_done
    buffer_load_dwordx4 v[20:23], v4, s[8:11], s25 offen sc1
    buffer_load_dwordx4 v[24:27], v4, s[8:11], s26 offen sc1
    buffer_load_dwordx4 v[28:31], v4, s[8:11], s27 offen sc1
    buffer_load_dwordx4 v[40:43], v4, s[8:11], s28 offen sc1
    s_sub_u32 s35, s35, 1
    s_cmp_lg_u32 s35, 0
    s_cbranch_scc1 L_redf_poll1
    s_or_b32 s39, s39, 1
    s_mov_b32 s58, 1
    s_branch L_redf_done
L_redf_done:
    v_mfma_f32_16x16x32_bf16 v[44:47], v[20:23], v[48:51], 0
    v_mfma_f32_16x16x32_bf16 v[44:47], v[24:27], v[48:51], v[44:47]
    v_mfma_f32_16x16x32_bf16 v[44:47], v[28:31], v[48:51], v[44:47]
    v_mfma_f32_16x16x32_bf16 v[44:47], v[40:43], v[48:51], v[44:47]
    s_nop 7
    v_permlane32_swap_b32 v44, v45
    v_permlane32_swap_b32 v46, v47
    v_add_f32 v44, v44, v45
    v_add_f32 v46, v46, v47
    v_cvt_pk_bf16_f32 v44, v44, v46
    buffer_store_dword v44, v5, s[8:11], s30 offen
    s_mov_b32 s21, 5
    s_branch L_redf_done2
L_noredf:
    v_permlane32_swap_b32 v64, v68
    v_permlane32_swap_b32 v65, v69
    v_permlane32_swap_b32 v66, v70
    v_permlane32_swap_b32 v67, v71
    v_pk_add_f32 v[64:65], v[64:65], v[68:69]
    v_pk_add_f32 v[66:67], v[66:67], v[70:71]
    v_cvt_pk_bf16_f32 v18, v64, v65
    v_cvt_pk_bf16_f32 v19, v66, v67
    s_mov_b32 s74, s33
    s_add_u32 s32, s32, 262144
    s_add_u32 s72, s72, 262144
    s_add_u32 s33, s33, 65536
    s_add_u32 s73, s73, 65536
    s_add_u32 s87, s30, s57
    s_add_u32 s88, s87, 4096
    s_add_u32 s89, s30, 8192
    s_add_u32 s20, s18, 3
    s_and_b32 s20, s20, 3
    s_mul_i32 s20, s20, 9216
    s_add_u32 s29, s20, 0x100000
    s_add_u32 s18, s18, 1
    s_and_b32 s19, s18, 7
    s_or_b32 s19, s19, s17
    s_cmp_eq_u32 s19, 0
    s_cbranch_scc0 L_kvw_25
    s_lshl_b32 s22, s18, 4
    s_add_u32 s22, s22, 0x200480
    s_mov_b32 s35, s3
L_pg_26:
    s_mov_b64 exec, 1
    buffer_load_dword v22, off, s[8:11], s22 sc1
    s_waitcnt vmcnt(0)
    s_nop 0
    v_readfirstlane_b32 s19, v22
    s_mov_b64 exec, -1
    s_cmp_ge_u32 s19, 128
    s_cbranch_scc1 L_pg_26_d
    s_sub_u32 s35, s35, 1
    s_cmp_lg_u32 s35, 0
    s_cbranch_scc1 L_pg_26
    s_mov_b32 s3, 1
L_pg_26_d:
L_kvw_25:
    s_mov_b32 s21, 27
L_redf_done2:
    v_add_u32 v56, s57, v1
    s_cmp_eq_u32 s21, 0
    s_cbranch_scc1 L_gdelf_x
    s_mov_b32 s22, s21
L_gdelf:
    s_sub_u32 s22, s22, 1
    s_cmp_gt_i32 s22, 0
    s_cbranch_scc1 L_gdelf
L_gdelf_x:
    s_cmp_eq_u32 s17, 0
    s_cbranch_scc1 L_gatf0
    buffer_load_dwordx4 v[72:75], v1, s[8:11], s87 offen sc1
    buffer_load_dwordx4 v[76:79], v1, s[8:11], s88 offen sc1
    s_xor_b32 s44, s44, 1
    s_mov_b32 s30, s31
    s_mov_b32 s31, s29
    s_mov_b32 s35, s58
    v_mov_b64 v[48:49], 0
    v_mov_b64 v[50:51], 0
    v_mov_b64 v[52:53], 0
    v_mov_b64 v[54:55], 0
    v_mov_b64 v[60:61], 0
    v_mov_b64 v[62:63], 0
    v_mov_b64 v[64:65], 0
    v_mov_b64 v[66:67], 0
    ds_read_b128 v[32:35], v12 offset:0
    ds_read_b128 v[36:39], v12 offset:1024
L_gatf_poll:
    s_waitcnt vmcnt(0)
    v_max3_u32 v57, v72, v73, v74
    v_max3_u32 v58, v75, v76, v77
    v_max3_u32 v57, v57, v78, v79
    v_max_u32 v57, v57, v58
    v_cmp_eq_u32 vcc, -1, v57
    s_cbranch_vccz L_gatf_ok
    buffer_load_dwordx4 v[72:75], v1, s[8:11], s87 offen sc1
    buffer_load_dwordx4 v[76:79], v1, s[8:11], s88 offen sc1
    s_sub_u32 s35, s35, 1
    s_cmp_lg_u32 s35, 0
    s_cbranch_scc1 L_gatf_poll
    s_or_b32 s39, s39, 2
    s_mov_b32 s58, 1
L_gatf_ok:
    ds_write_b128 v56, v[72:75] offset:0
    ds_write_b128 v56, v[76:79] offset:4096
    ds_read_b128 v[40:43], v12 offset:2048
    ds_read_b128 v[44:47], v12 offset:3072
    v_mov_b64 v[56:57], 0
    v_mov_b64 v[58:59], 0
    s_branch L_gatf_w
L_gatf0:
    buffer_load_dwordx4 v[72:75], v1, s[8:11], s87 offen sc1
    buffer_load_dwordx4 v[76:79], v1, s[8:11], s88 offen sc1
    buffer_load_dwordx4 v[68:71], v1, s[8:11], s89 offen sc1
    s_xor_b32 s44, s44, 1
    s_mov_b32 s30, s31
    s_mov_b32 s31, s29
    s_mov_b32 s35, s58
    v_mov_b64 v[48:49], 0
    v_mov_b64 v[50:51], 0
    v_mov_b64 v[52:53], 0
    v_mov_b64 v[54:55], 0
    v_mov_b64 v[60:61], 0
    v_mov_b64 v[62:63], 0
    v_mov_b64 v[64:65], 0
    v_mov_b64 v[66:67], 0
    ds_read_b128 v[32:35], v12 offset:0
    ds_read_b128 v[36:39], v12 offset:1024
L_gatf0_poll:
    s_waitcnt vmcnt(0)
    v_max3_u32 v57, v72, v73, v74
    v_max3_u32 v58, v75, v76, v77
    v_max3_u32 v57, v57, v78, v79
    v_max3_u32 v58, v58, v68, v69
    v_max3_u32 v57, v57, v70, v71
    v_max_u32 v57, v57, v58
    v_cmp_eq_u32 vcc, -1, v57
    s_cbranch_vccz L_gatf0_ok
    buffer_load_dwordx4 v[72:75], v1, s[8:11], s87 offen sc1
    buffer_load_dwordx4 v[76:79], v1, s[8:11], s88 offen sc1
    buffer_load_dwordx4 v[68:71], v1, s[8:11], s89 offen sc1
    s_sub_u32 s35, s35, 1
    s_cmp_lg_u32 s35, 0
    s_cbranch_scc1 L_gatf0_poll
    s_or_b32 s39, s39, 2
    s_mov_b32 s58, 1
L_gatf0_ok:
    ds_write_b128 v56, v[72:75] offset:0
    ds_write_b128 v56, v[76:79] offset:4096
    ds_write_b128 v1, v[68:71] offset:8192
    ds_read_b128 v[40:43], v12 offset:2048
    ds_read_b128 v[44:47], v12 offset:3072
    v_mov_b64 v[56:57], 0
    v_mov_b64 v[58:59], 0
L_gatf_w:
    s_waitcnt lgkmcnt(2)
    s_barrier
    s_branch L_chain_loopf
L_chain_lastf:
    s_mov_b64 exec, s[36:37]
    buffer_store_dwordx4 v[56:59], v6, s[8:11], s73 offen sc1
    s_mov_b64 exec, -1
    buffer_store_dwordx2 v[18:19], v13, s[8:11], s74 offen sc1
    v_smfmac_f32_16x16x64_bf16 v[64:67], v[20:23], a[224:231], v2
    ds_read_b128 v[28:31], v1 offset:4096
    v_smfmac_f32_16x16x64_bf16 v[68:71], v[20:23], a[232:239], v2
    s_waitcnt lgkmcnt(1)
    v_smfmac_f32_16x16x64_bf16 v[64:67], v[24:27], a[240:247], v2
    ds_read_b128 v[20:23], v1 offset:5120
    v_smfmac_f32_16x16x64_bf16 v[68:71], v[24:27], a[248:255], v2
    s_waitcnt lgkmcnt(1)
    v_smfmac_f32_16x16x64_bf16 v[64:67], v[28:31], v[80:87], v2
    ds_read_b128 v[24:27], v1 offset:7168
    v_smfmac_f32_16x16x64_bf16 v[68:71], v[28:31], v[88:95], v2
    s_waitcnt lgkmcnt(1)
    v_smfmac_f32_16x16x64_bf16 v[64:67], v[20:23], v[96:103], v2
    ds_read_b128 v[28:31], v1 offset:8192
    v_smfmac_f32_16x16x64_bf16 v[68:71], v[20:23], v[104:111], v2
    s_waitcnt lgkmcnt(1)
    v_smfmac_f32_16x16x64_bf16 v[64:67], v[24:27], v[112:119], v2
    v_smfmac_f32_16x16x64_bf16 v[68:71], v[24:27], v[120:127], v2
    s_waitcnt lgkmcnt(0)
    v_smfmac_f32_16x16x64_bf16 v[64:67], v[28:31], v[128:135], v2
    v_smfmac_f32_16x16x64_bf16 v[68:71], v[28:31], v[136:143], v2
    s_nop 7
    v_permlane32_swap_b32 v64, v68
    v_permlane32_swap_b32 v65, v69
    v_permlane32_swap_b32 v66, v70
    v_permlane32_swap_b32 v67, v71
    v_pk_add_f32 v[64:65], v[64:65], v[68:69]
    v_pk_add_f32 v[66:67], v[66:67], v[70:71]
    v_cvt_pk_bf16_f32 v64, v64, v65
    v_cvt_pk_bf16_f32 v65, v66, v67
    buffer_store_dwordx2 v[64:65], v13, s[8:11], s33 offen sc1
    s_branch L_chain_donef
L_chain_donef:
    s_waitcnt vmcnt(0)
    s_barrier
    s_cmp_eq_u32 s17, 0
    s_cbranch_scc0 L_cdn_f
    v_mov_b32 v20, 64
    s_mov_b64 exec, 1
    buffer_store_dword v20, off, s[8:11], s86 sc1
    s_mov_b64 exec, -1
L_cdn_f:
    s_cmp_eq_u32 s39, 0
    s_cbranch_scc1 L_cd_f
    s_mov_b32 s21, 0x204500
    v_mov_b32 v21, s39
    buffer_atomic_or v21, off, s[8:11], s21
L_cd_f:
    s_waitcnt vmcnt(0)
    s_branch L_end
L_chain_slow:
    s_cmp_eq_u32 s17, 0
    s_cbranch_scc0 L_ld_27
    s_mov_b32 s20, 0x204580
    v_mov_b32 v61, 1
    s_mov_b64 exec, 1
    buffer_atomic_add v61, off, s[8:11], s20
    s_mov_b64 exec, -1
    s_mov_b32 s20, 0x204480
    buffer_load_dword v78, off, s[8:11], s20 sc1
    s_mov_b32 s20, 0x200480
    buffer_load_dword v79, off, s[8:11], s20 sc1
L_ld_27:
    v_and_b32 v20, 15, v0
    v_lshrrev_b32 v21, 4, v0
    v_lshlrev_b32 v1, 4, v0
    v_mov_b32 v2, 0x44444444
    v_mov_b32 v22, 0xeeeeeeee
    v_cmp_lt_u32 vcc, 7, v20
    s_nop 1
    v_cndmask_b32 v2, v2, v22, vcc
    v_lshrrev_b32 v25, 3, v20
    v_and_b32 v26, 7, v20
    v_lshl_add_u32 v22, v21, 3, v26
    v_lshlrev_b32 v6, 4, v22
    v_lshrrev_b32 v22, 1, v21
    v_lshl_add_u32 v22, v22, 6, v20
    s_lshl_b32 s19, s17, 4
    v_add_u32 v22, s19, v22
    v_lshlrev_b32 v22, 4, v22
    v_and_b32 v23, 1, v21
    v_lshl_add_u32 v3, v23, 3, v22
    v_lshlrev_b32 v22, 4, v20
    v_lshl_add_u32 v22, v21, 2, v22
    s_lshl_b32 s19, s17, 8
    v_add_u32 v17, s19, v22
    s_sub_u32 s19, s17, 1
    s_lshl_b32 s19, s19, 5
    s_add_u32 s19, s19, s16
    s_cmp_lt_u32 s19, 72
    s_cselect_b32 s34, 1, 0
    s_cmp_eq_u32 s17, 0
    s_cselect_b32 s34, 0, s34
    s_cmp_eq_u32 s34, 0
    s_cselect_b32 s19, 0, s19
    s_lshr_b32 s20, s19, 3
    s_mul_i32 s45, s20, 1
    s_add_u32 s45, s45, 1
    s_lshl_b32 s21, s19, 7
    v_lshl_add_u32 v22, v21, 1, v25
    s_movk_i32 s20, 9216
    v_mul_lo_u32 v22, v22, s20
    v_lshl_add_u32 v22, v26, 4, v22
    v_add_u32 v4, s21, v22
    v_lshlrev_b32 v22, 1, v20
    v_and_b32 v22, 7, v22
    v_bfe_u32 v23, v20, 2, 1
    v_add_u32 v22, v22, v23
    s_cmp_lt_u32 s19, 8
    s_cselect_b64 vcc, -1, 0
    v_cndmask_b32 v22, v20, v22, vcc
    v_lshlrev_b32 v22, 4, v22
    v_lshl_add_u32 v22, v21, 2, v22
    v_add_u32 v22, s21, v22
    v_mov_b32 v23, 0x40000000
    v_cmp_lt_u32 vcc, 7, v20
    s_nop 1
    v_cndmask_b32 v22, v22, v23, vcc
    s_cmp_eq_u32 s34, 0
    s_cselect_b64 vcc, -1, 0
    v_cndmask_b32 v5, v22, v23, vcc
    s_mul_i32 s19, s17, 1280
    s_add_u32 s19, s19, 9216
    v_add_u32 v7, s19, v6
    v_lshl_add_u32 v22, v25, 9, v6
    v_add_u32 v8, 9216, v22
    v_and_b32 v22, 1, v21
    v_lshl_add_u32 v22, v22, 3, v26
    v_lshlrev_b32 v22, 4, v22
    s_movk_i32 s20, 2560
    v_mul_lo_u32 v23, v25, s20
    v_add_u32 v22, v22, v23
    v_add_u32 v9, 10240, v22
    v_lshl_add_u32 v27, v25, 4, v26
    s_lshl_b32 s19, s17, 2
    v_add_u32 v22, s19, v21
    v_lshl_add_u32 v22, v22, 5, v27
    v_lshlrev_b32 v10, 4, v22
    s_lshl_b32 s19, s17, 5
    v_lshl_add_u32 v22, v21, 7, v27
    v_add_u32 v22, s19, v22
    v_lshlrev_b32 v11, 4, v22
    v_lshrrev_b32 v22, 1, v21
    v_lshl_add_u32 v22, v22, 3, v27
    v_add_u32 v22, s19, v22
    v_lshlrev_b32 v22, 4, v22
    v_and_b32 v23, 1, v21
    v_lshl_add_u32 v13, v23, 3, v22
    s_mul_i32 s19, s17, 36864
    s_add_u32 s19, s19, 16384
    v_add_u32 v12, s19, v1
    v_and_b32 v22, 3, v20
    v_lshrrev_b32 v23, 2, v26
    v_and_b32 v24, 1, v21
    v_cmp_eq_u32 s[40:41], v23, v24
    v_and_b32 v23, 1, v22
    v_lshlrev_b32 v23, 4, v23
    v_mov_b32 v28, 0x3f80
    v_lshlrev_b32 v16, v23, v28
    v_cndmask_b32 v29, 0, v16, s[40:41]
    v_cmp_gt_u32 vcc, 2, v22
    s_nop 1
    v_cndmask_b32 v14, 0, v29, vcc
    v_cmp_lt_u32 vcc, 1, v22
    s_nop 1
    v_cndmask_b32 v15, 0, v29, vcc
    v_lshrrev_b32 v23, 1, v20
    v_cmp_eq_u32 s[64:65], 0, v23
    v_cmp_eq_u32 s[66:67], 1, v23
    v_cmp_eq_u32 s[68:69], 2, v23
    v_cmp_eq_u32 s[70:71], 3, v23
    s_mov_b32 s36, 0x00ff00ff
    s_mov_b32 s37, 0x00ff00ff
    s_mov_b32 s60, 0x00ff00ff
    s_mov_b32 s61, 0
    s_mov_b32 s38, 0x3e0293ee
    s_lshl_b32 s56, s17, 9
    s_add_u32 s56, s56, 14336
    s_lshl_b32 s57, s17, 10
    s_mov_b32 s39, 0
    s_mov_b32 s58, 20000
    s_mul_i32 s23, s16, 9216
    s_add_u32 s23, s23, 0x0
    s_add_u32 s24, s23, 4096
    s_mov_b32 s25, 0x0
    s_mov_b32 s26, 0x12000
    s_mov_b32 s27, 0x24000
    s_mov_b32 s28, 0x36000
    s_mov_b32 s30, 0x102400
    s_mov_b32 s31, 0x104800
    s_lshl_b32 s32, s16, 13
    s_add_u32 s72, s32, 0x2000000
    s_add_u32 s32, s32, 0x1000000
    s_lshl_b32 s33, s16, 11
    s_lshl_b32 s20, s17, 9
    s_add_u32 s73, s33, s20
    s_add_u32 s73, s73, 0x6c00000
    s_add_u32 s33, s33, 0x7000000
    s_mov_b32 s18, 0
    s_mov_b32 s44, 0
    s_mov_b32 s74, 0x40000000
    v_mov_b64 v[18:19], 0
    s_mov_b32 s84, 0
    s_mov_b32 s85, 0
    v_mov_b32 v0, -1
    s_lshl_b32 s86, s16, 7
    s_add_u32 s86, s86, 0x201480
    s_cmp_eq_u32 s17, 0
    s_cselect_b32 s59, s86, 0x40000000
    s_cmp_eq_u32 s17, 0
    s_cbranch_scc0 L_cb_s_wait
    s_waitcnt vmcnt(0)
    v_readfirstlane_b32 s19, v78
    v_readfirstlane_b32 s20, v79
    s_cmp_ge_u32 s19, 32
    s_cselect_b32 s19, 1, 0
    s_cmp_ge_u32 s20, 128
    s_cselect_b32 s19, s19, 0
    s_cmp_eq_u32 s19, 1
    s_cbranch_scc1 L_cb_s_wait
    s_mov_b32 s21, 0x204480
    s_mov_b32 s35, s3
L_pg_28:
    s_mov_b64 exec, 1
    buffer_load_dword v22, off, s[8:11], s21 sc1
    s_waitcnt vmcnt(0)
    s_nop 0
    v_readfirstlane_b32 s19, v22
    s_mov_b64 exec, -1
    s_cmp_ge_u32 s19, 32
    s_cbranch_scc1 L_pg_28_d
    s_sleep 2
    s_sub_u32 s35, s35, 1
    s_cmp_lg_u32 s35, 0
    s_cbranch_scc1 L_pg_28
    s_mov_b32 s3, 1
L_pg_28_d:
    s_mov_b32 s21, 0x200480
    s_mov_b32 s35, s3
L_pg_29:
    s_mov_b64 exec, 1
    buffer_load_dword v22, off, s[8:11], s21 sc1
    s_waitcnt vmcnt(0)
    s_nop 0
    v_readfirstlane_b32 s19, v22
    s_mov_b64 exec, -1
    s_cmp_ge_u32 s19, 128
    s_cbranch_scc1 L_pg_29_d
    s_sleep 2
    s_sub_u32 s35, s35, 1
    s_cmp_lg_u32 s35, 0
    s_cbranch_scc1 L_pg_29
    s_mov_b32 s3, 1
L_pg_29_d:
L_cb_s_wait:
    v_mov_b64 v[48:49], 0
    v_mov_b64 v[50:51], 0
    v_mov_b64 v[52:53], 0
    v_mov_b64 v[54:55], 0
    v_mov_b64 v[56:57], 0
    v_mov_b64 v[58:59], 0
    v_mov_b64 v[60:61], 0
    v_mov_b64 v[62:63], 0
    v_mov_b64 v[64:65], 0
    v_mov_b64 v[66:67], 0
    v_mov_b64 v[68:69], 0
    v_mov_b64 v[70:71], 0
    ds_read_b128 v[32:35], v12 offset:0
    ds_read_b128 v[36:39], v12 offset:1024
    ds_read_b128 v[40:43], v12 offset:2048
    ds_read_b128 v[44:47], v12 offset:3072
    s_waitcnt vmcnt(0) lgkmcnt(0)
    s_barrier
    .p2align 6
L_chain_loops:
    ds_read_b128 v[20:23], v1 offset:0
    ds_read_b128 v[24:27], v1 offset:1024
    buffer_load_dwordx4 v[72:75], v10, s[8:11], s32 offen
    buffer_load_dwordx4 v[76:79], v10, s[8:11], s32 offen offset:128
    ds_read_b128 v[28:31], v1 offset:2048
    s_waitcnt lgkmcnt(2)
    v_smfmac_f32_16x16x64_bf16 v[48:51], v[20:23], a[0:7], v2
    v_smfmac_f32_16x16x64_bf16 v[52:55], v[20:23], a[8:15], v2
    v_smfmac_f32_16x16x64_bf16 v[56:59], v[20:23], v[32:39], v2
    v_smfmac_f32_16x16x64_bf16 v[60:63], v[20:23], v[40:47], v2
    ds_read_b128 v[20:23], v1 offset:3072
    s_waitcnt lgkmcnt(2)
    v_smfmac_f32_16x16x64_bf16 v[48:51], v[24:27], a[16:23], v2
    v_smfmac_f32_16x16x64_bf16 v[52:55], v[24:27], a[24:31], v2
    ds_read_b128 v[32:35], v12 offset:4096
    ds_read_b128 v[36:39], v12 offset:5120
    v_smfmac_f32_16x16x64_bf16 v[56:59], v[24:27], a[144:151], v2
    ds_read_b128 v[40:43], v12 offset:6144
    ds_read_b128 v[44:47], v12 offset:7168
    v_smfmac_f32_16x16x64_bf16 v[60:63], v[24:27], a[152:159], v2
    ds_read_b128 v[24:27], v1 offset:4096
    s_waitcnt lgkmcnt(6)
    v_smfmac_f32_16x16x64_bf16 v[48:51], v[28:31], a[32:39], v2
    v_smfmac_f32_16x16x64_bf16 v[52:55], v[28:31], a[40:47], v2
    s_waitcnt lgkmcnt(3)
    v_smfmac_f32_16x16x64_bf16 v[56:59], v[28:31], v[32:39], v2
    s_waitcnt lgkmcnt(1)
    v_smfmac_f32_16x16x64_bf16 v[60:63], v[28:31], v[40:47], v2
    ds_read_b128 v[28:31], v1 offset:5120
    v_smfmac_f32_16x16x64_bf16 v[48:51], v[20:23], a[48:55], v2
    v_smfmac_f32_16x16x64_bf16 v[52:55], v[20:23], a[56:63], v2
    ds_read_b128 v[32:35], v12 offset:8192
    ds_read_b128 v[36:39], v12 offset:9216
    v_smfmac_f32_16x16x64_bf16 v[56:59], v[20:23], a[160:167], v2
    ds_read_b128 v[40:43], v12 offset:10240
    ds_read_b128 v[44:47], v12 offset:11264
    v_smfmac_f32_16x16x64_bf16 v[60:63], v[20:23], a[168:175], v2
    ds_read_b128 v[20:23], v1 offset:6144
    s_waitcnt lgkmcnt(6)
    v_smfmac_f32_16x16x64_bf16 v[48:51], v[24:27], a[64:71], v2
    v_smfmac_f32_16x16x64_bf16 v[52:55], v[24:27], a[72:79], v2
    s_waitcnt lgkmcnt(3)
    v_smfmac_f32_16x16x64_bf16 v[56:59], v[24:27], v[32:39], v2
    s_waitcnt lgkmcnt(1)
    v_smfmac_f32_16x16x64_bf16 v[60:63], v[24:27], v[40:47], v2
    ds_read_b128 v[24:27], v1 offset:7168
    v_smfmac_f32_16x16x64_bf16 v[48:51], v[28:31], a[80:87], v2
    v_smfmac_f32_16x16x64_bf16 v[52:55], v[28:31], a[88:95], v2
    ds_read_b128 v[32:35], v12 offset:12288
    ds_read_b128 v[36:39], v12 offset:13312
    v_smfmac_f32_16x16x64_bf16 v[56:59], v[28:31], a[176:183], v2
    ds_read_b128 v[40:43], v12 offset:14336
    ds_read_b128 v[44:47], v12 offset:15360
    v_smfmac_f32_16x16x64_bf16 v[60:63], v[28:31], a[184:191], v2
    ds_read_b128 v[28:31], v1 offset:8192
    s_waitcnt lgkmcnt(6)
    v_smfmac_f32_16x16x64_bf16 v[48:51], v[20:23], a[96:103], v2
    v_mov_b64 v[68:69], 0
    v_smfmac_f32_16x16x64_bf16 v[52:55], v[20:23], a[104:111], v2
    v_mov_b64 v[70:71], 0
    s_waitcnt lgkmcnt(3)
    v_smfmac_f32_16x16x64_bf16 v[56:59], v[20:23], v[32:39], v2
    s_waitcnt lgkmcnt(1)
    v_smfmac_f32_16x16x64_bf16 v[60:63], v[20:23], v[40:47], v2
    v_smfmac_f32_16x16x64_bf16 v[48:51], v[24:27], a[112:119], v2
    v_smfmac_f32_16x16x64_bf16 v[52:55], v[24:27], a[120:127], v2
    ds_read_b128 v[32:35], v12 offset:16384
    ds_read_b128 v[36:39], v12 offset:17408
    v_smfmac_f32_16x16x64_bf16 v[56:59], v[24:27], a[192:199], v2
    ds_read_b128 v[40:43], v12 offset:18432
    ds_read_b128 v[44:47], v12 offset:19456
    v_smfmac_f32_16x16x64_bf16 v[60:63], v[24:27], a[200:207], v2
    s_waitcnt lgkmcnt(4)
    v_smfmac_f32_16x16x64_bf16 v[48:51], v[28:31], a[128:135], v2
    v_smfmac_f32_16x16x64_bf16 v[52:55], v[28:31], a[136:143], v2
    ds_read_b128 v[20:23], v1 offset:2048
    ds_read_b128 v[24:27], v1 offset:6144
    s_waitcnt lgkmcnt(4)
    v_smfmac_f32_16x16x64_bf16 v[56:59], v[28:31], v[32:39], v2
    ds_read_b128 v[32:35], v12 offset:20480
    ds_read_b128 v[36:39], v12 offset:21504
    s_waitcnt lgkmcnt(4)
    v_smfmac_f32_16x16x64_bf16 v[60:63], v[28:31], v[40:47], v2
    ds_read_b128 v[40:43], v12 offset:22528
    ds_read_b128 v[44:47], v12 offset:23552
    v_cvt_pk_bf16_f32 v48, v48, v49
    v_cvt_pk_bf16_f32 v49, v50, v51
    v_cvt_pk_bf16_f32 v52, v52, v53
    v_cvt_pk_bf16_f32 v53, v54, v55
    v_mfma_f32_16x16x16_bf16 v[48:51], v[48:49], v[14:15], 0
    s_nop 0
    v_mfma_f32_16x16x16_bf16 v[52:55], v[52:53], v[14:15], 0
    v_cvt_pk_bf16_f32 v56, v56, v57
    v_cvt_pk_bf16_f32 v57, v58, v59
    v_cvt_pk_bf16_f32 v60, v60, v61
    v_cvt_pk_bf16_f32 v61, v62, v63
    v_mfma_f32_16x16x16_bf16 v[56:59], v[56:57], v[14:15], 0
    s_nop 0
    v_mfma_f32_16x16x16_bf16 v[60:63], v[60:61], v[14:15], 0
    s_waitcnt lgkmcnt(2)
    v_smfmac_f32_16x16x64_bf16 v[64:67], v[20:23], v[32:39], v2
    ds_read_b128 v[32:35], v12 offset:24576
    ds_read_b128 v[36:39], v12 offset:25600
    v_cvt_pk_bf16_f32 v48, v48, v49
    v_cvt_pk_bf16_f32 v49, v50, v51
    v_cvt_pk_bf16_f32 v50, v52, v53
    v_cvt_pk_bf16_f32 v51, v54, v55
    s_waitcnt vmcnt(1)
    s_nop 0
    v_mfma_f32_16x16x32_bf16 v[52:55], v[72:75], v[48:51], 0
    s_waitcnt vmcnt(0)
    v_mfma_f32_16x16x32_bf16 v[76:79], v[76:79], v[48:51], 0
    v_cvt_pk_bf16_f32 v56, v56, v57
    v_cvt_pk_bf16_f32 v57, v58, v59
    v_cvt_pk_bf16_f32 v58, v60, v61
    v_cvt_pk_bf16_f32 v59, v62, v63
    s_waitcnt lgkmcnt(2)
    v_smfmac_f32_16x16x64_bf16 v[68:71], v[20:23], v[40:47], v2
    ds_read_b128 v[40:43], v12 offset:26624
    ds_read_b128 v[44:47], v12 offset:27648
    ds_read_b128 v[28:31], v1 offset:0
    v_mfma_f32_16x16x32_bf16 v[60:63], v[56:59], v[48:51], 0
    s_waitcnt lgkmcnt(3)
    v_smfmac_f32_16x16x64_bf16 v[64:67], v[24:27], v[32:39], v2
    ds_read_b128 v[20:23], v1 offset:1024
    s_mov_b64 exec, s[36:37]
    ds_write_b128 v7, v[52:55]
    ds_write_b128 v7, v[76:79] offset:512
    s_mov_b64 exec, -1
    buffer_load_dwordx4 v[72:75], v11, s[8:11], s72 offen
    s_mov_b64 exec, s[60:61]
    ds_write_b128 v7, v[60:63] offset:1024
    s_mov_b64 exec, -1
    buffer_load_dwordx4 v[76:79], v11, s[8:11], s72 offen offset:128
    s_waitcnt lgkmcnt(5)
    v_smfmac_f32_16x16x64_bf16 v[68:71], v[24:27], v[40:47], v2
    s_waitcnt lgkmcnt(4)
    v_smfmac_f32_16x16x64_bf16 v[64:67], v[28:31], a[208:215], v2
    ds_read_b128 v[24:27], v1 offset:3072
    v_smfmac_f32_16x16x64_bf16 v[68:71], v[28:31], a[216:223], v2
    s_waitcnt lgkmcnt(1)
    s_cmp_eq_u32 s18, 63
    s_cbranch_scc1 L_chain_lasts
    s_barrier
    ds_read_b128 v[48:51], v8 offset:0
    ds_read_b128 v[52:55], v8 offset:1280
    ds_read_b128 v[60:63], v8 offset:3840
    ds_read_b128 v[40:43], v9 offset:0
    ds_read_b128 v[44:47], v9 offset:1280
    s_mov_b64 exec, s[36:37]
    buffer_store_dwordx4 v[56:59], v6, s[8:11], s73 offen sc1
    s_mov_b64 exec, -1
    s_nop 3
    ds_read_b128 v[56:59], v8 offset:2560
    buffer_store_dwordx2 v[18:19], v13, s[8:11], s74 offen sc1
    v_smfmac_f32_16x16x64_bf16 v[64:67], v[20:23], a[224:231], v2
    ds_read_b128 v[28:31], v1 offset:4096
    v_smfmac_f32_16x16x64_bf16 v[68:71], v[20:23], a[232:239], v2
    s_sub_i32 s19, s18, 1
    s_max_i32 s19, s19, 0
    v_mov_b32 v18, s19
    s_mov_b64 exec, 1
    buffer_store_dword v18, off, s[8:11], s59 sc1
    s_mov_b64 exec, -1
    s_waitcnt lgkmcnt(7)
    v_smfmac_f32_16x16x64_bf16 v[64:67], v[24:27], a[240:247], v2
    ds_read_b128 v[20:23], v1 offset:5120
    v_smfmac_f32_16x16x64_bf16 v[68:71], v[24:27], a[248:255], v2
    s_waitcnt lgkmcnt(1)
    v_smfmac_f32_16x16x64_bf16 v[64:67], v[28:31], v[80:87], v2
    ds_read_b128 v[24:27], v1 offset:7168
    v_pk_add_f32 v[48:49], v[48:49], v[52:53]
    v_pk_add_f32 v[50:51], v[50:51], v[54:55]
    v_smfmac_f32_16x16x64_bf16 v[68:71], v[28:31], v[88:95], v2
    v_pk_add_f32 v[56:57], v[56:57], v[60:61]
    v_pk_add_f32 v[58:59], v[58:59], v[62:63]
    s_waitcnt lgkmcnt(1)
    v_smfmac_f32_16x16x64_bf16 v[64:67], v[20:23], v[96:103], v2
    ds_read_b128 v[28:31], v1 offset:8192
    v_pk_add_f32 v[40:41], v[40:41], v[44:45]
    v_pk_add_f32 v[42:43], v[42:43], v[46:47]
    v_smfmac_f32_16x16x64_bf16 v[68:71], v[20:23], v[104:111], v2
    v_pk_add_f32 v[48:49], v[48:49], v[56:57]
    v_pk_add_f32 v[50:51], v[50:51], v[58:59]
    v_add_f32_dpp v40, v40, v40 row_ror:8 row_mask:0xf bank_mask:0xf
    v_add_f32_dpp v41, v41, v41 row_ror:8 row_mask:0xf bank_mask:0xf
    v_add_f32_dpp v42, v42, v42 row_ror:8 row_mask:0xf bank_mask:0xf
    v_add_f32_dpp v43, v43, v43 row_ror:8 row_mask:0xf bank_mask:0xf
    v_max3_f32 v44, v48, v49, v50
    v_max3_f32 v44, v44, v51, v40
    v_max3_f32 v44, v44, v41, v42
    v_max_f32 v44, v44, v43
    s_waitcnt lgkmcnt(1)
    v_smfmac_f32_16x16x64_bf16 v[64:67], v[24:27], v[112:119], v2
    v_max_f32_dpp v44, v44, v44 row_ror:8 row_mask:0xf bank_mask:0xf
    v_mov_b32 v62, 0x3f803f80
    v_mov_b32 v45, v44
    v_smfmac_f32_16x16x64_bf16 v[68:71], v[24:27], v[120:127], v2
    s_waitcnt lgkmcnt(0)
    v_smfmac_f32_16x16x64_bf16 v[64:67], v[28:31], v[128:135], v2
    v_smfmac_f32_16x16x64_bf16 v[68:71], v[28:31], v[136:143], v2
    v_mov_b32 v63, 0x3f803f80
    v_permlane16_swap_b32 v44, v45
    v_max_f32 v44, v44, v45
    v_mov_b32 v45, v44
    v_mov_b32 v46, 0x3f003f00
    v_mov_b32 v47, 0x3f003f00
    v_permlane32_swap_b32 v44, v45
    v_max_f32 v44, v44, v45
    v_mul_f32 v44, s38, v44
    v_fma_f32 v48, v48, s38, -v44
    v_fma_f32 v49, v49, s38, -v44
    v_fma_f32 v50, v50, s38, -v44
    v_fma_f32 v51, v51, s38, -v44
    v_fma_f32 v40, v40, s38, -v44
    v_fma_f32 v41, v41, s38, -v44
    v_fma_f32 v42, v42, s38, -v44
    v_fma_f32 v43, v43, s38, -v44
    v_exp_f32 v48, v48
    v_exp_f32 v49, v49
    v_exp_f32 v50, v50
    v_exp_f32 v51, v51
    v_exp_f32 v40, v40
    v_exp_f32 v41, v41
    v_exp_f32 v42, v42
    v_exp_f32 v43, v43
    v_cvt_pk_bf16_f32 v56, v40, v41
    v_cvt_pk_bf16_f32 v57, v42, v43
    v_cvt_pk_bf16_f32 v52, v48, v49
    v_cvt_pk_bf16_f32 v53, v50, v51
    v_mfma_f32_16x16x16_bf16 v[28:31], v[46:47], v[56:57], 0
    v_mov_b32_dpp v54, v52 row_ror:8 row_mask:0xf bank_mask:0xf
    v_mov_b32_dpp v55, v53 row_ror:8 row_mask:0xf bank_mask:0xf
    v_mfma_f32_16x16x16_bf16 v[28:31], v[62:63], v[52:53], v[28:31]
    v_cvt_pk_bf16_f32 v58, v64, v65
    v_mfma_f32_16x16x16_bf16 v[28:31], v[62:63], v[54:55], v[28:31]
    v_cvt_pk_bf16_f32 v59, v66, v67
    s_waitcnt vmcnt(4)
    v_mfma_f32_16x16x32_bf16 v[20:23], v[72:75], v[52:55], 0
    v_cvt_pk_bf16_f32 v60, v68, v69
    s_waitcnt vmcnt(3)
    v_mfma_f32_16x16x32_bf16 v[24:27], v[76:79], v[52:55], 0
    v_cvt_pk_bf16_f32 v61, v70, v71
    v_mfma_f32_16x16x16_bf16 v[20:23], v[58:59], v[56:57], v[20:23]
    v_add_u32 v40, s56, v6
    v_mfma_f32_16x16x16_bf16 v[24:27], v[60:61], v[56:57], v[24:27]
    v_rcp_f32 v28, v28
    ds_read_b128 v[32:35], v12 offset:28672
    ds_read_b128 v[36:39], v12 offset:29696
    s_nop 2
    v_pk_mul_f32 v[20:21], v[20:21], v[28:29] op_sel_hi:[1,0]
    v_pk_mul_f32 v[22:23], v[22:23], v[28:29] op_sel_hi:[1,0]
    v_pk_mul_f32 v[24:25], v[24:25], v[28:29] op_sel_hi:[1,0]
    v_pk_mul_f32 v[26:27], v[26:27], v[28:29] op_sel_hi:[1,0]
    v_cvt_pk_bf16_f32 v60, v20, v21
    v_cvt_pk_bf16_f32 v61, v22, v23
    v_cvt_pk_bf16_f32 v62, v24, v25
    v_cvt_pk_bf16_f32 v63, v26, v27
    s_mov_b64 exec, s[36:37]
    ds_write_b128 v40, v[60:63]
    s_mov_b64 exec, -1
    v_mov_b64 v[72:73], 0
    v_mov_b64 v[74:75], 0
    v_mov_b64 v[76:77], 0
    v_mov_b64 v[78:79], 0
    v_mov_b64 v[28:29], 0
    v_mov_b64 v[30:31], 0
    ds_read_b128 v[40:43], v12 offset:30720
    ds_read_b128 v[44:47], v12 offset:31744
    s_waitcnt lgkmcnt(2)
    s_barrier
    ds_read_b128 v[20:23], v8 offset:5120
    ds_read_b128 v[24:27], v8 offset:6144
    ds_read_b128 v[48:51], v6 offset:14336
    ds_read_b128 v[52:55], v6 offset:14848
    ds_read_b128 v[56:59], v6 offset:15360
    ds_read_b128 v[60:63], v6 offset:15872
    s_waitcnt lgkmcnt(5)
    v_smfmac_f32_16x16x64_bf16 v[28:31], v[20:23], v[144:151], v2
    s_waitcnt lgkmcnt(4)
    v_smfmac_f32_16x16x64_bf16 v[28:31], v[24:27], v[152:159], v2
    s_waitcnt lgkmcnt(3)
    v_smfmac_f32_16x16x64_bf16 v[72:75], v[48:51], v[160:167], v2
    v_mov_b64 v[20:21], 0
    v_mov_b64 v[22:23], 0
    s_waitcnt lgkmcnt(2)
    v_smfmac_f32_16x16x64_bf16 v[72:75], v[52:55], v[168:175], v2
    v_mov_b64 v[24:25], 0
    v_mov_b64 v[26:27], 0
    s_waitcnt lgkmcnt(1)
    v_smfmac_f32_16x16x64_bf16 v[72:75], v[56:59], v[176:183], v2
    v_permlane32_swap_b32 v28, v29
    s_waitcnt lgkmcnt(0)
    v_smfmac_f32_16x16x64_bf16 v[72:75], v[60:63], v[32:39], v2
    ds_read_b128 v[32:35], v12 offset:32768
    ds_read_b128 v[36:39], v12 offset:33792
    v_permlane32_swap_b32 v30, v31
    v_smfmac_f32_16x16x64_bf16 v[76:79], v[48:51], v[184:191], v2
    v_add_f32 v28, v28, v29
    v_add_f32 v30, v30, v31
    v_smfmac_f32_16x16x64_bf16 v[76:79], v[52:55], v[192:199], v2
    v_cvt_pk_bf16_f32 v28, v28, v30
    v_bfi_b32 v28, 1, s44, v28
    buffer_store_dword v28, v17, s[8:11], s23 offen sc1
    v_smfmac_f32_16x16x64_bf16 v[76:79], v[56:59], v[200:207], v2
    v_cvt_pk_bf16_f32 v72, v72, v73
    v_cvt_pk_bf16_f32 v73, v74, v75
    v_bfi_b32 v72, 1, s44, v72
    buffer_store_dwordx2 v[72:73], v3, s[8:11], s23 offen offset:1024 sc1
    v_smfmac_f32_16x16x64_bf16 v[76:79], v[60:63], v[40:47], v2
    ds_read_b128 v[40:43], v12 offset:34816
    ds_read_b128 v[44:47], v12 offset:35840
    v_smfmac_f32_16x16x64_bf16 v[20:23], v[48:51], v[208:215], v2
    v_smfmac_f32_16x16x64_bf16 v[20:23], v[52:55], v[216:223], v2
    v_smfmac_f32_16x16x64_bf16 v[20:23], v[56:59], v[224:231], v2
    s_nop 2
    v_cvt_pk_bf16_f32 v76, v76, v77
    v_cvt_pk_bf16_f32 v77, v78, v79
    v_bfi_b32 v76, 1, s44, v76
    buffer_store_dwordx2 v[76:77], v3, s[8:11], s23 offen offset:3072 sc1
    s_waitcnt lgkmcnt(2)
    v_smfmac_f32_16x16x64_bf16 v[20:23], v[60:63], v[32:39], v2
    v_smfmac_f32_16x16x64_bf16 v[24:27], v[48:51], v[232:239], v2
    v_smfmac_f32_16x16x64_bf16 v[24:27], v[52:55], v[240:247], v2
    v_smfmac_f32_16x16x64_bf16 v[24:27], v[56:59], v[248:255], v2
    s_nop 4
    v_cvt_pk_bf16_f32 v20, v20, v21
    v_cvt_pk_bf16_f32 v21, v22, v23
    v_bfi_b32 v20, 1, s44, v20
    buffer_store_dwordx2 v[20:21], v3, s[8:11], s24 offen offset:1024 sc1
    s_waitcnt lgkmcnt(0)
    v_smfmac_f32_16x16x64_bf16 v[24:27], v[60:63], v[40:47], v2
    s_nop 7
    v_cvt_pk_bf16_f32 v24, v24, v25
    v_cvt_pk_bf16_f32 v25, v26, v27
    v_bfi_b32 v24, 1, s44, v24
    buffer_store_dwordx2 v[24:25], v3, s[8:11], s24 offen offset:3072 sc1
    s_cmp_eq_u32 s34, 0
    s_cbranch_scc1 L_noreds
    buffer_store_dword v0, v5, s[8:11], s31 offen sc1
    s_cmp_eq_u32 s45, 0
    s_cbranch_scc1 L_rdels_x
    s_mov_b32 s22, s45
L_rdels:
    s_sub_u32 s22, s22, 1
    s_cmp_gt_i32 s22, 0
    s_cbranch_scc1 L_rdels
L_rdels_x:
    buffer_load_dwordx4 v[20:23], v4, s[8:11], s25 offen sc1
    buffer_load_dwordx4 v[24:27], v4, s[8:11], s26 offen sc1
    buffer_load_dwordx4 v[28:31], v4, s[8:11], s27 offen sc1
    buffer_load_dwordx4 v[40:43], v4, s[8:11], s28 offen sc1
    v_cndmask_b32 v48, 0, v16, s[64:65]
    v_cndmask_b32 v49, 0, v16, s[66:67]
    v_cndmask_b32 v50, 0, v16, s[68:69]
    v_cndmask_b32 v51, 0, v16, s[70:71]
    v_permlane32_swap_b32 v64, v68
    v_permlane32_swap_b32 v65, v69
    v_permlane32_swap_b32 v66, v70
    v_permlane32_swap_b32 v67, v71
    v_pk_add_f32 v[64:65], v[64:65], v[68:69]
    v_pk_add_f32 v[66:67], v[66:67], v[70:71]
    v_cvt_pk_bf16_f32 v18, v64, v65
    v_cvt_pk_bf16_f32 v19, v66, v67
    s_mov_b32 s74, s33
    s_add_u32 s32, s32, 262144
    s_add_u32 s72, s72, 262144
    s_add_u32 s33, s33, 65536
    s_add_u32 s73, s73, 65536
    s_add_u32 s87, s30, s57
    s_add_u32 s88, s87, 4096
    s_add_u32 s89, s30, 8192
    s_add_u32 s20, s18, 3
    s_and_b32 s20, s20, 3
    s_mul_i32 s20, s20, 9216
    s_add_u32 s29, s20, 0x100000
    s_add_u32 s18, s18, 1
    buffer_load_dwordx4 v[20:23], v4, s[8:11], s25 offen sc1
    buffer_load_dwordx4 v[24:27], v4, s[8:11], s26 offen sc1
    buffer_load_dwordx4 v[28:31], v4, s[8:11], s27 offen sc1
    buffer_load_dwordx4 v[40:43], v4, s[8:11], s28 offen sc1
    s_mov_b32 s35, s58
    s_cmp_eq_u32 s44, 0
    s_cbranch_scc0 L_reds_poll1
L_reds_poll0:
    s_waitcnt vmcnt(4)
    v_or3_b32 v52, v20, v22, v24
    v_or3_b32 v53, v26, v28, v30
    v_or3_b32 v52, v52, v40, v42
    v_or_b32 v52, v52, v53
    v_and_b32 v52, 1, v52
    v_cmp_ne_u32 vcc, s44, v52
    s_cbranch_vccz L_reds_done
    buffer_load_dwordx4 v[20:23], v4, s[8:11], s25 offen sc1
    buffer_load_dwordx4 v[24:27], v4, s[8:11], s26 offen sc1
    buffer_load_dwordx4 v[28:31], v4, s[8:11], s27 offen sc1
    buffer_load_dwordx4 v[40:43], v4, s[8:11], s28 offen sc1
    s_sub_u32 s35, s35, 1
    s_cmp_lg_u32 s35, 0
    s_cbranch_scc1 L_reds_poll0
    s_or_b32 s39, s39, 1
    s_mov_b32 s58, 1
    s_branch L_reds_done
L_reds_poll1:
    s_waitcnt vmcnt(4)
    v_and_b32 v52, v20, v22
    v_and_b32 v53, v24, v26
    v_and_b32 v54, v28, v30
    v_and_b32 v55, v40, v42
    v_and_b32 v52, v52, v53
    v_and_b32 v54, v54, v55
    v_and_b32 v52, v52, v54
    v_and_b32 v52, 1, v52
    v_cmp_ne_u32 vcc, s44, v52
    s_cbranch_vccz L_reds_done
    buffer_load_dwordx4 v[20:23], v4, s[8:11], s25 offen sc1
    buffer_load_dwordx4 v[24:27], v4, s[8:11], s26 offen sc1
    buffer_load_dwordx4 v[28:31], v4, s[8:11], s27 offen sc1
    buffer_load_dwordx4 v[40:43], v4, s[8:11], s28 offen sc1
    s_sub_u32 s35, s35, 1
    s_cmp_lg_u32 s35, 0
    s_cbranch_scc1 L_reds_poll1
    s_or_b32 s39, s39, 1
    s_mov_b32 s58, 1
    s_branch L_reds_done
L_reds_done:
    v_mfma_f32_16x16x32_bf16 v[44:47], v[20:23], v[48:51], 0
    v_mfma_f32_16x16x32_bf16 v[44:47], v[24:27], v[48:51], v[44:47]
    v_mfma_f32_16x16x32_bf16 v[44:47], v[28:31], v[48:51], v[44:47]
    v_mfma_f32_16x16x32_bf16 v[44:47], v[40:43], v[48:51], v[44:47]
    s_nop 7
    v_permlane32_swap_b32 v44, v45
    v_permlane32_swap_b32 v46, v47
    v_add_f32 v44, v44, v45
    v_add_f32 v46, v46, v47
    v_cvt_pk_bf16_f32 v44, v44, v46
    buffer_store_dword v44, v5, s[8:11], s30 offen sc1
    s_mov_b32 s21, 5
    s_branch L_reds_done2
L_noreds:
    v_permlane32_swap_b32 v64, v68
    v_permlane32_swap_b32 v65, v69
    v_permlane32_swap_b32 v66, v70
    v_permlane32_swap_b32 v67, v71
    v_pk_add_f32 v[64:65], v[64:65], v[68:69]
    v_pk_add_f32 v[66:67], v[66:67], v[70:71]
    v_cvt_pk_bf16_f32 v18, v64, v65
    v_cvt_pk_bf16_f32 v19, v66, v67
    s_mov_b32 s74, s33
    s_add_u32 s32, s32, 262144
    s_add_u32 s72, s72, 262144
    s_add_u32 s33, s33, 65536
    s_add_u32 s73, s73, 65536
    s_add_u32 s87, s30, s57
    s_add_u32 s88, s87, 4096
    s_add_u32 s89, s30, 8192
    s_add_u32 s20, s18, 3
    s_and_b32 s20, s20, 3
    s_mul_i32 s20, s20, 9216
    s_add_u32 s29, s20, 0x100000
    s_add_u32 s18, s18, 1
    s_and_b32 s19, s18, 7
    s_or_b32 s19, s19, s17
    s_cmp_eq_u32 s19, 0
    s_cbranch_scc0 L_kvw_30
    s_lshl_b32 s22, s18, 4
    s_add_u32 s22, s22, 0x200480
    s_mov_b32 s35, s3
L_pg_31:
    s_mov_b64 exec, 1
    buffer_load_dword v22, off, s[8:11], s22 sc1
    s_waitcnt vmcnt(0)
    s_nop 0
    v_readfirstlane_b32 s19, v22
    s_mov_b64 exec, -1
    s_cmp_ge_u32 s19, 128
    s_cbranch_scc1 L_pg_31_d
    s_sub_u32 s35, s35, 1
    s_cmp_lg_u32 s35, 0
    s_cbranch_scc1 L_pg_31
    s_mov_b32 s3, 1
L_pg_31_d:
L_kvw_30:
    s_mov_b32 s21, 27
L_reds_done2:
    v_add_u32 v56, s57, v1
    s_cmp_eq_u32 s21, 0
    s_cbranch_scc1 L_gdels_x
    s_mov_b32 s22, s21
L_gdels:
    s_sub_u32 s22, s22, 1
    s_cmp_gt_i32 s22, 0
    s_cbranch_scc1 L_gdels
L_gdels_x:
    s_cmp_eq_u32 s17, 0
    s_cbranch_scc1 L_gats0
    buffer_load_dwordx4 v[72:75], v1, s[8:11], s87 offen sc1
    buffer_load_dwordx4 v[76:79], v1, s[8:11], s88 offen sc1
    s_xor_b32 s44, s44, 1
    s_mov_b32 s30, s31
    s_mov_b32 s31, s29
    s_mov_b32 s35, s58
    v_mov_b64 v[48:49], 0
    v_mov_b64 v[50:51], 0
    v_mov_b64 v[52:53], 0
    v_mov_b64 v[54:55], 0
    v_mov_b64 v[60:61], 0
    v_mov_b64 v[62:63], 0
    v_mov_b64 v[64:65], 0
    v_mov_b64 v[66:67], 0
    ds_read_b128 v[32:35], v12 offset:0
    ds_read_b128 v[36:39], v12 offset:1024
L_gats_poll:
    s_waitcnt vmcnt(0)
    v_max3_u32 v57, v72, v73, v74
    v_max3_u32 v58, v75, v76, v77
    v_max3_u32 v57, v57, v78, v79
    v_max_u32 v57, v57, v58
    v_cmp_eq_u32 vcc, -1, v57
    s_cbranch_vccz L_gats_ok
    buffer_load_dwordx4 v[72:75], v1, s[8:11], s87 offen sc1
    buffer_load_dwordx4 v[76:79], v1, s[8:11], s88 offen sc1
    s_sub_u32 s35, s35, 1
    s_cmp_lg_u32 s35, 0
    s_cbranch_scc1 L_gats_poll
    s_or_b32 s39, s39, 2
    s_mov_b32 s58, 1
L_gats_ok:
    ds_write_b128 v56, v[72:75] offset:0
    ds_write_b128 v56, v[76:79] offset:4096
    ds_read_b128 v[40:43], v12 offset:2048
    ds_read_b128 v[44:47], v12 offset:3072
    v_mov_b64 v[56:57], 0
    v_mov_b64 v[58:59], 0
    s_branch L_gats_w
L_gats0:
    buffer_load_dwordx4 v[72:75], v1, s[8:11], s87 offen sc1
    buffer_load_dwordx4 v[76:79], v1, s[8:11], s88 offen sc1
    buffer_load_dwordx4 v[68:71], v1, s[8:11], s89 offen sc1
    s_xor_b32 s44, s44, 1
    s_mov_b32 s30, s31
    s_mov_b32 s31, s29
    s_mov_b32 s35, s58
    v_mov_b64 v[48:49], 0
    v_mov_b64 v[50:51], 0
    v_mov_b64 v[52:53], 0
    v_mov_b64 v[54:55], 0
    v_mov_b64 v[60:61], 0
    v_mov_b64 v[62:63], 0
    v_mov_b64 v[64:65], 0
    v_mov_b64 v[66:67], 0
    ds_read_b128 v[32:35], v12 offset:0
    ds_read_b128 v[36:39], v12 offset:1024
L_gats0_poll:
    s_waitcnt vmcnt(0)
    v_max3_u32 v57, v72, v73, v74
    v_max3_u32 v58, v75, v76, v77
    v_max3_u32 v57, v57, v78, v79
    v_max3_u32 v58, v58, v68, v69
    v_max3_u32 v57, v57, v70, v71
    v_max_u32 v57, v57, v58
    v_cmp_eq_u32 vcc, -1, v57
    s_cbranch_vccz L_gats0_ok
    buffer_load_dwordx4 v[72:75], v1, s[8:11], s87 offen sc1
    buffer_load_dwordx4 v[76:79], v1, s[8:11], s88 offen sc1
    buffer_load_dwordx4 v[68:71], v1, s[8:11], s89 offen sc1
    s_sub_u32 s35, s35, 1
    s_cmp_lg_u32 s35, 0
    s_cbranch_scc1 L_gats0_poll
    s_or_b32 s39, s39, 2
    s_mov_b32 s58, 1
L_gats0_ok:
    ds_write_b128 v56, v[72:75] offset:0
    ds_write_b128 v56, v[76:79] offset:4096
    ds_write_b128 v1, v[68:71] offset:8192
    ds_read_b128 v[40:43], v12 offset:2048
    ds_read_b128 v[44:47], v12 offset:3072
    v_mov_b64 v[56:57], 0
    v_mov_b64 v[58:59], 0
L_gats_w:
    s_waitcnt lgkmcnt(2)
    s_barrier
    s_branch L_chain_loops
L_chain_lasts:
    s_mov_b64 exec, s[36:37]
    buffer_store_dwordx4 v[56:59], v6, s[8:11], s73 offen sc1
    s_mov_b64 exec, -1
    buffer_store_dwordx2 v[18:19], v13, s[8:11], s74 offen sc1
    v_smfmac_f32_16x16x64_bf16 v[64:67], v[20:23], a[224:231], v2
    ds_read_b128 v[28:31], v1 offset:4096
    v_smfmac_f32_16x16x64_bf16 v[68:71], v[20:23], a[232:239], v2
    s_waitcnt lgkmcnt(1)
    v_smfmac_f32_16x16x64_bf16 v[64:67], v[24:27], a[240:247], v2
    ds_read_b128 v[20:23], v1 offset:5120
    v_smfmac_f32_16x16x64_bf16 v[68:71], v[24:27], a[248:255], v2
    s_waitcnt lgkmcnt(1)
    v_smfmac_f32_16x16x64_bf16 v[64:67], v[28:31], v[80:87], v2
    ds_read_b128 v[24:27], v1 offset:7168
    v_smfmac_f32_16x16x64_bf16 v[68:71], v[28:31], v[88:95], v2
    s_waitcnt lgkmcnt(1)
    v_smfmac_f32_16x16x64_bf16 v[64:67], v[20:23], v[96:103], v2
    ds_read_b128 v[28:31], v1 offset:8192
    v_smfmac_f32_16x16x64_bf16 v[68:71], v[20:23], v[104:111], v2
    s_waitcnt lgkmcnt(1)
    v_smfmac_f32_16x16x64_bf16 v[64:67], v[24:27], v[112:119], v2
    v_smfmac_f32_16x16x64_bf16 v[68:71], v[24:27], v[120:127], v2
    s_waitcnt lgkmcnt(0)
    v_smfmac_f32_16x16x64_bf16 v[64:67], v[28:31], v[128:135], v2
    v_smfmac_f32_16x16x64_bf16 v[68:71], v[28:31], v[136:143], v2
    s_nop 7
    v_permlane32_swap_b32 v64, v68
    v_permlane32_swap_b32 v65, v69
    v_permlane32_swap_b32 v66, v70
    v_permlane32_swap_b32 v67, v71
    v_pk_add_f32 v[64:65], v[64:65], v[68:69]
    v_pk_add_f32 v[66:67], v[66:67], v[70:71]
    v_cvt_pk_bf16_f32 v64, v64, v65
    v_cvt_pk_bf16_f32 v65, v66, v67
    buffer_store_dwordx2 v[64:65], v13, s[8:11], s33 offen sc1
    s_branch L_chain_dones
L_chain_dones:
    s_waitcnt vmcnt(0)
    s_barrier
    s_cmp_eq_u32 s17, 0
    s_cbranch_scc0 L_cdn_s
    v_mov_b32 v20, 64
    s_mov_b64 exec, 1
    buffer_store_dword v20, off, s[8:11], s86 sc1
    s_mov_b64 exec, -1
L_cdn_s:
    s_cmp_eq_u32 s39, 0
    s_cbranch_scc1 L_cd_s
    s_mov_b32 s21, 0x204500
    v_mov_b32 v21, s39
    buffer_atomic_or v21, off, s[8:11], s21
L_cd_s:
    s_waitcnt vmcnt(0)
    s_branch L_end
L_end:
    s_endpgm
L_code_end:
.section .rodata,"a"
.p2align 6
.amdhsa_kernel parallel_sum__memory_aug_recurrent_mem_tr__mixer_channel_mlp__prompt_kernel
  .amdhsa_next_free_vgpr 512
  .amdhsa_next_free_sgpr 100
  .amdhsa_accum_offset 256
  .amdhsa_group_segment_fixed_size 0
  .amdhsa_kernarg_size 120
  .amdhsa_user_sgpr_count 2
  .amdhsa_user_sgpr_kernarg_segment_ptr 1
  .amdhsa_system_sgpr_workgroup_id_x 1
.end_amdhsa_kernel
.text
```
